```python
import torch

def _softmax(x, axis=-1):
    return torch.softmax(x, dim=axis)
def _gelu(x):
    return torch.nn.functional.gelu(x, approximate="tanh")
def _silu(x):
    return torch.nn.functional.silu(x)
def _sigmoid(x):
    return torch.sigmoid(x)
def _layernorm(x, axis=-1, eps=1e-5):
    m = x.mean(dim=axis, keepdim=True)
    v = x.var(dim=axis, keepdim=True, unbiased=False)
    return (x - m) / torch.sqrt(v + eps)
def _scatter_add(tgt, idx, src, axis=0):
    return tgt.clone().index_add_(axis, idx, src)
def _segment_sum(src, seg, n):
    out = torch.zeros((n,) + src.shape[1:], dtype=src.dtype)
    return out.index_add_(0, seg, src)
def _pad(x, pw):
    flat = tuple(v for pair in reversed(pw) for v in pair)
    return torch.nn.functional.pad(x, flat)

kernel_name = 'standalone__mha_block_cached__near_ridge'

def setup_inputs():

    _w = (lambda a: (lambda t: t.to(torch.bfloat16) if t.is_floating_point() else t)(torch.as_tensor(a)))
    B, Sq, D = 8, 144, 448
    H, Sk, Dh = 16, 2048, 256
    return {
        "x": _w((lambda *s: torch.randn(*s, dtype=torch.bfloat16) * 0.8)(B, Sq, D)),
        "k_cache": _w((lambda *s: torch.randn(*s, dtype=torch.bfloat16) * 0.8)(B, H, Sk, Dh)),
        "v_cache": _w((lambda *s: torch.randn(*s, dtype=torch.bfloat16) * 0.05)(B, H, Sk, Dh)),
        "wq": _w((lambda *s: torch.randn(*s, dtype=torch.bfloat16) * 0.8)(D, H * Dh) * (D ** -0.5)),
        "wo": _w((lambda *s: torch.randn(*s, dtype=torch.bfloat16) * 0.05)(H * Dh, D) * ((H * Dh) ** -0.5)),
    }

def reference(x, k_cache, v_cache, wq, wo):
    B, Sq, D = x.shape
    H, Dh = 16, 256
    q = (lambda x, *d: x.permute(*d))((x @ wq).reshape(B, Sq, H, Dh), 0, 2, 1, 3)
    scores = torch.einsum("bhqd,bhkd->bhqk", q, k_cache) * (Dh ** -0.5)
    p = _softmax(scores, axis=-1)
    o = torch.einsum("bhqk,bhkd->bhqd", p, v_cache)
    return (lambda x, *d: x.permute(*d))(o, 0, 2, 1, 3).reshape(B, Sq, H * Dh) @ wo
```

```asm
; @launch grid=(256,1,1) block=(256,1,1) lds=160256
.amdgcn_target "amdgcn-amd-amdhsa--gfx950"
.text
.globl standalone__mha_block_cached__near_ridge_kernel
.p2align 8
.type standalone__mha_block_cached__near_ridge_kernel,@function
standalone__mha_block_cached__near_ridge_kernel:
s_cmp_ge_u32 s2, 256
s_cbranch_scc1 L_done
s_load_dwordx16 s[48:63], s[0:1], 0
v_lshrrev_b32 v242, 6, v0
v_and_b32 v255, 63, v0
v_readfirstlane_b32 s3, v242
s_getpc_b64 s[90:91]
L_pc0:
s_lshr_b32 s85, s2, 3
s_lshl_b32 s85, s85, 11
v_and_b32 v1, 3, v0
v_lshl_add_u32 v1, v242, 2, v1
v_lshlrev_b32 v1, 7, v1
v_add_u32 v1, s85, v1
v_min_u32 v1, L_codeend-L_pc0-4, v1
global_load_dword v2, v1, s[90:91]
s_and_b32 s80, s2, 7
s_lshr_b32 s81, s2, 3
s_and_b32 s82, s81, 1
s_lshl_b32 s80, s80, 1
s_add_u32 s80, s80, s82
s_lshr_b32 s82, s81, 1
s_and_b32 s82, s82, 1
s_and_b32 s98, s81, 3
s_lshl_b32 s98, s98, 1
s_lshr_b32 s81, s81, 2
s_add_u32 s98, s98, s81
s_cmp_ge_u32 s98, 7
s_cselect_b32 s85, 7, 0
s_sub_u32 s98, s98, s85
s_lshl_b32 s84, s98, 19
s_lshl_b32 s98, s98, 7
s_mov_b32 s99, s98
v_lshlrev_b32 v241, 4, v255
v_mov_b32 v240, 1073741824
v_cmp_gt_u32 vcc, 56, v255
s_mul_i32 s46, s3, 8448
s_mul_i32 s47, s3, 4224
v_cndmask_b32 v233, v240, v241, vcc
v_lshrrev_b32 v3, 3, v255
v_mul_u32_u24 v243, 896, v3
v_and_b32 v3, 6, v3
v_and_b32 v4, 7, v255
v_xor_b32 v3, v3, v4
v_lshl_add_u32 v243, v3, 4, v243
v_lshrrev_b32 v3, 5, v255
v_lshlrev_b32 v3, 2, v3
v_lshl_add_u32 v3, v242, 4, v3
v_lshlrev_b32 v245, 13, v3
v_and_b32 v3, 31, v255
v_lshl_add_u32 v245, v3, 4, v245
s_mul_i32 s44, s3, 14336
s_mul_i32 s86, s3, 3584
s_mul_i32 s85, s82, 57344
s_add_u32 s45, s44, 57344
s_add_u32 s44, s44, s85
s_sub_u32 s45, s45, s85
s_mul_i32 s85, s81, 129024
s_lshl_b32 s87, s80, 9
v_add_u32 v224, s44, v243
v_add_u32 v225, s44, v243
v_add_u32 v225, 7168, v225
v_add_u32 v226, s45, v243
v_add_u32 v227, s45, v243
v_add_u32 v227, 7168, v227
v_add_u32 v216, 0, v245
v_add_u32 v217, 8192, v245
v_add_u32 v218, 16384, v245
v_add_u32 v219, 24576, v245
v_add_u32 v220, 65536, v245
v_add_u32 v221, 73728, v245
v_add_u32 v222, 81920, v245
v_add_u32 v223, 90112, v245
s_waitcnt lgkmcnt(0)
s_add_u32 s20, s48, s85
s_addc_u32 s21, s49, 0
s_mov_b32 s22, 129024
s_mov_b32 s23, 0x20000
s_add_u32 s12, s54, s87
s_addc_u32 s13, s55, 0
s_sub_u32 s14, 3670016, s87
s_mov_b32 s15, 0x20000
s_add_u32 m0, s47, 0
s_nop 0
buffer_load_dwordx4 v224, s[20:23], s98 offen lds
s_add_u32 m0, s47, 1024
s_nop 0
buffer_load_dwordx4 v225, s[20:23], s98 offen lds
s_add_u32 m0, s47, 2048
s_nop 0
buffer_load_dwordx4 v226, s[20:23], s98 offen lds
s_add_u32 m0, s47, 3072
s_nop 0
buffer_load_dwordx4 v227, s[20:23], s98 offen lds
s_add_u32 s98, s98, 128
s_cmp_ge_u32 s98, 896
s_cselect_b32 s98, 0, s98
s_add_u32 m0, s46, 101376
s_nop 0
buffer_load_dwordx4 v216, s[12:15], s84 offen lds
s_add_u32 m0, s46, 102432
s_nop 0
buffer_load_dwordx4 v217, s[12:15], s84 offen lds
s_add_u32 m0, s46, 103488
s_nop 0
buffer_load_dwordx4 v218, s[12:15], s84 offen lds
s_add_u32 m0, s46, 104544
s_nop 0
buffer_load_dwordx4 v219, s[12:15], s84 offen lds
s_add_u32 m0, s46, 105600
s_nop 0
buffer_load_dwordx4 v220, s[12:15], s84 offen lds
s_add_u32 m0, s46, 106656
s_nop 0
buffer_load_dwordx4 v221, s[12:15], s84 offen lds
s_add_u32 m0, s46, 107712
s_nop 0
buffer_load_dwordx4 v222, s[12:15], s84 offen lds
s_add_u32 m0, s46, 108768
s_nop 0
buffer_load_dwordx4 v223, s[12:15], s84 offen lds
s_add_u32 s84, s84, 524288
s_cmp_ge_u32 s84, 3670016
s_cselect_b32 s84, 0, s84
s_add_u32 m0, s47, 143360
s_add_u32 s40, s86, 114688
buffer_load_dwordx4 v233, s[20:23], s40 offen lds
s_add_u32 m0, s47, 144416
s_add_u32 s40, s86, 115584
buffer_load_dwordx4 v233, s[20:23], s40 offen lds
s_add_u32 m0, s47, 145472
s_add_u32 s40, s86, 116480
buffer_load_dwordx4 v233, s[20:23], s40 offen lds
s_add_u32 m0, s47, 146528
s_add_u32 s40, s86, 117376
buffer_load_dwordx4 v233, s[20:23], s40 offen lds
s_lshl_b32 s83, s81, 4
s_add_u32 s83, s83, s80
s_lshl_b32 s83, s83, 1
s_add_u32 s83, s83, s82
s_lshl_b32 s85, s83, 16
s_add_u32 s85, s85, 16777216
s_add_u32 s28, s62, s85
s_addc_u32 s29, s63, 0
s_mov_b32 s30, 65536
s_mov_b32 s31, 0x20000
s_lshl_b32 s96, s3, 7
s_add_u32 s96, s96, 61440
v_lshlrev_b32 v239, 16, v255
v_mov_b32 v4, 0
buffer_store_dword v4, v239, s[28:31], s96 offen sc1
buffer_store_dword v4, v239, s[28:31], s96 offen offset:512 sc1
s_add_u32 m0, s47, 16896
s_nop 0
buffer_load_dwordx4 v224, s[20:23], s98 offen lds
s_add_u32 m0, s47, 17920
s_nop 0
buffer_load_dwordx4 v225, s[20:23], s98 offen lds
s_add_u32 m0, s47, 18944
s_nop 0
buffer_load_dwordx4 v226, s[20:23], s98 offen lds
s_add_u32 m0, s47, 19968
s_nop 0
buffer_load_dwordx4 v227, s[20:23], s98 offen lds
s_add_u32 s98, s98, 128
s_cmp_ge_u32 s98, 896
s_cselect_b32 s98, 0, s98
s_add_u32 m0, s46, 33792
s_nop 0
buffer_load_dwordx4 v216, s[12:15], s84 offen lds
s_add_u32 m0, s46, 34848
s_nop 0
buffer_load_dwordx4 v217, s[12:15], s84 offen lds
s_add_u32 m0, s46, 35904
s_nop 0
buffer_load_dwordx4 v218, s[12:15], s84 offen lds
s_add_u32 m0, s46, 36960
s_nop 0
buffer_load_dwordx4 v219, s[12:15], s84 offen lds
s_add_u32 m0, s46, 38016
s_nop 0
buffer_load_dwordx4 v220, s[12:15], s84 offen lds
s_add_u32 m0, s46, 39072
s_nop 0
buffer_load_dwordx4 v221, s[12:15], s84 offen lds
s_add_u32 m0, s46, 40128
s_nop 0
buffer_load_dwordx4 v222, s[12:15], s84 offen lds
s_add_u32 m0, s46, 41184
s_nop 0
buffer_load_dwordx4 v223, s[12:15], s84 offen lds
s_add_u32 s84, s84, 524288
s_cmp_ge_u32 s84, 3670016
s_cselect_b32 s84, 0, s84
v_lshrrev_b32 v8, 2, v255
v_mul_u32_u24 v254, 1056, v8
v_and_b32 v8, 3, v255
v_lshl_add_u32 v254, v8, 3, v254
v_and_b32 v5, 15, v255
v_lshrrev_b32 v6, 4, v255
v_and_b32 v7, 6, v5
v_xor_b32 v7, v7, v6
v_lshlrev_b32 v237, 7, v5
v_lshl_add_u32 v237, v7, 4, v237
v_add_u32 v237, s47, v237
v_xor_b32 v236, 64, v237
v_mul_u32_u24 v235, 1056, v5
v_lshl_add_u32 v235, v6, 4, v235
v_add_u32 v235, 143360, v235
s_add_u32 s86, s3, 0
s_and_b32 s86, s86, 3
s_lshl_b32 s86, s86, 7
v_add_u32 v176, s86, v254
v_add_u32 v180, 101376, v176
s_add_u32 s86, s3, 1
s_and_b32 s86, s86, 3
s_lshl_b32 s86, s86, 7
v_add_u32 v177, s86, v254
v_add_u32 v181, 101376, v177
s_add_u32 s86, s3, 2
s_and_b32 s86, s86, 3
s_lshl_b32 s86, s86, 7
v_add_u32 v178, s86, v254
v_add_u32 v182, 101376, v178
s_add_u32 s86, s3, 3
s_and_b32 s86, s86, 3
s_lshl_b32 s86, s86, 7
v_add_u32 v179, s86, v254
v_add_u32 v183, 101376, v179
v_add_u32 v234, s99, v235
s_add_u32 m0, s46, 67584
s_nop 0
buffer_load_dwordx4 v216, s[12:15], s84 offen lds
s_add_u32 m0, s46, 68640
s_nop 0
buffer_load_dwordx4 v217, s[12:15], s84 offen lds
s_add_u32 m0, s46, 69696
s_nop 0
buffer_load_dwordx4 v218, s[12:15], s84 offen lds
s_add_u32 m0, s46, 70752
s_nop 0
buffer_load_dwordx4 v219, s[12:15], s84 offen lds
s_add_u32 m0, s46, 71808
s_nop 0
buffer_load_dwordx4 v220, s[12:15], s84 offen lds
s_add_u32 m0, s46, 72864
s_nop 0
buffer_load_dwordx4 v221, s[12:15], s84 offen lds
s_add_u32 m0, s46, 73920
s_nop 0
buffer_load_dwordx4 v222, s[12:15], s84 offen lds
s_add_u32 m0, s46, 74976
s_nop 0
buffer_load_dwordx4 v223, s[12:15], s84 offen lds
s_add_u32 s84, s84, 524288
s_cmp_ge_u32 s84, 3670016
s_cselect_b32 s84, 0, s84
s_waitcnt vmcnt(22) lgkmcnt(0)
s_barrier
ds_read_b128 a[112:115], v234 offset:0
ds_read_b128 a[116:119], v234 offset:64
ds_read_b128 a[0:3], v237 offset:0
ds_read_b128 a[56:59], v237 offset:2048
ds_read_b128 a[4:7], v236 offset:0
ds_read_b128 a[60:63], v236 offset:2048
ds_read_b64_tr_b16 a[192:193], v180 offset:0
ds_read_b64_tr_b16 a[194:195], v180 offset:512
ds_read_b64_tr_b16 a[196:197], v180 offset:32
ds_read_b64_tr_b16 a[198:199], v180 offset:544
ds_read_b64_tr_b16 a[200:201], v180 offset:64
ds_read_b64_tr_b16 a[202:203], v180 offset:576
ds_read_b64_tr_b16 a[204:205], v180 offset:96
ds_read_b64_tr_b16 a[206:207], v180 offset:608
ds_read_b64_tr_b16 a[208:209], v181 offset:0
ds_read_b64_tr_b16 a[210:211], v181 offset:512
ds_read_b64_tr_b16 a[212:213], v181 offset:32
ds_read_b64_tr_b16 a[214:215], v181 offset:544
ds_read_b64_tr_b16 a[216:217], v181 offset:64
ds_read_b64_tr_b16 a[218:219], v181 offset:576
ds_read_b64_tr_b16 a[220:221], v181 offset:96
ds_read_b64_tr_b16 a[222:223], v181 offset:608
s_waitcnt lgkmcnt(5)
v_mfma_f32_16x16x32_bf16 v[0:3], a[192:195], a[0:3], 0
ds_read_b64_tr_b16 a[224:225], v182 offset:0
v_add_u32 v184, 33792, v176
v_mfma_f32_16x16x32_bf16 v[64:67], a[192:195], a[56:59], 0
ds_read_b64_tr_b16 a[226:227], v182 offset:512
v_add_u32 v185, 33792, v177
v_mfma_f32_16x16x32_bf16 v[128:131], a[192:195], a[112:115], 0
ds_read_b64_tr_b16 a[228:229], v182 offset:32
v_add_u32 v186, 33792, v178
v_mfma_f32_16x16x32_bf16 v[4:7], a[196:199], a[0:3], 0
ds_read_b64_tr_b16 a[230:231], v182 offset:544
v_add_u32 v187, 33792, v179
v_mfma_f32_16x16x32_bf16 v[68:71], a[196:199], a[56:59], 0
ds_read_b64_tr_b16 a[232:233], v182 offset:64
ds_read_b64_tr_b16 a[234:235], v182 offset:576
v_mfma_f32_16x16x32_bf16 v[132:135], a[196:199], a[112:115], 0
ds_read_b64_tr_b16 a[236:237], v182 offset:96
ds_read_b64_tr_b16 a[238:239], v182 offset:608
v_mfma_f32_16x16x32_bf16 v[8:11], a[200:203], a[0:3], 0
ds_read_b64_tr_b16 a[240:241], v183 offset:0
s_add_u32 m0, s47, 0
v_mfma_f32_16x16x32_bf16 v[72:75], a[200:203], a[56:59], 0
ds_read_b64_tr_b16 a[242:243], v183 offset:512
buffer_load_dwordx4 v224, s[20:23], s98 offen lds
v_mfma_f32_16x16x32_bf16 v[136:139], a[200:203], a[112:115], 0
ds_read_b64_tr_b16 a[244:245], v183 offset:32
s_add_u32 m0, s47, 1024
v_mfma_f32_16x16x32_bf16 v[12:15], a[204:207], a[0:3], 0
ds_read_b64_tr_b16 a[246:247], v183 offset:544
s_add_u32 s99, s99, 128
s_cmp_ge_u32 s99, 896
s_cselect_b32 s99, 0, s99
v_add_u32 v234, s99, v235
v_mfma_f32_16x16x32_bf16 v[76:79], a[204:207], a[56:59], 0
ds_read_b64_tr_b16 a[248:249], v183 offset:64
ds_read_b64_tr_b16 a[250:251], v183 offset:576
v_mfma_f32_16x16x32_bf16 v[140:143], a[204:207], a[112:115], 0
ds_read_b64_tr_b16 a[252:253], v183 offset:96
buffer_load_dwordx4 v225, s[20:23], s98 offen lds
v_mfma_f32_16x16x32_bf16 v[16:19], a[208:211], a[0:3], 0
ds_read_b64_tr_b16 a[254:255], v183 offset:608
s_add_u32 m0, s47, 2048
v_mfma_f32_16x16x32_bf16 v[80:83], a[208:211], a[56:59], 0
ds_read_b64_tr_b16 a[192:193], v180 offset:16896
s_waitcnt lgkmcnt(5)
v_mfma_f32_16x16x32_bf16 v[20:23], a[212:215], a[0:3], 0
ds_read_b64_tr_b16 a[194:195], v180 offset:17408
ds_read_b64_tr_b16 a[196:197], v180 offset:16928
v_mfma_f32_16x16x32_bf16 v[84:87], a[212:215], a[56:59], 0
ds_read_b64_tr_b16 a[198:199], v180 offset:17440
buffer_load_dwordx4 v226, s[20:23], s98 offen lds
v_mfma_f32_16x16x32_bf16 v[24:27], a[216:219], a[0:3], 0
ds_read_b64_tr_b16 a[200:201], v180 offset:16960
s_add_u32 m0, s47, 3072
v_mfma_f32_16x16x32_bf16 v[88:91], a[216:219], a[56:59], 0
ds_read_b64_tr_b16 a[202:203], v180 offset:17472
ds_read_b64_tr_b16 a[204:205], v180 offset:16992
v_mfma_f32_16x16x32_bf16 v[28:31], a[220:223], a[0:3], 0
ds_read_b64_tr_b16 a[206:207], v180 offset:17504
ds_read_b64_tr_b16 a[208:209], v181 offset:16896
v_mfma_f32_16x16x32_bf16 v[92:95], a[220:223], a[56:59], 0
ds_read_b64_tr_b16 a[210:211], v181 offset:17408
buffer_load_dwordx4 v227, s[20:23], s98 offen lds
v_mfma_f32_16x16x32_bf16 v[32:35], a[224:227], a[0:3], 0
s_waitcnt vmcnt(20)
ds_read_b128 a[8:11], v237 offset:16896
v_mfma_f32_16x16x32_bf16 v[96:99], a[224:227], a[56:59], 0
ds_read_b128 a[64:67], v237 offset:18944
ds_read_b128 a[12:15], v236 offset:16896
v_mfma_f32_16x16x32_bf16 v[36:39], a[228:231], a[0:3], 0
ds_read_b128 a[68:71], v236 offset:18944
s_add_u32 s98, s98, 128
s_cmp_ge_u32 s98, 896
s_cselect_b32 s98, 0, s98
v_mfma_f32_16x16x32_bf16 v[100:103], a[228:231], a[56:59], 0
ds_read_b64_tr_b16 a[212:213], v181 offset:16928
ds_read_b64_tr_b16 a[214:215], v181 offset:17440
v_mfma_f32_16x16x32_bf16 v[40:43], a[232:235], a[0:3], 0
ds_read_b64_tr_b16 a[216:217], v181 offset:16960
ds_read_b64_tr_b16 a[218:219], v181 offset:17472
v_mfma_f32_16x16x32_bf16 v[104:107], a[232:235], a[56:59], 0
ds_read_b64_tr_b16 a[220:221], v181 offset:16992
ds_read_b64_tr_b16 a[222:223], v181 offset:17504
v_mfma_f32_16x16x32_bf16 v[44:47], a[236:239], a[0:3], 0
ds_read_b64_tr_b16 a[224:225], v182 offset:16896
ds_read_b64_tr_b16 a[226:227], v182 offset:17408
v_mfma_f32_16x16x32_bf16 v[108:111], a[236:239], a[56:59], 0
ds_read_b64_tr_b16 a[228:229], v182 offset:16928
s_waitcnt lgkmcnt(9)
s_add_u32 m0, s47, 16896
v_mfma_f32_16x16x32_bf16 v[48:51], a[240:243], a[0:3], 0
ds_read_b64_tr_b16 a[230:231], v182 offset:17440
buffer_load_dwordx4 v224, s[20:23], s98 offen lds
v_mfma_f32_16x16x32_bf16 v[112:115], a[240:243], a[56:59], 0
ds_read_b64_tr_b16 a[232:233], v182 offset:16960
s_add_u32 m0, s47, 17920
v_mfma_f32_16x16x32_bf16 v[52:55], a[244:247], a[0:3], 0
ds_read_b64_tr_b16 a[234:235], v182 offset:17472
ds_read_b64_tr_b16 a[236:237], v182 offset:16992
v_mfma_f32_16x16x32_bf16 v[116:119], a[244:247], a[56:59], 0
ds_read_b64_tr_b16 a[238:239], v182 offset:17504
s_add_u32 s92, s60, 0
s_addc_u32 s93, s61, 0
v_mfma_f32_16x16x32_bf16 v[56:59], a[248:251], a[0:3], 0
ds_read_b64_tr_b16 a[240:241], v183 offset:16896
buffer_load_dwordx4 v225, s[20:23], s98 offen lds
v_mfma_f32_16x16x32_bf16 v[120:123], a[248:251], a[56:59], 0
ds_read_b64_tr_b16 a[242:243], v183 offset:17408
s_add_u32 m0, s47, 18944
v_mfma_f32_16x16x32_bf16 v[60:63], a[252:255], a[0:3], 0
ds_read_b64_tr_b16 a[244:245], v183 offset:16928
ds_read_b64_tr_b16 a[246:247], v183 offset:17440
v_mfma_f32_16x16x32_bf16 v[124:127], a[252:255], a[56:59], 0
s_mov_b32 s94, 256
s_mov_b32 s95, 0x20000
v_mfma_f32_16x16x32_bf16 v[0:3], a[192:195], a[4:7], v[0:3]
ds_read_b64_tr_b16 a[248:249], v183 offset:16960
buffer_load_dwordx4 v226, s[20:23], s98 offen lds
v_mfma_f32_16x16x32_bf16 v[64:67], a[192:195], a[60:63], v[64:67]
ds_read_b64_tr_b16 a[250:251], v183 offset:17472
s_add_u32 m0, s47, 19968
v_mfma_f32_16x16x32_bf16 v[128:131], a[192:195], a[116:119], v[128:131]
s_getreg_b32 s86, hwreg(HW_REG_XCC_ID, 0, 4)
s_or_b32 s86, s86, 0x10
v_mfma_f32_16x16x32_bf16 v[4:7], a[196:199], a[4:7], v[4:7]
ds_read_b64_tr_b16 a[252:253], v183 offset:16992
ds_read_b64_tr_b16 a[254:255], v183 offset:17504
v_mfma_f32_16x16x32_bf16 v[68:71], a[196:199], a[60:63], v[68:71]
buffer_load_dwordx4 v227, s[20:23], s98 offen lds
s_add_u32 s98, s98, 128
s_cmp_ge_u32 s98, 896
s_cselect_b32 s98, 0, s98
v_mfma_f32_16x16x32_bf16 v[132:135], a[196:199], a[116:119], v[132:135]
s_and_b32 s85, s83, 3
s_lshl_b32 s85, s85, 3
v_mfma_f32_16x16x32_bf16 v[8:11], a[200:203], a[4:7], v[8:11]
s_lshl_b32 s85, s86, s85
v_mov_b32 v238, s85
v_mfma_f32_16x16x32_bf16 v[72:75], a[200:203], a[60:63], v[72:75]
s_and_b32 s97, s83, 0xfc
s_cmp_eq_u32 s3, 0
s_cselect_b32 s97, s97, 0x10000
v_mfma_f32_16x16x32_bf16 v[136:139], a[200:203], a[116:119], v[136:139]
s_waitcnt vmcnt(16) lgkmcnt(0)
s_barrier
v_mfma_f32_16x16x32_bf16 v[12:15], a[204:207], a[4:7], v[12:15]
ds_read_b128 a[120:123], v234 offset:0
ds_read_b128 a[124:127], v234 offset:64
v_mfma_f32_16x16x32_bf16 v[76:79], a[204:207], a[60:63], v[76:79]
ds_read_b64_tr_b16 a[192:193], v184 offset:0
s_add_u32 m0, s46, 101376
v_mfma_f32_16x16x32_bf16 v[140:143], a[204:207], a[116:119], v[140:143]
ds_read_b64_tr_b16 a[194:195], v184 offset:512
buffer_load_dwordx4 v216, s[12:15], s84 offen lds
v_mfma_f32_16x16x32_bf16 v[16:19], a[208:211], a[4:7], v[16:19]
ds_read_b64_tr_b16 a[196:197], v184 offset:32
s_add_u32 m0, s46, 102432
v_mfma_f32_16x16x32_bf16 v[80:83], a[208:211], a[60:63], v[80:83]
ds_read_b64_tr_b16 a[198:199], v184 offset:544
v_add_u32 v180, 67584, v176
v_mfma_f32_16x16x32_bf16 v[20:23], a[212:215], a[4:7], v[20:23]
ds_read_b64_tr_b16 a[200:201], v184 offset:64
v_add_u32 v181, 67584, v177
v_mfma_f32_16x16x32_bf16 v[84:87], a[212:215], a[60:63], v[84:87]
ds_read_b64_tr_b16 a[202:203], v184 offset:576
buffer_load_dwordx4 v217, s[12:15], s84 offen lds
v_mfma_f32_16x16x32_bf16 v[24:27], a[216:219], a[4:7], v[24:27]
ds_read_b64_tr_b16 a[204:205], v184 offset:96
s_add_u32 m0, s46, 103488
v_mfma_f32_16x16x32_bf16 v[88:91], a[216:219], a[60:63], v[88:91]
ds_read_b64_tr_b16 a[206:207], v184 offset:608
s_add_u32 s99, s99, 128
s_cmp_ge_u32 s99, 896
s_cselect_b32 s99, 0, s99
v_add_u32 v234, s99, v235
v_mfma_f32_16x16x32_bf16 v[28:31], a[220:223], a[4:7], v[28:31]
ds_read_b64_tr_b16 a[208:209], v185 offset:0
v_add_u32 v182, 67584, v178
v_mfma_f32_16x16x32_bf16 v[92:95], a[220:223], a[60:63], v[92:95]
ds_read_b64_tr_b16 a[210:211], v185 offset:512
buffer_load_dwordx4 v218, s[12:15], s84 offen lds
v_mfma_f32_16x16x32_bf16 v[32:35], a[224:227], a[4:7], v[32:35]
ds_read_b64_tr_b16 a[212:213], v185 offset:32
s_add_u32 m0, s46, 104544
v_mfma_f32_16x16x32_bf16 v[96:99], a[224:227], a[60:63], v[96:99]
ds_read_b64_tr_b16 a[214:215], v185 offset:544
v_add_u32 v183, 67584, v179
v_mfma_f32_16x16x32_bf16 v[36:39], a[228:231], a[4:7], v[36:39]
ds_read_b64_tr_b16 a[216:217], v185 offset:64
ds_read_b64_tr_b16 a[218:219], v185 offset:576
v_mfma_f32_16x16x32_bf16 v[100:103], a[228:231], a[60:63], v[100:103]
s_waitcnt vmcnt(7)
ds_read_b128 a[16:19], v237 offset:0
v_mfma_f32_16x16x32_bf16 v[40:43], a[232:235], a[4:7], v[40:43]
ds_read_b128 a[72:75], v237 offset:2048
ds_read_b128 a[20:23], v236 offset:0
v_mfma_f32_16x16x32_bf16 v[104:107], a[232:235], a[60:63], v[104:107]
ds_read_b128 a[76:79], v236 offset:2048
buffer_load_dwordx4 v219, s[12:15], s84 offen lds
v_mfma_f32_16x16x32_bf16 v[44:47], a[236:239], a[4:7], v[44:47]
ds_read_b64_tr_b16 a[220:221], v185 offset:96
s_add_u32 m0, s46, 105600
v_mfma_f32_16x16x32_bf16 v[108:111], a[236:239], a[60:63], v[108:111]
ds_read_b64_tr_b16 a[222:223], v185 offset:608
ds_read_b64_tr_b16 a[224:225], v186 offset:0
v_mfma_f32_16x16x32_bf16 v[48:51], a[240:243], a[4:7], v[48:51]
ds_read_b64_tr_b16 a[226:227], v186 offset:512
ds_read_b64_tr_b16 a[228:229], v186 offset:32
v_mfma_f32_16x16x32_bf16 v[112:115], a[240:243], a[60:63], v[112:115]
ds_read_b64_tr_b16 a[230:231], v186 offset:544
buffer_load_dwordx4 v220, s[12:15], s84 offen lds
v_mfma_f32_16x16x32_bf16 v[52:55], a[244:247], a[4:7], v[52:55]
ds_read_b64_tr_b16 a[232:233], v186 offset:64
s_waitcnt lgkmcnt(7)
s_add_u32 m0, s47, 0
v_mfma_f32_16x16x32_bf16 v[116:119], a[244:247], a[60:63], v[116:119]
ds_read_b64_tr_b16 a[234:235], v186 offset:576
ds_read_b64_tr_b16 a[236:237], v186 offset:96
v_mfma_f32_16x16x32_bf16 v[56:59], a[248:251], a[4:7], v[56:59]
ds_read_b64_tr_b16 a[238:239], v186 offset:608
ds_read_b64_tr_b16 a[240:241], v187 offset:0
v_mfma_f32_16x16x32_bf16 v[120:123], a[248:251], a[60:63], v[120:123]
ds_read_b64_tr_b16 a[242:243], v187 offset:512
buffer_load_dwordx4 v224, s[20:23], s98 offen lds
v_mfma_f32_16x16x32_bf16 v[60:63], a[252:255], a[4:7], v[60:63]
ds_read_b64_tr_b16 a[244:245], v187 offset:32
s_add_u32 m0, s47, 1024
v_mfma_f32_16x16x32_bf16 v[124:127], a[252:255], a[60:63], v[124:127]
ds_read_b64_tr_b16 a[246:247], v187 offset:544
s_lshl_b32 s85, s83, 19
v_mfma_f32_16x16x32_bf16 v[0:3], a[192:195], a[8:11], v[0:3]
ds_read_b64_tr_b16 a[248:249], v187 offset:64
ds_read_b64_tr_b16 a[250:251], v187 offset:576
v_mfma_f32_16x16x32_bf16 v[64:67], a[192:195], a[64:67], v[64:67]
buffer_load_dwordx4 v225, s[20:23], s98 offen lds
s_add_u32 m0, s47, 2048
v_mfma_f32_16x16x32_bf16 v[128:131], a[192:195], a[120:123], v[128:131]
s_add_u32 s4, s50, s85
s_addc_u32 s5, s51, 0
v_mfma_f32_16x16x32_bf16 v[4:7], a[196:199], a[8:11], v[4:7]
ds_read_b64_tr_b16 a[252:253], v187 offset:96
ds_read_b64_tr_b16 a[254:255], v187 offset:608
v_mfma_f32_16x16x32_bf16 v[68:71], a[196:199], a[64:67], v[68:71]
s_mov_b32 s6, 524288
s_mov_b32 s7, 0x20000
v_mfma_f32_16x16x32_bf16 v[132:135], a[196:199], a[120:123], v[132:135]
buffer_load_dwordx4 v226, s[20:23], s98 offen lds
s_add_u32 m0, s47, 3072
v_mfma_f32_16x16x32_bf16 v[8:11], a[200:203], a[8:11], v[8:11]
ds_read_b64_tr_b16 a[192:193], v184 offset:16896
ds_read_b64_tr_b16 a[194:195], v184 offset:17408
v_mfma_f32_16x16x32_bf16 v[72:75], a[200:203], a[64:67], v[72:75]
s_add_u32 s8, s52, s85
s_addc_u32 s9, s53, 0
v_mfma_f32_16x16x32_bf16 v[136:139], a[200:203], a[120:123], v[136:139]
s_waitcnt vmcnt(8)
ds_read_b128 a[24:27], v237 offset:16896
v_mfma_f32_16x16x32_bf16 v[12:15], a[204:207], a[8:11], v[12:15]
ds_read_b128 a[80:83], v237 offset:18944
ds_read_b128 a[28:31], v236 offset:16896
v_mfma_f32_16x16x32_bf16 v[76:79], a[204:207], a[64:67], v[76:79]
ds_read_b128 a[84:87], v236 offset:18944
buffer_load_dwordx4 v227, s[20:23], s98 offen lds
v_mfma_f32_16x16x32_bf16 v[140:143], a[204:207], a[120:123], v[140:143]
ds_read_b64_tr_b16 a[196:197], v184 offset:16928
s_add_u32 s98, s98, 128
s_cmp_ge_u32 s98, 896
s_cselect_b32 s98, 0, s98
v_mfma_f32_16x16x32_bf16 v[16:19], a[208:211], a[8:11], v[16:19]
ds_read_b64_tr_b16 a[198:199], v184 offset:17440
s_add_u32 m0, s46, 106656
v_mfma_f32_16x16x32_bf16 v[80:83], a[208:211], a[64:67], v[80:83]
ds_read_b64_tr_b16 a[200:201], v184 offset:16960
ds_read_b64_tr_b16 a[202:203], v184 offset:17472
v_mfma_f32_16x16x32_bf16 v[20:23], a[212:215], a[8:11], v[20:23]
ds_read_b64_tr_b16 a[204:205], v184 offset:16992
buffer_load_dwordx4 v221, s[12:15], s84 offen lds
v_mfma_f32_16x16x32_bf16 v[84:87], a[212:215], a[64:67], v[84:87]
ds_read_b64_tr_b16 a[206:207], v184 offset:17504
s_waitcnt lgkmcnt(6)
s_add_u32 m0, s47, 16896
v_mfma_f32_16x16x32_bf16 v[24:27], a[216:219], a[8:11], v[24:27]
ds_read_b64_tr_b16 a[208:209], v185 offset:16896
ds_read_b64_tr_b16 a[210:211], v185 offset:17408
v_mfma_f32_16x16x32_bf16 v[88:91], a[216:219], a[64:67], v[88:91]
s_mov_b32 s10, 524288
s_mov_b32 s11, 0x20000
v_mfma_f32_16x16x32_bf16 v[28:31], a[220:223], a[8:11], v[28:31]
ds_read_b64_tr_b16 a[212:213], v185 offset:16928
buffer_load_dwordx4 v224, s[20:23], s98 offen lds
v_mfma_f32_16x16x32_bf16 v[92:95], a[220:223], a[64:67], v[92:95]
ds_read_b64_tr_b16 a[214:215], v185 offset:17440
s_add_u32 m0, s47, 17920
v_mfma_f32_16x16x32_bf16 v[32:35], a[224:227], a[8:11], v[32:35]
ds_read_b64_tr_b16 a[216:217], v185 offset:16960
ds_read_b64_tr_b16 a[218:219], v185 offset:17472
v_mfma_f32_16x16x32_bf16 v[96:99], a[224:227], a[64:67], v[96:99]
v_lshl_add_u32 v247, v242, 12, v241
s_mul_i32 s101, s83, 0
v_mfma_f32_16x16x32_bf16 v[36:39], a[228:231], a[8:11], v[36:39]
ds_read_b64_tr_b16 a[220:221], v185 offset:16992
buffer_load_dwordx4 v225, s[20:23], s98 offen lds
v_mfma_f32_16x16x32_bf16 v[100:103], a[228:231], a[64:67], v[100:103]
ds_read_b64_tr_b16 a[222:223], v185 offset:17504
s_add_u32 m0, s47, 18944
v_mfma_f32_16x16x32_bf16 v[40:43], a[232:235], a[8:11], v[40:43]
ds_read_b64_tr_b16 a[224:225], v186 offset:16896
ds_read_b64_tr_b16 a[226:227], v186 offset:17408
v_mfma_f32_16x16x32_bf16 v[104:107], a[232:235], a[64:67], v[104:107]
s_mul_i32 s85, s80, 229376
s_add_u32 s16, s56, s85
s_addc_u32 s17, s57, 0
v_mfma_f32_16x16x32_bf16 v[44:47], a[236:239], a[8:11], v[44:47]
ds_read_b64_tr_b16 a[228:229], v186 offset:16928
buffer_load_dwordx4 v226, s[20:23], s98 offen lds
v_mfma_f32_16x16x32_bf16 v[108:111], a[236:239], a[64:67], v[108:111]
ds_read_b64_tr_b16 a[230:231], v186 offset:17440
s_add_u32 m0, s47, 19968
v_mfma_f32_16x16x32_bf16 v[48:51], a[240:243], a[8:11], v[48:51]
ds_read_b64_tr_b16 a[232:233], v186 offset:16960
ds_read_b64_tr_b16 a[234:235], v186 offset:17472
v_mfma_f32_16x16x32_bf16 v[112:115], a[240:243], a[64:67], v[112:115]
s_mov_b32 s18, 229376
s_mov_b32 s19, 0x20000
v_mfma_f32_16x16x32_bf16 v[52:55], a[244:247], a[8:11], v[52:55]
ds_read_b64_tr_b16 a[236:237], v186 offset:16992
buffer_load_dwordx4 v227, s[20:23], s98 offen lds
v_mfma_f32_16x16x32_bf16 v[116:119], a[244:247], a[64:67], v[116:119]
ds_read_b64_tr_b16 a[238:239], v186 offset:17504
s_add_u32 s98, s98, 128
s_cmp_ge_u32 s98, 896
s_cselect_b32 s98, 0, s98
v_mfma_f32_16x16x32_bf16 v[56:59], a[248:251], a[8:11], v[56:59]
ds_read_b64_tr_b16 a[240:241], v187 offset:16896
s_add_u32 m0, s46, 107712
v_mfma_f32_16x16x32_bf16 v[120:123], a[248:251], a[64:67], v[120:123]
ds_read_b64_tr_b16 a[242:243], v187 offset:17408
s_lshr_b32 s85, s83, 1
v_mfma_f32_16x16x32_bf16 v[60:63], a[252:255], a[8:11], v[60:63]
ds_read_b64_tr_b16 a[244:245], v187 offset:16928
buffer_load_dwordx4 v222, s[12:15], s84 offen lds
v_mfma_f32_16x16x32_bf16 v[124:127], a[252:255], a[64:67], v[124:127]
ds_read_b64_tr_b16 a[246:247], v187 offset:17440
s_add_u32 m0, s46, 108768
v_mfma_f32_16x16x32_bf16 v[0:3], a[192:195], a[12:15], v[0:3]
ds_read_b64_tr_b16 a[248:249], v187 offset:16960
ds_read_b64_tr_b16 a[250:251], v187 offset:17472
v_mfma_f32_16x16x32_bf16 v[64:67], a[192:195], a[68:71], v[64:67]
s_lshl_b32 s85, s85, 17
s_add_u32 s24, s62, s85
s_addc_u32 s25, s63, 0
v_mfma_f32_16x16x32_bf16 v[128:131], a[192:195], a[124:127], v[128:131]
buffer_load_dwordx4 v223, s[12:15], s84 offen lds
s_waitcnt lgkmcnt(5)
v_mfma_f32_16x16x32_bf16 v[4:7], a[196:199], a[12:15], v[4:7]
ds_read_b64_tr_b16 a[252:253], v187 offset:16992
s_add_u32 s84, s84, 524288
s_cmp_ge_u32 s84, 3670016
s_cselect_b32 s84, 0, s84
v_mfma_f32_16x16x32_bf16 v[68:71], a[196:199], a[68:71], v[68:71]
ds_read_b64_tr_b16 a[254:255], v187 offset:17504
s_mov_b32 s26, 131072
v_mfma_f32_16x16x32_bf16 v[132:135], a[196:199], a[124:127], v[132:135]
s_mov_b32 s27, 0x20000
s_mov_b32 s32, 0x3db8aa3b
v_mfma_f32_16x16x32_bf16 v[8:11], a[200:203], a[12:15], v[8:11]
buffer_atomic_or v238, v239, s[92:95], s97 offen sc1
s_mov_b32 s33, 0x41317218
v_mfma_f32_16x16x32_bf16 v[72:75], a[200:203], a[68:71], v[72:75]
s_mov_b32 s34, 0x42b17218
s_mul_i32 s85, s3, 5
v_mfma_f32_16x16x32_bf16 v[136:139], a[200:203], a[124:127], v[136:139]
s_sub_u32 s85, s85, 5
s_cmp_eq_u32 s3, 0
s_cselect_b32 s85, 0, s85
v_mfma_f32_16x16x32_bf16 v[12:15], a[204:207], a[12:15], v[12:15]
s_waitcnt vmcnt(25) lgkmcnt(0)
s_barrier
v_mfma_f32_16x16x32_bf16 v[76:79], a[204:207], a[68:71], v[76:79]
ds_read_b128 a[128:131], v234 offset:0
ds_read_b128 a[132:135], v234 offset:64
v_mfma_f32_16x16x32_bf16 v[140:143], a[204:207], a[124:127], v[140:143]
ds_read_b64_tr_b16 a[192:193], v180 offset:0
s_add_u32 m0, s46, 33792
v_mfma_f32_16x16x32_bf16 v[16:19], a[208:211], a[12:15], v[16:19]
ds_read_b64_tr_b16 a[194:195], v180 offset:512
buffer_load_dwordx4 v216, s[12:15], s84 offen lds
v_mfma_f32_16x16x32_bf16 v[80:83], a[208:211], a[68:71], v[80:83]
ds_read_b64_tr_b16 a[196:197], v180 offset:32
s_add_u32 m0, s46, 34848
v_mfma_f32_16x16x32_bf16 v[20:23], a[212:215], a[12:15], v[20:23]
ds_read_b64_tr_b16 a[198:199], v180 offset:544
v_add_u32 v184, 101376, v176
v_mfma_f32_16x16x32_bf16 v[84:87], a[212:215], a[68:71], v[84:87]
s_waitcnt vmcnt(9)
ds_read_b128 a[32:35], v237 offset:0
v_mfma_f32_16x16x32_bf16 v[24:27], a[216:219], a[12:15], v[24:27]
ds_read_b128 a[88:91], v237 offset:2048
ds_read_b128 a[36:39], v236 offset:0
v_mfma_f32_16x16x32_bf16 v[88:91], a[216:219], a[68:71], v[88:91]
ds_read_b128 a[92:95], v236 offset:2048
buffer_load_dwordx4 v217, s[12:15], s84 offen lds
v_mfma_f32_16x16x32_bf16 v[28:31], a[220:223], a[12:15], v[28:31]
ds_read_b64_tr_b16 a[200:201], v180 offset:64
s_add_u32 m0, s46, 35904
v_mfma_f32_16x16x32_bf16 v[92:95], a[220:223], a[68:71], v[92:95]
ds_read_b64_tr_b16 a[202:203], v180 offset:576
s_add_u32 s99, s99, 128
s_cmp_ge_u32 s99, 896
s_cselect_b32 s99, 0, s99
v_add_u32 v234, s99, v235
v_mfma_f32_16x16x32_bf16 v[32:35], a[224:227], a[12:15], v[32:35]
ds_read_b64_tr_b16 a[204:205], v180 offset:96
v_add_u32 v185, 101376, v177
v_mfma_f32_16x16x32_bf16 v[96:99], a[224:227], a[68:71], v[96:99]
ds_read_b64_tr_b16 a[206:207], v180 offset:608
buffer_load_dwordx4 v218, s[12:15], s84 offen lds
v_mfma_f32_16x16x32_bf16 v[36:39], a[228:231], a[12:15], v[36:39]
ds_read_b64_tr_b16 a[208:209], v181 offset:0
s_waitcnt lgkmcnt(5)
s_add_u32 m0, s47, 0
v_mfma_f32_16x16x32_bf16 v[100:103], a[228:231], a[68:71], v[100:103]
ds_read_b64_tr_b16 a[210:211], v181 offset:512
v_add_u32 v186, 101376, v178
v_mfma_f32_16x16x32_bf16 v[40:43], a[232:235], a[12:15], v[40:43]
ds_read_b64_tr_b16 a[212:213], v181 offset:32
v_add_u32 v187, 101376, v179
v_mfma_f32_16x16x32_bf16 v[104:107], a[232:235], a[68:71], v[104:107]
ds_read_b64_tr_b16 a[214:215], v181 offset:544
buffer_load_dwordx4 v224, s[20:23], s98 offen lds
v_mfma_f32_16x16x32_bf16 v[44:47], a[236:239], a[12:15], v[44:47]
ds_read_b64_tr_b16 a[216:217], v181 offset:64
s_add_u32 m0, s47, 1024
v_mfma_f32_16x16x32_bf16 v[108:111], a[236:239], a[68:71], v[108:111]
ds_read_b64_tr_b16 a[218:219], v181 offset:576
ds_read_b64_tr_b16 a[220:221], v181 offset:96
v_mfma_f32_16x16x32_bf16 v[48:51], a[240:243], a[12:15], v[48:51]
ds_read_b64_tr_b16 a[222:223], v181 offset:608
ds_read_b64_tr_b16 a[224:225], v182 offset:0
v_mfma_f32_16x16x32_bf16 v[112:115], a[240:243], a[68:71], v[112:115]
ds_read_b64_tr_b16 a[226:227], v182 offset:512
buffer_load_dwordx4 v225, s[20:23], s98 offen lds
v_mfma_f32_16x16x32_bf16 v[52:55], a[244:247], a[12:15], v[52:55]
ds_read_b64_tr_b16 a[228:229], v182 offset:32
s_add_u32 m0, s47, 2048
v_mfma_f32_16x16x32_bf16 v[116:119], a[244:247], a[68:71], v[116:119]
ds_read_b64_tr_b16 a[230:231], v182 offset:544
ds_read_b64_tr_b16 a[232:233], v182 offset:64
v_mfma_f32_16x16x32_bf16 v[56:59], a[248:251], a[12:15], v[56:59]
ds_read_b64_tr_b16 a[234:235], v182 offset:576
ds_read_b64_tr_b16 a[236:237], v182 offset:96
v_mfma_f32_16x16x32_bf16 v[120:123], a[248:251], a[68:71], v[120:123]
ds_read_b64_tr_b16 a[238:239], v182 offset:608
buffer_load_dwordx4 v226, s[20:23], s98 offen lds
v_mfma_f32_16x16x32_bf16 v[60:63], a[252:255], a[12:15], v[60:63]
s_waitcnt vmcnt(9)
ds_read_b128 a[40:43], v237 offset:16896
v_mfma_f32_16x16x32_bf16 v[124:127], a[252:255], a[68:71], v[124:127]
ds_read_b128 a[96:99], v237 offset:18944
ds_read_b128 a[44:47], v236 offset:16896
v_mfma_f32_16x16x32_bf16 v[0:3], a[192:195], a[16:19], v[0:3]
ds_read_b128 a[100:103], v236 offset:18944
s_add_u32 m0, s47, 3072
v_mfma_f32_16x16x32_bf16 v[64:67], a[192:195], a[72:75], v[64:67]
ds_read_b64_tr_b16 a[240:241], v183 offset:0
buffer_load_dwordx4 v227, s[20:23], s98 offen lds
v_mfma_f32_16x16x32_bf16 v[128:131], a[192:195], a[128:131], v[128:131]
ds_read_b64_tr_b16 a[242:243], v183 offset:512
s_add_u32 s98, s98, 128
s_cmp_ge_u32 s98, 896
s_cselect_b32 s98, 0, s98
v_mfma_f32_16x16x32_bf16 v[4:7], a[196:199], a[16:19], v[4:7]
ds_read_b64_tr_b16 a[244:245], v183 offset:32
s_add_u32 m0, s46, 36960
v_mfma_f32_16x16x32_bf16 v[68:71], a[196:199], a[72:75], v[68:71]
ds_read_b64_tr_b16 a[246:247], v183 offset:544
ds_read_b64_tr_b16 a[248:249], v183 offset:64
v_mfma_f32_16x16x32_bf16 v[132:135], a[196:199], a[128:131], v[132:135]
buffer_load_dwordx4 v219, s[12:15], s84 offen lds
s_waitcnt lgkmcnt(5)
v_mfma_f32_16x16x32_bf16 v[8:11], a[200:203], a[16:19], v[8:11]
ds_read_b64_tr_b16 a[250:251], v183 offset:576
s_add_u32 m0, s46, 38016
v_mfma_f32_16x16x32_bf16 v[72:75], a[200:203], a[72:75], v[72:75]
ds_read_b64_tr_b16 a[252:253], v183 offset:96
ds_read_b64_tr_b16 a[254:255], v183 offset:608
v_mfma_f32_16x16x32_bf16 v[136:139], a[200:203], a[128:131], v[136:139]
ds_read_b64_tr_b16 a[192:193], v180 offset:16896
ds_read_b64_tr_b16 a[194:195], v180 offset:17408
v_mfma_f32_16x16x32_bf16 v[12:15], a[204:207], a[16:19], v[12:15]
ds_read_b64_tr_b16 a[196:197], v180 offset:16928
buffer_load_dwordx4 v220, s[12:15], s84 offen lds
v_mfma_f32_16x16x32_bf16 v[76:79], a[204:207], a[72:75], v[76:79]
ds_read_b64_tr_b16 a[198:199], v180 offset:17440
s_add_u32 m0, s46, 39072
v_mfma_f32_16x16x32_bf16 v[140:143], a[204:207], a[128:131], v[140:143]
s_mul_i32 s39, s85, 1056
s_mul_i32 s43, s85, 896
v_mfma_f32_16x16x32_bf16 v[16:19], a[208:211], a[16:19], v[16:19]
ds_read_b64_tr_b16 a[200:201], v180 offset:16960
ds_read_b64_tr_b16 a[202:203], v180 offset:17472
v_mfma_f32_16x16x32_bf16 v[80:83], a[208:211], a[72:75], v[80:83]
buffer_load_dwordx4 v221, s[12:15], s84 offen lds
s_add_u32 m0, s46, 40128
v_mfma_f32_16x16x32_bf16 v[20:23], a[212:215], a[16:19], v[20:23]
ds_read_b64_tr_b16 a[204:205], v180 offset:16992
ds_read_b64_tr_b16 a[206:207], v180 offset:17504
v_mfma_f32_16x16x32_bf16 v[84:87], a[212:215], a[72:75], v[84:87]
s_mul_i32 s42, s3, 7168
s_mul_i32 s100, s82, 384
v_mfma_f32_16x16x32_bf16 v[24:27], a[216:219], a[16:19], v[24:27]
ds_read_b64_tr_b16 a[208:209], v181 offset:16896
ds_read_b64_tr_b16 a[210:211], v181 offset:17408
v_mfma_f32_16x16x32_bf16 v[88:91], a[216:219], a[72:75], v[88:91]
buffer_load_dwordx4 v222, s[12:15], s84 offen lds
s_add_u32 m0, s46, 41184
v_mfma_f32_16x16x32_bf16 v[28:31], a[220:223], a[16:19], v[28:31]
ds_read_b64_tr_b16 a[212:213], v181 offset:16928
ds_read_b64_tr_b16 a[214:215], v181 offset:17440
v_mfma_f32_16x16x32_bf16 v[92:95], a[220:223], a[72:75], v[92:95]
s_lshl_b32 s85, s85, 10
v_add_u32 v246, s85, v241
v_mfma_f32_16x16x32_bf16 v[32:35], a[224:227], a[16:19], v[32:35]
ds_read_b64_tr_b16 a[216:217], v181 offset:16960
ds_read_b64_tr_b16 a[218:219], v181 offset:17472
v_mfma_f32_16x16x32_bf16 v[96:99], a[224:227], a[72:75], v[96:99]
buffer_load_dwordx4 v223, s[12:15], s84 offen lds
s_add_u32 s84, s84, 524288
s_cmp_ge_u32 s84, 3670016
s_cselect_b32 s84, 0, s84
v_mfma_f32_16x16x32_bf16 v[36:39], a[228:231], a[16:19], v[36:39]
ds_read_b64_tr_b16 a[220:221], v181 offset:16992
ds_read_b64_tr_b16 a[222:223], v181 offset:17504
v_mfma_f32_16x16x32_bf16 v[100:103], a[228:231], a[72:75], v[100:103]
v_add_u32 v240, 135168, v241
v_lshrrev_b32 v241, 3, v255
v_mfma_f32_16x16x32_bf16 v[40:43], a[232:235], a[16:19], v[40:43]
ds_read_b64_tr_b16 a[224:225], v182 offset:16896
ds_read_b64_tr_b16 a[226:227], v182 offset:17408
v_mfma_f32_16x16x32_bf16 v[104:107], a[232:235], a[72:75], v[104:107]
v_mul_u32_u24 v244, 28672, v241
v_and_b32 v241, 7, v255
v_mfma_f32_16x16x32_bf16 v[44:47], a[236:239], a[16:19], v[44:47]
ds_read_b64_tr_b16 a[228:229], v182 offset:16928
ds_read_b64_tr_b16 a[230:231], v182 offset:17440
v_mfma_f32_16x16x32_bf16 v[108:111], a[236:239], a[72:75], v[108:111]
v_lshl_add_u32 v244, v241, 4, v244
s_waitcnt lgkmcnt(5)
v_mfma_f32_16x16x32_bf16 v[48:51], a[240:243], a[16:19], v[48:51]
ds_read_b64_tr_b16 a[232:233], v182 offset:16960
ds_read_b64_tr_b16 a[234:235], v182 offset:17472
v_mfma_f32_16x16x32_bf16 v[112:115], a[240:243], a[72:75], v[112:115]
v_mul_u32_u24 v251, 1056, v241
v_lshrrev_b32 v241, 4, v255
v_mfma_f32_16x16x32_bf16 v[52:55], a[244:247], a[16:19], v[52:55]
ds_read_b64_tr_b16 a[236:237], v182 offset:16992
ds_read_b64_tr_b16 a[238:239], v182 offset:17504
v_mfma_f32_16x16x32_bf16 v[116:119], a[244:247], a[72:75], v[116:119]
v_lshl_add_u32 v251, v241, 4, v251
v_bfe_u32 v241, v255, 3, 1
v_mfma_f32_16x16x32_bf16 v[56:59], a[248:251], a[16:19], v[56:59]
ds_read_b64_tr_b16 a[240:241], v183 offset:16896
ds_read_b64_tr_b16 a[242:243], v183 offset:17408
v_mfma_f32_16x16x32_bf16 v[120:123], a[248:251], a[72:75], v[120:123]
v_lshl_add_u32 v251, v241, 9, v251
v_bfe_u32 v241, v255, 2, 3
v_mfma_f32_16x16x32_bf16 v[60:63], a[252:255], a[16:19], v[60:63]
ds_read_b64_tr_b16 a[244:245], v183 offset:16928
ds_read_b64_tr_b16 a[246:247], v183 offset:17440
v_mfma_f32_16x16x32_bf16 v[124:127], a[252:255], a[72:75], v[124:127]
v_mul_u32_u24 v250, 1056, v241
v_lshrrev_b32 v241, 5, v255
v_mfma_f32_16x16x32_bf16 v[0:3], a[192:195], a[20:23], v[0:3]
ds_read_b64_tr_b16 a[248:249], v183 offset:16960
ds_read_b64_tr_b16 a[250:251], v183 offset:17472
v_mfma_f32_16x16x32_bf16 v[64:67], a[192:195], a[76:79], v[64:67]
v_lshl_add_u32 v250, v241, 9, v250
v_and_b32 v241, 3, v255
v_mfma_f32_16x16x32_bf16 v[128:131], a[192:195], a[132:135], v[128:131]
v_lshl_add_u32 v250, v241, 3, v250
v_mov_b32 v249, v251
v_mfma_f32_16x16x32_bf16 v[4:7], a[196:199], a[20:23], v[4:7]
ds_read_b64_tr_b16 a[252:253], v183 offset:16992
ds_read_b64_tr_b16 a[254:255], v183 offset:17504
v_mfma_f32_16x16x32_bf16 v[68:71], a[196:199], a[76:79], v[68:71]
v_mov_b32 v248, v250
s_mov_b32 s37, 101376
v_mfma_f32_16x16x32_bf16 v[132:135], a[196:199], a[132:135], v[132:135]
s_waitcnt vmcnt(5)
ds_read_b128 a[168:171], v237 offset:0
v_mfma_f32_16x16x32_bf16 v[8:11], a[200:203], a[20:23], v[8:11]
ds_read_b128 a[176:179], v237 offset:2048
ds_read_b128 a[172:175], v236 offset:0
v_mfma_f32_16x16x32_bf16 v[72:75], a[200:203], a[76:79], v[72:75]
ds_read_b128 a[180:183], v236 offset:2048
s_mov_b32 s38, 33792
v_mfma_f32_16x16x32_bf16 v[136:139], a[200:203], a[132:135], v[136:139]
s_waitcnt vmcnt(13) lgkmcnt(0)
s_barrier
v_mfma_f32_16x16x32_bf16 v[12:15], a[204:207], a[20:23], v[12:15]
ds_read_b128 a[136:139], v234 offset:0
ds_read_b128 a[140:143], v234 offset:64
v_mfma_f32_16x16x32_bf16 v[76:79], a[204:207], a[76:79], v[76:79]
ds_read_b64_tr_b16 a[192:193], v184 offset:0
s_add_u32 m0, s46, 67584
v_mfma_f32_16x16x32_bf16 v[140:143], a[204:207], a[132:135], v[140:143]
ds_read_b64_tr_b16 a[194:195], v184 offset:512
buffer_load_dwordx4 v216, s[12:15], s84 offen lds
v_mfma_f32_16x16x32_bf16 v[16:19], a[208:211], a[20:23], v[16:19]
ds_read_b64_tr_b16 a[196:197], v184 offset:32
s_add_u32 m0, s46, 68640
v_mfma_f32_16x16x32_bf16 v[80:83], a[208:211], a[76:79], v[80:83]
ds_read_b64_tr_b16 a[198:199], v184 offset:544
v_add_u32 v180, 33792, v176
v_mfma_f32_16x16x32_bf16 v[20:23], a[212:215], a[20:23], v[20:23]
ds_read_b64_tr_b16 a[200:201], v184 offset:64
v_add_u32 v181, 33792, v177
v_mfma_f32_16x16x32_bf16 v[84:87], a[212:215], a[76:79], v[84:87]
ds_read_b64_tr_b16 a[202:203], v184 offset:576
buffer_load_dwordx4 v217, s[12:15], s84 offen lds
v_mfma_f32_16x16x32_bf16 v[24:27], a[216:219], a[20:23], v[24:27]
ds_read_b64_tr_b16 a[204:205], v184 offset:96
s_add_u32 m0, s46, 69696
v_mfma_f32_16x16x32_bf16 v[88:91], a[216:219], a[76:79], v[88:91]
ds_read_b64_tr_b16 a[206:207], v184 offset:608
s_add_u32 s99, s99, 128
s_cmp_ge_u32 s99, 896
s_cselect_b32 s99, 0, s99
v_add_u32 v234, s99, v235
v_mfma_f32_16x16x32_bf16 v[28:31], a[220:223], a[20:23], v[28:31]
ds_read_b64_tr_b16 a[208:209], v185 offset:0
v_add_u32 v182, 33792, v178
v_mfma_f32_16x16x32_bf16 v[92:95], a[220:223], a[76:79], v[92:95]
ds_read_b64_tr_b16 a[210:211], v185 offset:512
buffer_load_dwordx4 v218, s[12:15], s84 offen lds
v_mfma_f32_16x16x32_bf16 v[32:35], a[224:227], a[20:23], v[32:35]
ds_read_b64_tr_b16 a[212:213], v185 offset:32
s_add_u32 m0, s46, 70752
v_mfma_f32_16x16x32_bf16 v[96:99], a[224:227], a[76:79], v[96:99]
ds_read_b64_tr_b16 a[214:215], v185 offset:544
v_add_u32 v183, 33792, v179
v_mfma_f32_16x16x32_bf16 v[36:39], a[228:231], a[20:23], v[36:39]
ds_read_b64_tr_b16 a[216:217], v185 offset:64
ds_read_b64_tr_b16 a[218:219], v185 offset:576
v_mfma_f32_16x16x32_bf16 v[100:103], a[228:231], a[76:79], v[100:103]
ds_read_b64_tr_b16 a[220:221], v185 offset:96
buffer_load_dwordx4 v219, s[12:15], s84 offen lds
v_mfma_f32_16x16x32_bf16 v[40:43], a[232:235], a[20:23], v[40:43]
ds_read_b64_tr_b16 a[222:223], v185 offset:608
s_add_u32 m0, s46, 71808
v_mfma_f32_16x16x32_bf16 v[104:107], a[232:235], a[76:79], v[104:107]
ds_read_b64_tr_b16 a[224:225], v186 offset:0
ds_read_b64_tr_b16 a[226:227], v186 offset:512
v_mfma_f32_16x16x32_bf16 v[44:47], a[236:239], a[20:23], v[44:47]
ds_read_b64_tr_b16 a[228:229], v186 offset:32
ds_read_b64_tr_b16 a[230:231], v186 offset:544
v_mfma_f32_16x16x32_bf16 v[108:111], a[236:239], a[76:79], v[108:111]
buffer_load_dwordx4 v220, s[12:15], s84 offen lds
s_add_u32 m0, s46, 72864
v_mfma_f32_16x16x32_bf16 v[48:51], a[240:243], a[20:23], v[48:51]
ds_read_b64_tr_b16 a[232:233], v186 offset:64
ds_read_b64_tr_b16 a[234:235], v186 offset:576
v_mfma_f32_16x16x32_bf16 v[112:115], a[240:243], a[76:79], v[112:115]
s_lshl_b32 s85, s3, 11
v_add_u32 v241, s85, v240
v_mfma_f32_16x16x32_bf16 v[52:55], a[244:247], a[20:23], v[52:55]
ds_read_b64_tr_b16 a[236:237], v186 offset:96
ds_read_b64_tr_b16 a[238:239], v186 offset:608
v_mfma_f32_16x16x32_bf16 v[116:119], a[244:247], a[76:79], v[116:119]
buffer_load_dwordx4 v221, s[12:15], s84 offen lds
s_add_u32 m0, s46, 73920
v_mfma_f32_16x16x32_bf16 v[56:59], a[248:251], a[20:23], v[56:59]
ds_read_b64_tr_b16 a[240:241], v187 offset:0
ds_read_b64_tr_b16 a[242:243], v187 offset:512
v_mfma_f32_16x16x32_bf16 v[120:123], a[248:251], a[76:79], v[120:123]
v_mfma_f32_16x16x32_bf16 v[60:63], a[252:255], a[20:23], v[60:63]
ds_read_b64_tr_b16 a[244:245], v187 offset:32
ds_read_b64_tr_b16 a[246:247], v187 offset:544
v_mfma_f32_16x16x32_bf16 v[124:127], a[252:255], a[76:79], v[124:127]
buffer_load_dwordx4 v222, s[12:15], s84 offen lds
s_waitcnt lgkmcnt(5)
v_mfma_f32_16x16x32_bf16 v[0:3], a[192:195], a[24:27], v[0:3]
ds_read_b64_tr_b16 a[248:249], v187 offset:64
s_add_u32 m0, s46, 74976
v_mfma_f32_16x16x32_bf16 v[64:67], a[192:195], a[80:83], v[64:67]
ds_read_b64_tr_b16 a[250:251], v187 offset:576
v_mfma_f32_16x16x32_bf16 v[128:131], a[192:195], a[136:139], v[128:131]
v_mfma_f32_16x16x32_bf16 v[4:7], a[196:199], a[24:27], v[4:7]
ds_read_b64_tr_b16 a[252:253], v187 offset:96
buffer_load_dwordx4 v223, s[12:15], s84 offen lds
v_mfma_f32_16x16x32_bf16 v[68:71], a[196:199], a[80:83], v[68:71]
ds_read_b64_tr_b16 a[254:255], v187 offset:608
s_add_u32 s84, s84, 524288
s_cmp_ge_u32 s84, 3670016
s_cselect_b32 s84, 0, s84
v_mfma_f32_16x16x32_bf16 v[132:135], a[196:199], a[136:139], v[132:135]
s_add_u32 s40, s101, 0
s_and_b32 s40, s40, 0x7c000
v_mfma_f32_16x16x32_bf16 v[8:11], a[200:203], a[24:27], v[8:11]
ds_read_b64_tr_b16 a[192:193], v184 offset:16896
s_add_u32 m0, s47, 0
v_mfma_f32_16x16x32_bf16 v[72:75], a[200:203], a[80:83], v[72:75]
ds_read_b64_tr_b16 a[194:195], v184 offset:17408
buffer_load_dwordx4 v247, s[4:7], s40 offen offset:0 nt lds
v_mfma_f32_16x16x32_bf16 v[136:139], a[200:203], a[136:139], v[136:139]
s_add_u32 m0, s47, 32
v_mfma_f32_16x16x32_bf16 v[12:15], a[204:207], a[24:27], v[12:15]
ds_read_b64_tr_b16 a[196:197], v184 offset:16928
ds_read_b64_tr_b16 a[198:199], v184 offset:17440
v_mfma_f32_16x16x32_bf16 v[76:79], a[204:207], a[80:83], v[76:79]
v_mfma_f32_16x16x32_bf16 v[140:143], a[204:207], a[136:139], v[140:143]
buffer_load_dwordx4 v247, s[4:7], s40 offen offset:1024 nt lds
s_add_u32 m0, s47, 64
v_mfma_f32_16x16x32_bf16 v[16:19], a[208:211], a[24:27], v[16:19]
ds_read_b64_tr_b16 a[200:201], v184 offset:16960
ds_read_b64_tr_b16 a[202:203], v184 offset:17472
v_mfma_f32_16x16x32_bf16 v[80:83], a[208:211], a[80:83], v[80:83]
v_mfma_f32_16x16x32_bf16 v[20:23], a[212:215], a[24:27], v[20:23]
ds_read_b64_tr_b16 a[204:205], v184 offset:16992
ds_read_b64_tr_b16 a[206:207], v184 offset:17504
v_mfma_f32_16x16x32_bf16 v[84:87], a[212:215], a[80:83], v[84:87]
buffer_load_dwordx4 v247, s[4:7], s40 offen offset:2048 nt lds
s_add_u32 m0, s47, 96
v_mfma_f32_16x16x32_bf16 v[24:27], a[216:219], a[24:27], v[24:27]
ds_read_b64_tr_b16 a[208:209], v185 offset:16896
ds_read_b64_tr_b16 a[210:211], v185 offset:17408
v_mfma_f32_16x16x32_bf16 v[88:91], a[216:219], a[80:83], v[88:91]
v_mfma_f32_16x16x32_bf16 v[28:31], a[220:223], a[24:27], v[28:31]
ds_read_b64_tr_b16 a[212:213], v185 offset:16928
ds_read_b64_tr_b16 a[214:215], v185 offset:17440
v_mfma_f32_16x16x32_bf16 v[92:95], a[220:223], a[80:83], v[92:95]
buffer_load_dwordx4 v247, s[4:7], s40 offen offset:3072 nt lds
s_add_u32 m0, s47, 16896
v_mfma_f32_16x16x32_bf16 v[32:35], a[224:227], a[24:27], v[32:35]
ds_read_b64_tr_b16 a[216:217], v185 offset:16960
ds_read_b64_tr_b16 a[218:219], v185 offset:17472
v_mfma_f32_16x16x32_bf16 v[96:99], a[224:227], a[80:83], v[96:99]
v_mfma_f32_16x16x32_bf16 v[36:39], a[228:231], a[24:27], v[36:39]
ds_read_b64_tr_b16 a[220:221], v185 offset:16992
ds_read_b64_tr_b16 a[222:223], v185 offset:17504
v_mfma_f32_16x16x32_bf16 v[100:103], a[228:231], a[80:83], v[100:103]
buffer_load_dwordx4 v247, s[8:11], s40 offen offset:0 nt lds
s_add_u32 m0, s47, 16928
v_mfma_f32_16x16x32_bf16 v[40:43], a[232:235], a[24:27], v[40:43]
ds_read_b64_tr_b16 a[224:225], v186 offset:16896
ds_read_b64_tr_b16 a[226:227], v186 offset:17408
v_mfma_f32_16x16x32_bf16 v[104:107], a[232:235], a[80:83], v[104:107]
s_waitcnt lgkmcnt(5)
v_mfma_f32_16x16x32_bf16 v[44:47], a[236:239], a[24:27], v[44:47]
ds_read_b64_tr_b16 a[228:229], v186 offset:16928
ds_read_b64_tr_b16 a[230:231], v186 offset:17440
v_mfma_f32_16x16x32_bf16 v[108:111], a[236:239], a[80:83], v[108:111]
buffer_load_dwordx4 v247, s[8:11], s40 offen offset:1024 nt lds
s_add_u32 m0, s47, 16960
v_mfma_f32_16x16x32_bf16 v[48:51], a[240:243], a[24:27], v[48:51]
ds_read_b64_tr_b16 a[232:233], v186 offset:16960
ds_read_b64_tr_b16 a[234:235], v186 offset:17472
v_mfma_f32_16x16x32_bf16 v[112:115], a[240:243], a[80:83], v[112:115]
v_mfma_f32_16x16x32_bf16 v[52:55], a[244:247], a[24:27], v[52:55]
ds_read_b64_tr_b16 a[236:237], v186 offset:16992
ds_read_b64_tr_b16 a[238:239], v186 offset:17504
v_mfma_f32_16x16x32_bf16 v[116:119], a[244:247], a[80:83], v[116:119]
buffer_load_dwordx4 v247, s[8:11], s40 offen offset:2048 nt lds
s_add_u32 m0, s47, 16992
v_mfma_f32_16x16x32_bf16 v[56:59], a[248:251], a[24:27], v[56:59]
ds_read_b64_tr_b16 a[240:241], v187 offset:16896
ds_read_b64_tr_b16 a[242:243], v187 offset:17408
v_mfma_f32_16x16x32_bf16 v[120:123], a[248:251], a[80:83], v[120:123]
v_mfma_f32_16x16x32_bf16 v[60:63], a[252:255], a[24:27], v[60:63]
ds_read_b64_tr_b16 a[244:245], v187 offset:16928
ds_read_b64_tr_b16 a[246:247], v187 offset:17440
v_mfma_f32_16x16x32_bf16 v[124:127], a[252:255], a[80:83], v[124:127]
buffer_load_dwordx4 v247, s[8:11], s40 offen offset:3072 nt lds
v_mfma_f32_16x16x32_bf16 v[0:3], a[192:195], a[28:31], v[0:3]
ds_read_b64_tr_b16 a[248:249], v187 offset:16960
ds_read_b64_tr_b16 a[250:251], v187 offset:17472
v_mfma_f32_16x16x32_bf16 v[64:67], a[192:195], a[84:87], v[64:67]
v_mfma_f32_16x16x32_bf16 v[128:131], a[192:195], a[140:143], v[128:131]
v_mfma_f32_16x16x32_bf16 v[4:7], a[196:199], a[28:31], v[4:7]
ds_read_b64_tr_b16 a[252:253], v187 offset:16992
ds_read_b64_tr_b16 a[254:255], v187 offset:17504
v_mfma_f32_16x16x32_bf16 v[68:71], a[196:199], a[84:87], v[68:71]
v_mfma_f32_16x16x32_bf16 v[132:135], a[196:199], a[140:143], v[132:135]
v_mfma_f32_16x16x32_bf16 v[8:11], a[200:203], a[28:31], v[8:11]
v_mfma_f32_16x16x32_bf16 v[72:75], a[200:203], a[84:87], v[72:75]
v_mfma_f32_16x16x32_bf16 v[136:139], a[200:203], a[140:143], v[136:139]
s_waitcnt vmcnt(16) lgkmcnt(0)
s_barrier
v_mfma_f32_16x16x32_bf16 v[12:15], a[204:207], a[28:31], v[12:15]
ds_read_b128 a[144:147], v234 offset:0
ds_read_b128 a[148:151], v234 offset:64
v_mfma_f32_16x16x32_bf16 v[76:79], a[204:207], a[84:87], v[76:79]
ds_read_b64_tr_b16 a[192:193], v180 offset:0
s_add_u32 m0, s46, 101376
v_mfma_f32_16x16x32_bf16 v[140:143], a[204:207], a[140:143], v[140:143]
ds_read_b64_tr_b16 a[194:195], v180 offset:512
buffer_load_dwordx4 v216, s[12:15], s84 offen lds
v_mfma_f32_16x16x32_bf16 v[16:19], a[208:211], a[28:31], v[16:19]
ds_read_b64_tr_b16 a[196:197], v180 offset:32
s_add_u32 m0, s46, 102432
v_mfma_f32_16x16x32_bf16 v[80:83], a[208:211], a[84:87], v[80:83]
ds_read_b64_tr_b16 a[198:199], v180 offset:544
v_add_u32 v184, 67584, v176
v_mfma_f32_16x16x32_bf16 v[20:23], a[212:215], a[28:31], v[20:23]
ds_read_b64_tr_b16 a[200:201], v180 offset:64
v_add_u32 v185, 67584, v177
v_mfma_f32_16x16x32_bf16 v[84:87], a[212:215], a[84:87], v[84:87]
ds_read_b64_tr_b16 a[202:203], v180 offset:576
buffer_load_dwordx4 v217, s[12:15], s84 offen lds
v_mfma_f32_16x16x32_bf16 v[24:27], a[216:219], a[28:31], v[24:27]
ds_read_b64_tr_b16 a[204:205], v180 offset:96
s_add_u32 m0, s46, 103488
v_mfma_f32_16x16x32_bf16 v[88:91], a[216:219], a[84:87], v[88:91]
ds_read_b64_tr_b16 a[206:207], v180 offset:608
s_add_u32 s99, s99, 128
s_cmp_ge_u32 s99, 896
s_cselect_b32 s99, 0, s99
v_add_u32 v234, s99, v235
v_mfma_f32_16x16x32_bf16 v[28:31], a[220:223], a[28:31], v[28:31]
ds_read_b64_tr_b16 a[208:209], v181 offset:0
v_add_u32 v186, 67584, v178
v_mfma_f32_16x16x32_bf16 v[92:95], a[220:223], a[84:87], v[92:95]
ds_read_b64_tr_b16 a[210:211], v181 offset:512
buffer_load_dwordx4 v218, s[12:15], s84 offen lds
v_mfma_f32_16x16x32_bf16 v[32:35], a[224:227], a[28:31], v[32:35]
ds_read_b64_tr_b16 a[212:213], v181 offset:32
s_add_u32 m0, s46, 104544
v_mfma_f32_16x16x32_bf16 v[96:99], a[224:227], a[84:87], v[96:99]
ds_read_b64_tr_b16 a[214:215], v181 offset:544
v_add_u32 v187, 67584, v179
v_mfma_f32_16x16x32_bf16 v[36:39], a[228:231], a[28:31], v[36:39]
ds_read_b64_tr_b16 a[216:217], v181 offset:64
ds_read_b64_tr_b16 a[218:219], v181 offset:576
v_mfma_f32_16x16x32_bf16 v[100:103], a[228:231], a[84:87], v[100:103]
ds_read_b64_tr_b16 a[220:221], v181 offset:96
buffer_load_dwordx4 v219, s[12:15], s84 offen lds
v_mfma_f32_16x16x32_bf16 v[40:43], a[232:235], a[28:31], v[40:43]
ds_read_b64_tr_b16 a[222:223], v181 offset:608
s_add_u32 m0, s46, 105600
v_mfma_f32_16x16x32_bf16 v[104:107], a[232:235], a[84:87], v[104:107]
ds_read_b64_tr_b16 a[224:225], v182 offset:0
ds_read_b64_tr_b16 a[226:227], v182 offset:512
v_mfma_f32_16x16x32_bf16 v[44:47], a[236:239], a[28:31], v[44:47]
ds_read_b64_tr_b16 a[228:229], v182 offset:32
ds_read_b64_tr_b16 a[230:231], v182 offset:544
v_mfma_f32_16x16x32_bf16 v[108:111], a[236:239], a[84:87], v[108:111]
buffer_load_dwordx4 v220, s[12:15], s84 offen lds
s_add_u32 m0, s46, 106656
v_mfma_f32_16x16x32_bf16 v[48:51], a[240:243], a[28:31], v[48:51]
ds_read_b64_tr_b16 a[232:233], v182 offset:64
ds_read_b64_tr_b16 a[234:235], v182 offset:576
v_mfma_f32_16x16x32_bf16 v[112:115], a[240:243], a[84:87], v[112:115]
v_mfma_f32_16x16x32_bf16 v[52:55], a[244:247], a[28:31], v[52:55]
ds_read_b64_tr_b16 a[236:237], v182 offset:96
ds_read_b64_tr_b16 a[238:239], v182 offset:608
v_mfma_f32_16x16x32_bf16 v[116:119], a[244:247], a[84:87], v[116:119]
buffer_load_dwordx4 v221, s[12:15], s84 offen lds
s_add_u32 m0, s46, 107712
v_mfma_f32_16x16x32_bf16 v[56:59], a[248:251], a[28:31], v[56:59]
ds_read_b64_tr_b16 a[240:241], v183 offset:0
ds_read_b64_tr_b16 a[242:243], v183 offset:512
v_mfma_f32_16x16x32_bf16 v[120:123], a[248:251], a[84:87], v[120:123]
v_mfma_f32_16x16x32_bf16 v[60:63], a[252:255], a[28:31], v[60:63]
ds_read_b64_tr_b16 a[244:245], v183 offset:32
ds_read_b64_tr_b16 a[246:247], v183 offset:544
v_mfma_f32_16x16x32_bf16 v[124:127], a[252:255], a[84:87], v[124:127]
buffer_load_dwordx4 v222, s[12:15], s84 offen lds
s_waitcnt lgkmcnt(5)
v_mfma_f32_16x16x32_bf16 v[0:3], a[192:195], a[32:35], v[0:3]
ds_read_b64_tr_b16 a[248:249], v183 offset:64
s_add_u32 m0, s46, 108768
v_mfma_f32_16x16x32_bf16 v[64:67], a[192:195], a[88:91], v[64:67]
ds_read_b64_tr_b16 a[250:251], v183 offset:576
v_mfma_f32_16x16x32_bf16 v[128:131], a[192:195], a[144:147], v[128:131]
v_mfma_f32_16x16x32_bf16 v[4:7], a[196:199], a[32:35], v[4:7]
ds_read_b64_tr_b16 a[252:253], v183 offset:96
buffer_load_dwordx4 v223, s[12:15], s84 offen lds
v_mfma_f32_16x16x32_bf16 v[68:71], a[196:199], a[88:91], v[68:71]
ds_read_b64_tr_b16 a[254:255], v183 offset:608
s_add_u32 s84, s84, 524288
s_cmp_ge_u32 s84, 3670016
s_cselect_b32 s84, 0, s84
v_mfma_f32_16x16x32_bf16 v[132:135], a[196:199], a[144:147], v[132:135]
v_mfma_f32_16x16x32_bf16 v[8:11], a[200:203], a[32:35], v[8:11]
ds_read_b64_tr_b16 a[192:193], v180 offset:16896
ds_read_b64_tr_b16 a[194:195], v180 offset:17408
v_mfma_f32_16x16x32_bf16 v[72:75], a[200:203], a[88:91], v[72:75]
v_mfma_f32_16x16x32_bf16 v[136:139], a[200:203], a[144:147], v[136:139]
v_mfma_f32_16x16x32_bf16 v[12:15], a[204:207], a[32:35], v[12:15]
ds_read_b64_tr_b16 a[196:197], v180 offset:16928
ds_read_b64_tr_b16 a[198:199], v180 offset:17440
v_mfma_f32_16x16x32_bf16 v[76:79], a[204:207], a[88:91], v[76:79]
v_mfma_f32_16x16x32_bf16 v[140:143], a[204:207], a[144:147], v[140:143]
v_mfma_f32_16x16x32_bf16 v[16:19], a[208:211], a[32:35], v[16:19]
ds_read_b64_tr_b16 a[200:201], v180 offset:16960
ds_read_b64_tr_b16 a[202:203], v180 offset:17472
v_mfma_f32_16x16x32_bf16 v[80:83], a[208:211], a[88:91], v[80:83]
v_mfma_f32_16x16x32_bf16 v[20:23], a[212:215], a[32:35], v[20:23]
ds_read_b64_tr_b16 a[204:205], v180 offset:16992
ds_read_b64_tr_b16 a[206:207], v180 offset:17504
v_mfma_f32_16x16x32_bf16 v[84:87], a[212:215], a[88:91], v[84:87]
v_mfma_f32_16x16x32_bf16 v[24:27], a[216:219], a[32:35], v[24:27]
ds_read_b64_tr_b16 a[208:209], v181 offset:16896
ds_read_b64_tr_b16 a[210:211], v181 offset:17408
v_mfma_f32_16x16x32_bf16 v[88:91], a[216:219], a[88:91], v[88:91]
v_mfma_f32_16x16x32_bf16 v[28:31], a[220:223], a[32:35], v[28:31]
ds_read_b64_tr_b16 a[212:213], v181 offset:16928
ds_read_b64_tr_b16 a[214:215], v181 offset:17440
v_mfma_f32_16x16x32_bf16 v[92:95], a[220:223], a[88:91], v[92:95]
v_mfma_f32_16x16x32_bf16 v[32:35], a[224:227], a[32:35], v[32:35]
ds_read_b64_tr_b16 a[216:217], v181 offset:16960
ds_read_b64_tr_b16 a[218:219], v181 offset:17472
v_mfma_f32_16x16x32_bf16 v[96:99], a[224:227], a[88:91], v[96:99]
v_mfma_f32_16x16x32_bf16 v[36:39], a[228:231], a[32:35], v[36:39]
ds_read_b64_tr_b16 a[220:221], v181 offset:16992
ds_read_b64_tr_b16 a[222:223], v181 offset:17504
v_mfma_f32_16x16x32_bf16 v[100:103], a[228:231], a[88:91], v[100:103]
v_mfma_f32_16x16x32_bf16 v[40:43], a[232:235], a[32:35], v[40:43]
ds_read_b64_tr_b16 a[224:225], v182 offset:16896
ds_read_b64_tr_b16 a[226:227], v182 offset:17408
v_mfma_f32_16x16x32_bf16 v[104:107], a[232:235], a[88:91], v[104:107]
s_waitcnt lgkmcnt(5)
v_mfma_f32_16x16x32_bf16 v[44:47], a[236:239], a[32:35], v[44:47]
ds_read_b64_tr_b16 a[228:229], v182 offset:16928
ds_read_b64_tr_b16 a[230:231], v182 offset:17440
v_mfma_f32_16x16x32_bf16 v[108:111], a[236:239], a[88:91], v[108:111]
v_mfma_f32_16x16x32_bf16 v[48:51], a[240:243], a[32:35], v[48:51]
ds_read_b64_tr_b16 a[232:233], v182 offset:16960
ds_read_b64_tr_b16 a[234:235], v182 offset:17472
v_mfma_f32_16x16x32_bf16 v[112:115], a[240:243], a[88:91], v[112:115]
v_mfma_f32_16x16x32_bf16 v[52:55], a[244:247], a[32:35], v[52:55]
ds_read_b64_tr_b16 a[236:237], v182 offset:16992
ds_read_b64_tr_b16 a[238:239], v182 offset:17504
v_mfma_f32_16x16x32_bf16 v[116:119], a[244:247], a[88:91], v[116:119]
v_mfma_f32_16x16x32_bf16 v[56:59], a[248:251], a[32:35], v[56:59]
ds_read_b64_tr_b16 a[240:241], v183 offset:16896
ds_read_b64_tr_b16 a[242:243], v183 offset:17408
v_mfma_f32_16x16x32_bf16 v[120:123], a[248:251], a[88:91], v[120:123]
v_mfma_f32_16x16x32_bf16 v[60:63], a[252:255], a[32:35], v[60:63]
ds_read_b64_tr_b16 a[244:245], v183 offset:16928
ds_read_b64_tr_b16 a[246:247], v183 offset:17440
v_mfma_f32_16x16x32_bf16 v[124:127], a[252:255], a[88:91], v[124:127]
v_mfma_f32_16x16x32_bf16 v[0:3], a[192:195], a[36:39], v[0:3]
ds_read_b64_tr_b16 a[248:249], v183 offset:16960
ds_read_b64_tr_b16 a[250:251], v183 offset:17472
v_mfma_f32_16x16x32_bf16 v[64:67], a[192:195], a[92:95], v[64:67]
v_mfma_f32_16x16x32_bf16 v[128:131], a[192:195], a[148:151], v[128:131]
v_mfma_f32_16x16x32_bf16 v[4:7], a[196:199], a[36:39], v[4:7]
ds_read_b64_tr_b16 a[252:253], v183 offset:16992
ds_read_b64_tr_b16 a[254:255], v183 offset:17504
v_mfma_f32_16x16x32_bf16 v[68:71], a[196:199], a[92:95], v[68:71]
v_mfma_f32_16x16x32_bf16 v[132:135], a[196:199], a[148:151], v[132:135]
v_mfma_f32_16x16x32_bf16 v[8:11], a[200:203], a[36:39], v[8:11]
v_mfma_f32_16x16x32_bf16 v[72:75], a[200:203], a[92:95], v[72:75]
v_mfma_f32_16x16x32_bf16 v[136:139], a[200:203], a[148:151], v[136:139]
s_waitcnt vmcnt(16) lgkmcnt(0)
s_barrier
v_mfma_f32_16x16x32_bf16 v[12:15], a[204:207], a[36:39], v[12:15]
ds_read_b128 a[152:155], v234 offset:0
ds_read_b128 a[156:159], v234 offset:64
v_mfma_f32_16x16x32_bf16 v[76:79], a[204:207], a[92:95], v[76:79]
ds_read_b64_tr_b16 a[192:193], v184 offset:0
v_add_u32 v180, 101376, v176
v_mfma_f32_16x16x32_bf16 v[140:143], a[204:207], a[148:151], v[140:143]
ds_read_b64_tr_b16 a[194:195], v184 offset:512
v_add_u32 v181, 101376, v177
v_mfma_f32_16x16x32_bf16 v[16:19], a[208:211], a[36:39], v[16:19]
ds_read_b64_tr_b16 a[196:197], v184 offset:32
v_add_u32 v182, 101376, v178
v_mfma_f32_16x16x32_bf16 v[80:83], a[208:211], a[92:95], v[80:83]
ds_read_b64_tr_b16 a[198:199], v184 offset:544
v_add_u32 v183, 101376, v179
v_mfma_f32_16x16x32_bf16 v[20:23], a[212:215], a[36:39], v[20:23]
ds_read_b64_tr_b16 a[200:201], v184 offset:64
ds_read_b64_tr_b16 a[202:203], v184 offset:576
v_mfma_f32_16x16x32_bf16 v[84:87], a[212:215], a[92:95], v[84:87]
ds_read_b64_tr_b16 a[204:205], v184 offset:96
ds_read_b64_tr_b16 a[206:207], v184 offset:608
v_mfma_f32_16x16x32_bf16 v[24:27], a[216:219], a[36:39], v[24:27]
ds_read_b64_tr_b16 a[208:209], v185 offset:0
s_add_u32 s99, s99, 128
s_cmp_ge_u32 s99, 896
s_cselect_b32 s99, 0, s99
v_add_u32 v234, s99, v235
v_mfma_f32_16x16x32_bf16 v[88:91], a[216:219], a[92:95], v[88:91]
ds_read_b64_tr_b16 a[210:211], v185 offset:512
s_add_u32 s40, s101, 16384
v_mfma_f32_16x16x32_bf16 v[28:31], a[220:223], a[36:39], v[28:31]
ds_read_b64_tr_b16 a[212:213], v185 offset:32
s_and_b32 s40, s40, 0x7c000
v_mfma_f32_16x16x32_bf16 v[92:95], a[220:223], a[92:95], v[92:95]
ds_read_b64_tr_b16 a[214:215], v185 offset:544
s_add_u32 m0, s47, 33792
v_mfma_f32_16x16x32_bf16 v[32:35], a[224:227], a[36:39], v[32:35]
ds_read_b64_tr_b16 a[216:217], v185 offset:64
buffer_load_dwordx4 v247, s[4:7], s40 offen offset:0 nt lds
v_mfma_f32_16x16x32_bf16 v[96:99], a[224:227], a[92:95], v[96:99]
ds_read_b64_tr_b16 a[218:219], v185 offset:576
s_add_u32 m0, s47, 33824
v_mfma_f32_16x16x32_bf16 v[36:39], a[228:231], a[36:39], v[36:39]
ds_read_b64_tr_b16 a[220:221], v185 offset:96
ds_read_b64_tr_b16 a[222:223], v185 offset:608
v_mfma_f32_16x16x32_bf16 v[100:103], a[228:231], a[92:95], v[100:103]
v_mfma_f32_16x16x32_bf16 v[40:43], a[232:235], a[36:39], v[40:43]
ds_read_b64_tr_b16 a[224:225], v186 offset:0
buffer_load_dwordx4 v247, s[4:7], s40 offen offset:1024 nt lds
v_mfma_f32_16x16x32_bf16 v[104:107], a[232:235], a[92:95], v[104:107]
ds_read_b64_tr_b16 a[226:227], v186 offset:512
s_add_u32 m0, s47, 33856
v_mfma_f32_16x16x32_bf16 v[44:47], a[236:239], a[36:39], v[44:47]
ds_read_b64_tr_b16 a[228:229], v186 offset:32
ds_read_b64_tr_b16 a[230:231], v186 offset:544
v_mfma_f32_16x16x32_bf16 v[108:111], a[236:239], a[92:95], v[108:111]
v_mfma_f32_16x16x32_bf16 v[48:51], a[240:243], a[36:39], v[48:51]
ds_read_b64_tr_b16 a[232:233], v186 offset:64
buffer_load_dwordx4 v247, s[4:7], s40 offen offset:2048 nt lds
v_mfma_f32_16x16x32_bf16 v[112:115], a[240:243], a[92:95], v[112:115]
ds_read_b64_tr_b16 a[234:235], v186 offset:576
s_add_u32 m0, s47, 33888
v_mfma_f32_16x16x32_bf16 v[52:55], a[244:247], a[36:39], v[52:55]
ds_read_b64_tr_b16 a[236:237], v186 offset:96
ds_read_b64_tr_b16 a[238:239], v186 offset:608
v_mfma_f32_16x16x32_bf16 v[116:119], a[244:247], a[92:95], v[116:119]
v_mfma_f32_16x16x32_bf16 v[56:59], a[248:251], a[36:39], v[56:59]
ds_read_b64_tr_b16 a[240:241], v187 offset:0
buffer_load_dwordx4 v247, s[4:7], s40 offen offset:3072 nt lds
v_mfma_f32_16x16x32_bf16 v[120:123], a[248:251], a[92:95], v[120:123]
ds_read_b64_tr_b16 a[242:243], v187 offset:512
s_add_u32 m0, s47, 50688
v_mfma_f32_16x16x32_bf16 v[60:63], a[252:255], a[36:39], v[60:63]
ds_read_b64_tr_b16 a[244:245], v187 offset:32
ds_read_b64_tr_b16 a[246:247], v187 offset:544
v_mfma_f32_16x16x32_bf16 v[124:127], a[252:255], a[92:95], v[124:127]
s_waitcnt lgkmcnt(5)
v_mfma_f32_16x16x32_bf16 v[0:3], a[192:195], a[40:43], v[0:3]
ds_read_b64_tr_b16 a[248:249], v187 offset:64
buffer_load_dwordx4 v247, s[8:11], s40 offen offset:0 nt lds
v_mfma_f32_16x16x32_bf16 v[64:67], a[192:195], a[96:99], v[64:67]
ds_read_b64_tr_b16 a[250:251], v187 offset:576
s_add_u32 m0, s47, 50720
v_mfma_f32_16x16x32_bf16 v[128:131], a[192:195], a[152:155], v[128:131]
v_mfma_f32_16x16x32_bf16 v[4:7], a[196:199], a[40:43], v[4:7]
ds_read_b64_tr_b16 a[252:253], v187 offset:96
ds_read_b64_tr_b16 a[254:255], v187 offset:608
v_mfma_f32_16x16x32_bf16 v[68:71], a[196:199], a[96:99], v[68:71]
buffer_load_dwordx4 v247, s[8:11], s40 offen offset:1024 nt lds
s_add_u32 m0, s47, 50752
v_mfma_f32_16x16x32_bf16 v[132:135], a[196:199], a[152:155], v[132:135]
v_mfma_f32_16x16x32_bf16 v[8:11], a[200:203], a[40:43], v[8:11]
ds_read_b64_tr_b16 a[192:193], v184 offset:16896
ds_read_b64_tr_b16 a[194:195], v184 offset:17408
v_mfma_f32_16x16x32_bf16 v[72:75], a[200:203], a[96:99], v[72:75]
v_mfma_f32_16x16x32_bf16 v[136:139], a[200:203], a[152:155], v[136:139]
buffer_load_dwordx4 v247, s[8:11], s40 offen offset:2048 nt lds
s_add_u32 m0, s47, 50784
v_mfma_f32_16x16x32_bf16 v[12:15], a[204:207], a[40:43], v[12:15]
ds_read_b64_tr_b16 a[196:197], v184 offset:16928
ds_read_b64_tr_b16 a[198:199], v184 offset:17440
v_mfma_f32_16x16x32_bf16 v[76:79], a[204:207], a[96:99], v[76:79]
v_mfma_f32_16x16x32_bf16 v[140:143], a[204:207], a[152:155], v[140:143]
v_mfma_f32_16x16x32_bf16 v[16:19], a[208:211], a[40:43], v[16:19]
ds_read_b64_tr_b16 a[200:201], v184 offset:16960
buffer_load_dwordx4 v247, s[8:11], s40 offen offset:3072 nt lds
v_mfma_f32_16x16x32_bf16 v[80:83], a[208:211], a[96:99], v[80:83]
ds_read_b64_tr_b16 a[202:203], v184 offset:17472
v_mfma_f32_16x16x32_bf16 v[20:23], a[212:215], a[40:43], v[20:23]
ds_read_b64_tr_b16 a[204:205], v184 offset:16992
ds_read_b64_tr_b16 a[206:207], v184 offset:17504
v_mfma_f32_16x16x32_bf16 v[84:87], a[212:215], a[96:99], v[84:87]
v_mfma_f32_16x16x32_bf16 v[24:27], a[216:219], a[40:43], v[24:27]
ds_read_b64_tr_b16 a[208:209], v185 offset:16896
ds_read_b64_tr_b16 a[210:211], v185 offset:17408
v_mfma_f32_16x16x32_bf16 v[88:91], a[216:219], a[96:99], v[88:91]
v_mfma_f32_16x16x32_bf16 v[28:31], a[220:223], a[40:43], v[28:31]
ds_read_b64_tr_b16 a[212:213], v185 offset:16928
ds_read_b64_tr_b16 a[214:215], v185 offset:17440
v_mfma_f32_16x16x32_bf16 v[92:95], a[220:223], a[96:99], v[92:95]
v_mfma_f32_16x16x32_bf16 v[32:35], a[224:227], a[40:43], v[32:35]
ds_read_b64_tr_b16 a[216:217], v185 offset:16960
ds_read_b64_tr_b16 a[218:219], v185 offset:17472
v_mfma_f32_16x16x32_bf16 v[96:99], a[224:227], a[96:99], v[96:99]
v_mfma_f32_16x16x32_bf16 v[36:39], a[228:231], a[40:43], v[36:39]
ds_read_b64_tr_b16 a[220:221], v185 offset:16992
ds_read_b64_tr_b16 a[222:223], v185 offset:17504
v_mfma_f32_16x16x32_bf16 v[100:103], a[228:231], a[96:99], v[100:103]
v_mfma_f32_16x16x32_bf16 v[40:43], a[232:235], a[40:43], v[40:43]
ds_read_b64_tr_b16 a[224:225], v186 offset:16896
ds_read_b64_tr_b16 a[226:227], v186 offset:17408
v_mfma_f32_16x16x32_bf16 v[104:107], a[232:235], a[96:99], v[104:107]
s_waitcnt lgkmcnt(5)
v_mfma_f32_16x16x32_bf16 v[44:47], a[236:239], a[40:43], v[44:47]
ds_read_b64_tr_b16 a[228:229], v186 offset:16928
ds_read_b64_tr_b16 a[230:231], v186 offset:17440
v_mfma_f32_16x16x32_bf16 v[108:111], a[236:239], a[96:99], v[108:111]
v_mfma_f32_16x16x32_bf16 v[48:51], a[240:243], a[40:43], v[48:51]
ds_read_b64_tr_b16 a[232:233], v186 offset:16960
ds_read_b64_tr_b16 a[234:235], v186 offset:17472
v_mfma_f32_16x16x32_bf16 v[112:115], a[240:243], a[96:99], v[112:115]
v_mfma_f32_16x16x32_bf16 v[52:55], a[244:247], a[40:43], v[52:55]
ds_read_b64_tr_b16 a[236:237], v186 offset:16992
ds_read_b64_tr_b16 a[238:239], v186 offset:17504
v_mfma_f32_16x16x32_bf16 v[116:119], a[244:247], a[96:99], v[116:119]
v_mfma_f32_16x16x32_bf16 v[56:59], a[248:251], a[40:43], v[56:59]
ds_read_b64_tr_b16 a[240:241], v187 offset:16896
ds_read_b64_tr_b16 a[242:243], v187 offset:17408
v_mfma_f32_16x16x32_bf16 v[120:123], a[248:251], a[96:99], v[120:123]
v_mfma_f32_16x16x32_bf16 v[60:63], a[252:255], a[40:43], v[60:63]
ds_read_b64_tr_b16 a[244:245], v187 offset:16928
ds_read_b64_tr_b16 a[246:247], v187 offset:17440
v_mfma_f32_16x16x32_bf16 v[124:127], a[252:255], a[96:99], v[124:127]
v_mfma_f32_16x16x32_bf16 v[0:3], a[192:195], a[44:47], v[0:3]
ds_read_b64_tr_b16 a[248:249], v187 offset:16960
ds_read_b64_tr_b16 a[250:251], v187 offset:17472
v_mfma_f32_16x16x32_bf16 v[64:67], a[192:195], a[100:103], v[64:67]
v_mfma_f32_16x16x32_bf16 v[128:131], a[192:195], a[156:159], v[128:131]
v_mfma_f32_16x16x32_bf16 v[4:7], a[196:199], a[44:47], v[4:7]
ds_read_b64_tr_b16 a[252:253], v187 offset:16992
ds_read_b64_tr_b16 a[254:255], v187 offset:17504
v_mfma_f32_16x16x32_bf16 v[68:71], a[196:199], a[100:103], v[68:71]
v_mfma_f32_16x16x32_bf16 v[132:135], a[196:199], a[156:159], v[132:135]
v_mfma_f32_16x16x32_bf16 v[8:11], a[200:203], a[44:47], v[8:11]
v_mfma_f32_16x16x32_bf16 v[72:75], a[200:203], a[100:103], v[72:75]
v_mfma_f32_16x16x32_bf16 v[136:139], a[200:203], a[156:159], v[136:139]
s_waitcnt vmcnt(8) lgkmcnt(0)
s_barrier
v_mfma_f32_16x16x32_bf16 v[12:15], a[204:207], a[44:47], v[12:15]
ds_read_b128 a[184:187], v234 offset:0
ds_read_b128 a[188:191], v234 offset:64
v_mfma_f32_16x16x32_bf16 v[76:79], a[204:207], a[100:103], v[76:79]
ds_read_b64_tr_b16 a[192:193], v180 offset:0
ds_read_b64_tr_b16 a[194:195], v180 offset:512
v_mfma_f32_16x16x32_bf16 v[140:143], a[204:207], a[156:159], v[140:143]
ds_read_b64_tr_b16 a[196:197], v180 offset:16896
ds_read_b64_tr_b16 a[198:199], v180 offset:17408
v_mfma_f32_16x16x32_bf16 v[16:19], a[208:211], a[44:47], v[16:19]
ds_read_b64_tr_b16 a[200:201], v180 offset:32
ds_read_b64_tr_b16 a[202:203], v180 offset:544
v_mfma_f32_16x16x32_bf16 v[80:83], a[208:211], a[100:103], v[80:83]
s_xor_b32 s85, s83, 1
s_lshl_b32 s85, s85, 16
v_mfma_f32_16x16x32_bf16 v[20:23], a[212:215], a[44:47], v[20:23]
ds_read_b64_tr_b16 a[204:205], v180 offset:16928
ds_read_b64_tr_b16 a[206:207], v180 offset:17440
v_mfma_f32_16x16x32_bf16 v[84:87], a[212:215], a[100:103], v[84:87]
s_add_u32 s85, s85, 16777216
s_add_u32 s12, s62, s85
s_addc_u32 s13, s63, 0
v_mfma_f32_16x16x32_bf16 v[24:27], a[216:219], a[44:47], v[24:27]
ds_read_b64_tr_b16 a[208:209], v180 offset:64
s_add_u32 s99, s99, 128
s_cmp_ge_u32 s99, 896
s_cselect_b32 s99, 0, s99
v_add_u32 v234, s99, v235
v_mfma_f32_16x16x32_bf16 v[88:91], a[216:219], a[100:103], v[88:91]
ds_read_b64_tr_b16 a[210:211], v180 offset:576
s_add_u32 s40, s101, 32768
v_mfma_f32_16x16x32_bf16 v[28:31], a[220:223], a[44:47], v[28:31]
ds_read_b64_tr_b16 a[212:213], v180 offset:16960
s_and_b32 s40, s40, 0x7c000
v_mfma_f32_16x16x32_bf16 v[92:95], a[220:223], a[100:103], v[92:95]
ds_read_b64_tr_b16 a[214:215], v180 offset:17472
s_add_u32 m0, s47, 67584
v_mfma_f32_16x16x32_bf16 v[32:35], a[224:227], a[44:47], v[32:35]
ds_read_b64_tr_b16 a[216:217], v180 offset:96
buffer_load_dwordx4 v247, s[4:7], s40 offen offset:0 nt lds
v_mfma_f32_16x16x32_bf16 v[96:99], a[224:227], a[100:103], v[96:99]
ds_read_b64_tr_b16 a[218:219], v180 offset:608
s_add_u32 m0, s47, 67616
v_mfma_f32_16x16x32_bf16 v[36:39], a[228:231], a[44:47], v[36:39]
ds_read_b64_tr_b16 a[220:221], v180 offset:16992
ds_read_b64_tr_b16 a[222:223], v180 offset:17504
v_mfma_f32_16x16x32_bf16 v[100:103], a[228:231], a[100:103], v[100:103]
s_mov_b32 s14, 65536
s_mov_b32 s15, 0x20000
v_mfma_f32_16x16x32_bf16 v[40:43], a[232:235], a[44:47], v[40:43]
ds_read_b64_tr_b16 a[224:225], v181 offset:0
buffer_load_dwordx4 v247, s[4:7], s40 offen offset:1024 nt lds
v_mfma_f32_16x16x32_bf16 v[104:107], a[232:235], a[100:103], v[104:107]
ds_read_b64_tr_b16 a[226:227], v181 offset:512
s_add_u32 m0, s47, 67648
v_mfma_f32_16x16x32_bf16 v[44:47], a[236:239], a[44:47], v[44:47]
ds_read_b64_tr_b16 a[228:229], v181 offset:16896
ds_read_b64_tr_b16 a[230:231], v181 offset:17408
v_mfma_f32_16x16x32_bf16 v[108:111], a[236:239], a[100:103], v[108:111]
s_mov_b32 s85, 32736
s_mov_b32 s86, 27776
v_mfma_f32_16x16x32_bf16 v[48:51], a[240:243], a[44:47], v[48:51]
ds_read_b64_tr_b16 a[232:233], v181 offset:32
buffer_load_dwordx4 v247, s[4:7], s40 offen offset:2048 nt lds
v_mfma_f32_16x16x32_bf16 v[112:115], a[240:243], a[100:103], v[112:115]
ds_read_b64_tr_b16 a[234:235], v181 offset:544
s_add_u32 m0, s47, 67680
v_mfma_f32_16x16x32_bf16 v[52:55], a[244:247], a[44:47], v[52:55]
ds_read_b64_tr_b16 a[236:237], v181 offset:16928
ds_read_b64_tr_b16 a[238:239], v181 offset:17440
v_mfma_f32_16x16x32_bf16 v[116:119], a[244:247], a[100:103], v[116:119]
s_cmp_eq_u32 s3, 1
s_cselect_b32 s44, 15840, s85
s_cselect_b32 s84, 13440, s86
v_mfma_f32_16x16x32_bf16 v[56:59], a[248:251], a[44:47], v[56:59]
ds_read_b64_tr_b16 a[240:241], v181 offset:64
buffer_load_dwordx4 v247, s[4:7], s40 offen offset:3072 nt lds
v_mfma_f32_16x16x32_bf16 v[120:123], a[248:251], a[100:103], v[120:123]
ds_read_b64_tr_b16 a[242:243], v181 offset:576
s_add_u32 m0, s47, 84480
v_mfma_f32_16x16x32_bf16 v[60:63], a[252:255], a[44:47], v[60:63]
ds_read_b64_tr_b16 a[244:245], v181 offset:16960
ds_read_b64_tr_b16 a[246:247], v181 offset:17472
v_mfma_f32_16x16x32_bf16 v[124:127], a[252:255], a[100:103], v[124:127]
s_add_u32 s45, s101, 49152
s_waitcnt lgkmcnt(5)
v_mfma_f32_16x16x32_bf16 v[0:3], a[192:195], a[168:171], v[0:3]
ds_read_b64_tr_b16 a[248:249], v181 offset:96
buffer_load_dwordx4 v247, s[8:11], s40 offen offset:0 nt lds
v_mfma_f32_16x16x32_bf16 v[64:67], a[192:195], a[176:179], v[64:67]
ds_read_b64_tr_b16 a[250:251], v181 offset:608
s_add_u32 m0, s47, 84512
v_mfma_f32_16x16x32_bf16 v[128:131], a[192:195], a[184:187], v[128:131]
s_and_b32 s36, s45, 0x7c000
v_mfma_f32_16x16x32_bf16 v[0:3], a[196:199], a[172:175], v[0:3]
ds_read_b64_tr_b16 a[252:253], v181 offset:16992
ds_read_b64_tr_b16 a[254:255], v181 offset:17504
v_mfma_f32_16x16x32_bf16 v[64:67], a[196:199], a[180:183], v[64:67]
buffer_load_dwordx4 v247, s[8:11], s40 offen offset:1024 nt lds
s_add_u32 m0, s47, 84544
v_mfma_f32_16x16x32_bf16 v[128:131], a[196:199], a[188:191], v[128:131]
v_mfma_f32_16x16x32_bf16 v[4:7], a[200:203], a[168:171], v[4:7]
ds_read_b64_tr_b16 a[192:193], v182 offset:0
ds_read_b64_tr_b16 a[194:195], v182 offset:512
v_mfma_f32_16x16x32_bf16 v[68:71], a[200:203], a[176:179], v[68:71]
v_mfma_f32_16x16x32_bf16 v[132:135], a[200:203], a[184:187], v[132:135]
buffer_load_dwordx4 v247, s[8:11], s40 offen offset:2048 nt lds
s_add_u32 m0, s47, 84576
v_mfma_f32_16x16x32_bf16 v[4:7], a[204:207], a[172:175], v[4:7]
ds_read_b64_tr_b16 a[196:197], v182 offset:16896
ds_read_b64_tr_b16 a[198:199], v182 offset:17408
v_mfma_f32_16x16x32_bf16 v[68:71], a[204:207], a[180:183], v[68:71]
v_mfma_f32_16x16x32_bf16 v[132:135], a[204:207], a[188:191], v[132:135]
v_mfma_f32_16x16x32_bf16 v[8:11], a[208:211], a[168:171], v[8:11]
ds_read_b64_tr_b16 a[200:201], v182 offset:32
buffer_load_dwordx4 v247, s[8:11], s40 offen offset:3072 nt lds
v_mfma_f32_16x16x32_bf16 v[72:75], a[208:211], a[176:179], v[72:75]
ds_read_b64_tr_b16 a[202:203], v182 offset:544
v_mfma_f32_16x16x32_bf16 v[136:139], a[208:211], a[184:187], v[136:139]
v_mfma_f32_16x16x32_bf16 v[8:11], a[212:215], a[172:175], v[8:11]
ds_read_b64_tr_b16 a[204:205], v182 offset:16928
ds_read_b64_tr_b16 a[206:207], v182 offset:17440
v_mfma_f32_16x16x32_bf16 v[72:75], a[212:215], a[180:183], v[72:75]
v_cvt_pk_bf16_f32 v0, v0, v1
v_cvt_pk_bf16_f32 v1, v2, v3
v_mfma_f32_16x16x32_bf16 v[136:139], a[212:215], a[188:191], v[136:139]
v_cvt_pk_bf16_f32 v2, v4, v5
v_cvt_pk_bf16_f32 v3, v6, v7
v_mfma_f32_16x16x32_bf16 v[12:15], a[216:219], a[168:171], v[12:15]
ds_read_b64_tr_b16 a[208:209], v182 offset:64
ds_read_b64_tr_b16 a[210:211], v182 offset:576
v_mfma_f32_16x16x32_bf16 v[76:79], a[216:219], a[176:179], v[76:79]
v_cvt_pk_bf16_f32 v64, v64, v65
v_cvt_pk_bf16_f32 v65, v66, v67
v_mfma_f32_16x16x32_bf16 v[140:143], a[216:219], a[184:187], v[140:143]
v_cvt_pk_bf16_f32 v66, v68, v69
v_cvt_pk_bf16_f32 v67, v70, v71
v_mfma_f32_16x16x32_bf16 v[12:15], a[220:223], a[172:175], v[12:15]
ds_read_b64_tr_b16 a[212:213], v182 offset:16960
ds_read_b64_tr_b16 a[214:215], v182 offset:17472
v_mfma_f32_16x16x32_bf16 v[76:79], a[220:223], a[180:183], v[76:79]
v_permlane32_swap_b32 v0, v2
v_permlane32_swap_b32 v1, v3
v_mfma_f32_16x16x32_bf16 v[140:143], a[220:223], a[188:191], v[140:143]
v_permlane32_swap_b32 v64, v66
v_permlane32_swap_b32 v65, v67
v_mfma_f32_16x16x32_bf16 v[16:19], a[224:227], a[168:171], v[16:19]
ds_read_b64_tr_b16 a[216:217], v182 offset:96
ds_read_b64_tr_b16 a[218:219], v182 offset:608
v_mfma_f32_16x16x32_bf16 v[80:83], a[224:227], a[176:179], v[80:83]
v_permlane16_swap_b32 v0, v2
v_permlane16_swap_b32 v1, v3
v_mfma_f32_16x16x32_bf16 v[16:19], a[228:231], a[172:175], v[16:19]
ds_read_b64_tr_b16 a[220:221], v182 offset:16992
ds_read_b64_tr_b16 a[222:223], v182 offset:17504
v_mfma_f32_16x16x32_bf16 v[80:83], a[228:231], a[180:183], v[80:83]
v_permlane16_swap_b32 v64, v66
v_permlane16_swap_b32 v65, v67
v_mfma_f32_16x16x32_bf16 v[20:23], a[232:235], a[168:171], v[20:23]
ds_read_b64_tr_b16 a[224:225], v183 offset:0
ds_read_b64_tr_b16 a[226:227], v183 offset:512
v_mfma_f32_16x16x32_bf16 v[84:87], a[232:235], a[176:179], v[84:87]
v_cvt_pk_bf16_f32 v144, v128, v129
s_waitcnt lgkmcnt(5)
v_mfma_f32_16x16x32_bf16 v[20:23], a[236:239], a[172:175], v[20:23]
ds_read_b64_tr_b16 a[228:229], v183 offset:16896
ds_read_b64_tr_b16 a[230:231], v183 offset:17408
v_mfma_f32_16x16x32_bf16 v[84:87], a[236:239], a[180:183], v[84:87]
v_cvt_pk_bf16_f32 v145, v130, v131
v_cvt_pk_bf16_f32 v146, v132, v133
v_mfma_f32_16x16x32_bf16 v[24:27], a[240:243], a[168:171], v[24:27]
ds_read_b64_tr_b16 a[232:233], v183 offset:32
ds_read_b64_tr_b16 a[234:235], v183 offset:544
v_mfma_f32_16x16x32_bf16 v[88:91], a[240:243], a[176:179], v[88:91]
v_cvt_pk_bf16_f32 v147, v134, v135
v_cvt_pk_bf16_f32 v148, v136, v137
v_mfma_f32_16x16x32_bf16 v[24:27], a[244:247], a[172:175], v[24:27]
ds_read_b64_tr_b16 a[236:237], v183 offset:16928
ds_read_b64_tr_b16 a[238:239], v183 offset:17440
v_mfma_f32_16x16x32_bf16 v[88:91], a[244:247], a[180:183], v[88:91]
v_cvt_pk_bf16_f32 v149, v138, v139
v_cvt_pk_bf16_f32 v150, v140, v141
v_mfma_f32_16x16x32_bf16 v[28:31], a[248:251], a[168:171], v[28:31]
ds_read_b64_tr_b16 a[240:241], v183 offset:64
ds_read_b64_tr_b16 a[242:243], v183 offset:576
v_mfma_f32_16x16x32_bf16 v[92:95], a[248:251], a[176:179], v[92:95]
v_cvt_pk_bf16_f32 v151, v142, v143
v_permlane32_swap_b32 v144, v146
v_mfma_f32_16x16x32_bf16 v[28:31], a[252:255], a[172:175], v[28:31]
ds_read_b64_tr_b16 a[244:245], v183 offset:16960
ds_read_b64_tr_b16 a[246:247], v183 offset:17472
v_mfma_f32_16x16x32_bf16 v[92:95], a[252:255], a[180:183], v[92:95]
v_permlane32_swap_b32 v145, v147
v_permlane32_swap_b32 v148, v150
v_mfma_f32_16x16x32_bf16 v[32:35], a[192:195], a[168:171], v[32:35]
ds_read_b64_tr_b16 a[248:249], v183 offset:96
ds_read_b64_tr_b16 a[250:251], v183 offset:608
v_mfma_f32_16x16x32_bf16 v[96:99], a[192:195], a[176:179], v[96:99]
v_permlane32_swap_b32 v149, v151
v_permlane16_swap_b32 v144, v146
v_mfma_f32_16x16x32_bf16 v[32:35], a[196:199], a[172:175], v[32:35]
ds_read_b64_tr_b16 a[252:253], v183 offset:16992
ds_read_b64_tr_b16 a[254:255], v183 offset:17504
v_mfma_f32_16x16x32_bf16 v[96:99], a[196:199], a[180:183], v[96:99]
v_permlane16_swap_b32 v145, v147
v_permlane16_swap_b32 v148, v150
v_mfma_f32_16x16x32_bf16 v[36:39], a[200:203], a[168:171], v[36:39]
v_permlane16_swap_b32 v149, v151
ds_write_b128 v241, v[144:147]
v_mfma_f32_16x16x32_bf16 v[100:103], a[200:203], a[176:179], v[100:103]
ds_write_b128 v241, v[148:151] offset:1024
v_mfma_f32_16x16x32_bf16 v[36:39], a[204:207], a[172:175], v[36:39]
v_cvt_pk_bf16_f32 v8, v8, v9
v_cvt_pk_bf16_f32 v9, v10, v11
v_mfma_f32_16x16x32_bf16 v[100:103], a[204:207], a[180:183], v[100:103]
v_cvt_pk_bf16_f32 v10, v12, v13
v_cvt_pk_bf16_f32 v11, v14, v15
v_mfma_f32_16x16x32_bf16 v[40:43], a[208:211], a[168:171], v[40:43]
v_cvt_pk_bf16_f32 v72, v72, v73
v_cvt_pk_bf16_f32 v73, v74, v75
v_mfma_f32_16x16x32_bf16 v[104:107], a[208:211], a[176:179], v[104:107]
v_cvt_pk_bf16_f32 v74, v76, v77
v_cvt_pk_bf16_f32 v75, v78, v79
v_mfma_f32_16x16x32_bf16 v[40:43], a[212:215], a[172:175], v[40:43]
s_waitcnt vmcnt(24) lgkmcnt(0)
s_barrier
v_mfma_f32_16x16x32_bf16 v[104:107], a[212:215], a[180:183], v[104:107]
ds_read_b128 a[96:99], v249 offset:0
v_permlane32_swap_b32 v8, v10
v_mfma_f32_16x16x32_bf16 v[44:47], a[216:219], a[168:171], v[44:47]
ds_read_b128 a[100:103], v249 offset:8448
v_permlane32_swap_b32 v9, v11
v_mfma_f32_16x16x32_bf16 v[108:111], a[216:219], a[176:179], v[108:111]
ds_read_b128 a[104:107], v249 offset:64
v_permlane32_swap_b32 v72, v74
v_mfma_f32_16x16x32_bf16 v[44:47], a[220:223], a[172:175], v[44:47]
ds_read_b128 a[108:111], v249 offset:8512
v_permlane32_swap_b32 v73, v75
v_mfma_f32_16x16x32_bf16 v[108:111], a[220:223], a[180:183], v[108:111]
ds_read_b128 a[112:115], v249 offset:128
v_permlane16_swap_b32 v8, v10
v_mfma_f32_16x16x32_bf16 v[48:51], a[224:227], a[168:171], v[48:51]
ds_read_b128 a[116:119], v249 offset:8576
v_permlane16_swap_b32 v9, v11
v_mfma_f32_16x16x32_bf16 v[112:115], a[224:227], a[176:179], v[112:115]
ds_read_b128 a[120:123], v249 offset:192
v_permlane16_swap_b32 v72, v74
v_mfma_f32_16x16x32_bf16 v[48:51], a[228:231], a[172:175], v[48:51]
ds_read_b128 a[124:127], v249 offset:8640
v_permlane16_swap_b32 v73, v75
v_mfma_f32_16x16x32_bf16 v[112:115], a[228:231], a[180:183], v[112:115]
ds_read_b128 a[128:131], v249 offset:256
v_cvt_pk_bf16_f32 v16, v16, v17
v_mfma_f32_16x16x32_bf16 v[52:55], a[232:235], a[168:171], v[52:55]
ds_read_b128 a[132:135], v249 offset:8704
v_cvt_pk_bf16_f32 v17, v18, v19
v_mfma_f32_16x16x32_bf16 v[116:119], a[232:235], a[176:179], v[116:119]
ds_read_b128 a[136:139], v249 offset:320
v_cvt_pk_bf16_f32 v18, v20, v21
v_mfma_f32_16x16x32_bf16 v[52:55], a[236:239], a[172:175], v[52:55]
ds_read_b128 a[140:143], v249 offset:8768
v_cvt_pk_bf16_f32 v19, v22, v23
v_mfma_f32_16x16x32_bf16 v[116:119], a[236:239], a[180:183], v[116:119]
ds_read_b128 a[144:147], v249 offset:384
v_cvt_pk_bf16_f32 v80, v80, v81
v_mfma_f32_16x16x32_bf16 v[56:59], a[240:243], a[168:171], v[56:59]
ds_read_b128 a[148:151], v249 offset:8832
v_cvt_pk_bf16_f32 v81, v82, v83
v_mfma_f32_16x16x32_bf16 v[120:123], a[240:243], a[176:179], v[120:123]
ds_read_b128 a[152:155], v249 offset:448
v_cvt_pk_bf16_f32 v82, v84, v85
v_mfma_f32_16x16x32_bf16 v[56:59], a[244:247], a[172:175], v[56:59]
ds_read_b128 a[156:159], v249 offset:8896
v_cvt_pk_bf16_f32 v83, v86, v87
v_mfma_f32_16x16x32_bf16 v[120:123], a[244:247], a[180:183], v[120:123]
v_permlane32_swap_b32 v16, v18
v_permlane32_swap_b32 v17, v19
v_mfma_f32_16x16x32_bf16 v[60:63], a[248:251], a[168:171], v[60:63]
v_permlane32_swap_b32 v80, v82
v_permlane32_swap_b32 v81, v83
v_mfma_f32_16x16x32_bf16 v[124:127], a[248:251], a[176:179], v[124:127]
v_permlane16_swap_b32 v16, v18
v_permlane16_swap_b32 v17, v19
v_mfma_f32_16x16x32_bf16 v[60:63], a[252:255], a[172:175], v[60:63]
v_permlane16_swap_b32 v80, v82
v_permlane16_swap_b32 v81, v83
v_mfma_f32_16x16x32_bf16 v[124:127], a[252:255], a[180:183], v[124:127]
v_cvt_pk_bf16_f32 v24, v24, v25
v_cvt_pk_bf16_f32 v25, v26, v27
v_cvt_pk_bf16_f32 v26, v28, v29
v_cvt_pk_bf16_f32 v27, v30, v31
v_cvt_pk_bf16_f32 v88, v88, v89
v_cvt_pk_bf16_f32 v89, v90, v91
v_cvt_pk_bf16_f32 v90, v92, v93
v_cvt_pk_bf16_f32 v91, v94, v95
v_permlane32_swap_b32 v24, v26
v_permlane32_swap_b32 v25, v27
v_permlane32_swap_b32 v88, v90
v_permlane32_swap_b32 v89, v91
v_permlane16_swap_b32 v24, v26
v_permlane16_swap_b32 v25, v27
v_permlane16_swap_b32 v88, v90
v_permlane16_swap_b32 v89, v91
v_cvt_pk_bf16_f32 v32, v32, v33
v_cvt_pk_bf16_f32 v33, v34, v35
v_cvt_pk_bf16_f32 v34, v36, v37
v_cvt_pk_bf16_f32 v35, v38, v39
v_cvt_pk_bf16_f32 v96, v96, v97
v_cvt_pk_bf16_f32 v97, v98, v99
v_cvt_pk_bf16_f32 v98, v100, v101
v_cvt_pk_bf16_f32 v99, v102, v103
v_permlane32_swap_b32 v32, v34
v_permlane32_swap_b32 v33, v35
v_permlane32_swap_b32 v96, v98
v_permlane32_swap_b32 v97, v99
v_permlane16_swap_b32 v32, v34
v_permlane16_swap_b32 v33, v35
v_permlane16_swap_b32 v96, v98
v_permlane16_swap_b32 v97, v99
v_cvt_pk_bf16_f32 v40, v40, v41
v_cvt_pk_bf16_f32 v41, v42, v43
v_cvt_pk_bf16_f32 v42, v44, v45
v_cvt_pk_bf16_f32 v43, v46, v47
v_cvt_pk_bf16_f32 v104, v104, v105
v_cvt_pk_bf16_f32 v105, v106, v107
v_cvt_pk_bf16_f32 v106, v108, v109
v_cvt_pk_bf16_f32 v107, v110, v111
v_permlane32_swap_b32 v40, v42
v_permlane32_swap_b32 v41, v43
v_permlane32_swap_b32 v104, v106
v_permlane32_swap_b32 v105, v107
v_permlane16_swap_b32 v40, v42
v_permlane16_swap_b32 v41, v43
v_permlane16_swap_b32 v104, v106
v_permlane16_swap_b32 v105, v107
v_cvt_pk_bf16_f32 v48, v48, v49
v_cvt_pk_bf16_f32 v49, v50, v51
v_cvt_pk_bf16_f32 v50, v52, v53
v_cvt_pk_bf16_f32 v51, v54, v55
v_cvt_pk_bf16_f32 v112, v112, v113
v_cvt_pk_bf16_f32 v113, v114, v115
v_cvt_pk_bf16_f32 v114, v116, v117
v_cvt_pk_bf16_f32 v115, v118, v119
v_permlane32_swap_b32 v48, v50
v_permlane32_swap_b32 v49, v51
v_permlane32_swap_b32 v112, v114
v_permlane32_swap_b32 v113, v115
v_permlane16_swap_b32 v48, v50
v_permlane16_swap_b32 v49, v51
v_permlane16_swap_b32 v112, v114
v_permlane16_swap_b32 v113, v115
v_cvt_pk_bf16_f32 v56, v56, v57
v_cvt_pk_bf16_f32 v57, v58, v59
v_cvt_pk_bf16_f32 v58, v60, v61
v_cvt_pk_bf16_f32 v59, v62, v63
v_cvt_pk_bf16_f32 v120, v120, v121
v_cvt_pk_bf16_f32 v121, v122, v123
v_cvt_pk_bf16_f32 v122, v124, v125
v_cvt_pk_bf16_f32 v123, v126, v127
v_permlane32_swap_b32 v56, v58
v_permlane32_swap_b32 v57, v59
v_permlane32_swap_b32 v120, v122
v_permlane32_swap_b32 v121, v123
v_permlane16_swap_b32 v56, v58
v_permlane16_swap_b32 v57, v59
v_permlane16_swap_b32 v120, v122
v_permlane16_swap_b32 v121, v123
v_mov_b32 v241, 0x3f803f80
v_accvgpr_write_b32 a236, v241
v_accvgpr_write_b32 a237, v241
v_accvgpr_write_b32 a238, v241
v_accvgpr_write_b32 a239, v241
s_cmp_lg_u32 s3, 0
s_cbranch_scc1 L_type1
ds_read_b128 a[64:67], v240 offset:0
ds_read_b128 a[68:71], v240 offset:1024
ds_read_b128 a[72:75], v240 offset:2048
ds_read_b128 a[76:79], v240 offset:3072
ds_read_b128 a[80:83], v240 offset:4096
ds_read_b128 a[84:87], v240 offset:5120
ds_read_b128 a[88:91], v240 offset:6144
ds_read_b128 a[92:95], v240 offset:7168
v_accvgpr_write_b32 a0, v0
v_accvgpr_write_b32 a1, v1
v_accvgpr_write_b32 a2, v2
v_accvgpr_write_b32 a3, v3
v_accvgpr_write_b32 a4, v8
v_accvgpr_write_b32 a5, v9
v_accvgpr_write_b32 a6, v10
v_accvgpr_write_b32 a7, v11
v_accvgpr_write_b32 a8, v16
v_accvgpr_write_b32 a9, v17
v_accvgpr_write_b32 a10, v18
v_accvgpr_write_b32 a11, v19
v_accvgpr_write_b32 a12, v24
v_accvgpr_write_b32 a13, v25
v_accvgpr_write_b32 a14, v26
v_accvgpr_write_b32 a15, v27
v_accvgpr_write_b32 a16, v32
v_accvgpr_write_b32 a17, v33
v_accvgpr_write_b32 a18, v34
v_accvgpr_write_b32 a19, v35
v_accvgpr_write_b32 a20, v40
v_accvgpr_write_b32 a21, v41
v_accvgpr_write_b32 a22, v42
v_accvgpr_write_b32 a23, v43
v_accvgpr_write_b32 a24, v48
v_accvgpr_write_b32 a25, v49
v_accvgpr_write_b32 a26, v50
v_accvgpr_write_b32 a27, v51
v_accvgpr_write_b32 a28, v56
v_accvgpr_write_b32 a29, v57
v_accvgpr_write_b32 a30, v58
v_accvgpr_write_b32 a31, v59
v_accvgpr_write_b32 a32, v64
v_accvgpr_write_b32 a33, v65
v_accvgpr_write_b32 a34, v66
v_accvgpr_write_b32 a35, v67
v_accvgpr_write_b32 a36, v72
v_accvgpr_write_b32 a37, v73
v_accvgpr_write_b32 a38, v74
v_accvgpr_write_b32 a39, v75
v_accvgpr_write_b32 a40, v80
v_accvgpr_write_b32 a41, v81
v_accvgpr_write_b32 a42, v82
v_accvgpr_write_b32 a43, v83
v_accvgpr_write_b32 a44, v88
v_accvgpr_write_b32 a45, v89
v_accvgpr_write_b32 a46, v90
v_accvgpr_write_b32 a47, v91
v_accvgpr_write_b32 a48, v96
v_accvgpr_write_b32 a49, v97
v_accvgpr_write_b32 a50, v98
v_accvgpr_write_b32 a51, v99
v_accvgpr_write_b32 a52, v104
v_accvgpr_write_b32 a53, v105
v_accvgpr_write_b32 a54, v106
v_accvgpr_write_b32 a55, v107
v_accvgpr_write_b32 a56, v112
v_accvgpr_write_b32 a57, v113
v_accvgpr_write_b32 a58, v114
v_accvgpr_write_b32 a59, v115
v_accvgpr_write_b32 a60, v120
v_accvgpr_write_b32 a61, v121
v_accvgpr_write_b32 a62, v122
v_accvgpr_write_b32 a63, v123
s_lshl_b32 s97, s81, 5
s_mov_b32 s41, 0x10101010
v_and_b32 v243, 7, v255
v_lshlrev_b32 v243, 2, v243
buffer_load_dword v245, v243, s[92:95], s97 offen sc1
s_waitcnt lgkmcnt(6)
v_mfma_f32_16x16x32_bf16 v[192:195], a[96:99], a[0:3], 0
ds_read_b64_tr_b16 a[160:161], v248 offset:16896
v_mfma_f32_16x16x32_bf16 v[196:199], a[100:103], a[0:3], 0
ds_read_b64_tr_b16 a[162:163], v248 offset:25344
v_mfma_f32_16x16x32_bf16 v[192:195], a[104:107], a[4:7], v[192:195]
ds_read_b64_tr_b16 a[164:165], v248 offset:16928
v_mfma_f32_16x16x32_bf16 v[196:199], a[108:111], a[4:7], v[196:199]
ds_read_b64_tr_b16 a[166:167], v248 offset:25376
v_mfma_f32_16x16x32_bf16 v[192:195], a[112:115], a[8:11], v[192:195]
ds_read_b64_tr_b16 a[168:169], v248 offset:16960
v_mfma_f32_16x16x32_bf16 v[196:199], a[116:119], a[8:11], v[196:199]
ds_read_b64_tr_b16 a[170:171], v248 offset:25408
v_mfma_f32_16x16x32_bf16 v[192:195], a[120:123], a[12:15], v[192:195]
ds_read_b64_tr_b16 a[172:173], v248 offset:16992
v_mfma_f32_16x16x32_bf16 v[196:199], a[124:127], a[12:15], v[196:199]
ds_read_b64_tr_b16 a[174:175], v248 offset:25440
v_mfma_f32_16x16x32_bf16 v[192:195], a[128:131], a[16:19], v[192:195]
ds_read_b64_tr_b16 a[176:177], v248 offset:17024
v_mfma_f32_16x16x32_bf16 v[196:199], a[132:135], a[16:19], v[196:199]
ds_read_b64_tr_b16 a[178:179], v248 offset:25472
s_waitcnt lgkmcnt(10)
v_mfma_f32_16x16x32_bf16 v[192:195], a[136:139], a[20:23], v[192:195]
ds_read_b64_tr_b16 a[180:181], v248 offset:17056
v_mfma_f32_16x16x32_bf16 v[196:199], a[140:143], a[20:23], v[196:199]
ds_read_b64_tr_b16 a[182:183], v248 offset:25504
v_mfma_f32_16x16x32_bf16 v[192:195], a[144:147], a[24:27], v[192:195]
ds_read_b64_tr_b16 a[184:185], v248 offset:17088
v_mfma_f32_16x16x32_bf16 v[196:199], a[148:151], a[24:27], v[196:199]
ds_read_b64_tr_b16 a[186:187], v248 offset:25536
v_mfma_f32_16x16x32_bf16 v[192:195], a[152:155], a[28:31], v[192:195]
ds_read_b64_tr_b16 a[188:189], v248 offset:17120
v_mfma_f32_16x16x32_bf16 v[196:199], a[156:159], a[28:31], v[196:199]
ds_read_b64_tr_b16 a[190:191], v248 offset:25568
v_mfma_f32_16x16x32_bf16 v[200:203], a[96:99], a[32:35], 0
ds_read_b64_tr_b16 a[192:193], v248 offset:17152
v_mfma_f32_16x16x32_bf16 v[204:207], a[100:103], a[32:35], 0
ds_read_b64_tr_b16 a[194:195], v248 offset:25600
v_mfma_f32_16x16x32_bf16 v[200:203], a[104:107], a[36:39], v[200:203]
ds_read_b64_tr_b16 a[196:197], v248 offset:17184
v_mfma_f32_16x16x32_bf16 v[204:207], a[108:111], a[36:39], v[204:207]
ds_read_b64_tr_b16 a[198:199], v248 offset:25632
v_max3_f32 v234, v192, v193, v194
v_mfma_f32_16x16x32_bf16 v[200:203], a[112:115], a[40:43], v[200:203]
ds_read_b64_tr_b16 a[200:201], v248 offset:17216
v_max3_f32 v235, v196, v197, v198
v_mfma_f32_16x16x32_bf16 v[204:207], a[116:119], a[40:43], v[204:207]
ds_read_b64_tr_b16 a[202:203], v248 offset:25664
v_max3_f32 v234, v234, v195, v199
v_mfma_f32_16x16x32_bf16 v[200:203], a[120:123], a[44:47], v[200:203]
ds_read_b64_tr_b16 a[204:205], v248 offset:17248
v_max_f32 v234, v234, v235
v_mfma_f32_16x16x32_bf16 v[204:207], a[124:127], a[44:47], v[204:207]
ds_read_b64_tr_b16 a[206:207], v248 offset:25696
v_mov_b32 v235, v234
v_mfma_f32_16x16x32_bf16 v[200:203], a[128:131], a[48:51], v[200:203]
ds_read_b64_tr_b16 a[208:209], v248 offset:17280
s_nop 1
v_mfma_f32_16x16x32_bf16 v[204:207], a[132:135], a[48:51], v[204:207]
ds_read_b64_tr_b16 a[210:211], v248 offset:25728
v_permlane32_swap_b32 v234, v235
v_mfma_f32_16x16x32_bf16 v[200:203], a[136:139], a[52:55], v[200:203]
ds_read_b64_tr_b16 a[212:213], v248 offset:17312
s_nop 1
v_mfma_f32_16x16x32_bf16 v[204:207], a[140:143], a[52:55], v[204:207]
ds_read_b64_tr_b16 a[214:215], v248 offset:25760
v_max_f32 v234, v234, v235
v_mfma_f32_16x16x32_bf16 v[200:203], a[144:147], a[56:59], v[200:203]
ds_read_b64_tr_b16 a[216:217], v248 offset:17344
v_mov_b32 v235, v234
v_mfma_f32_16x16x32_bf16 v[204:207], a[148:151], a[56:59], v[204:207]
ds_read_b64_tr_b16 a[218:219], v248 offset:25792
s_nop 1
v_mfma_f32_16x16x32_bf16 v[200:203], a[152:155], a[60:63], v[200:203]
ds_read_b64_tr_b16 a[220:221], v248 offset:17376
v_permlane16_swap_b32 v234, v235
v_mfma_f32_16x16x32_bf16 v[204:207], a[156:159], a[60:63], v[204:207]
ds_read_b64_tr_b16 a[222:223], v248 offset:25824
s_nop 1
v_mfma_f32_16x16x32_bf16 v[208:211], a[96:99], a[64:67], 0
v_max_f32 v234, v234, v235
v_mul_f32 v228, s32, v234
v_mfma_f32_16x16x32_bf16 v[212:215], a[100:103], a[64:67], 0
v_add_f32 v229, s34, v234
v_sub_f32 v228, 0, v228
v_mfma_f32_16x16x32_bf16 v[208:211], a[104:107], a[68:71], v[208:211]
v_fma_f32 v192, v192, s32, v228
v_fma_f32 v193, v193, s32, v228
v_mfma_f32_16x16x32_bf16 v[212:215], a[108:111], a[68:71], v[212:215]
v_fma_f32 v194, v194, s32, v228
v_fma_f32 v195, v195, s32, v228
v_mfma_f32_16x16x32_bf16 v[208:211], a[112:115], a[72:75], v[208:211]
v_fma_f32 v196, v196, s32, v228
v_fma_f32 v197, v197, s32, v228
v_mfma_f32_16x16x32_bf16 v[212:215], a[116:119], a[72:75], v[212:215]
v_fma_f32 v198, v198, s32, v228
v_fma_f32 v199, v199, s32, v228
v_mfma_f32_16x16x32_bf16 v[208:211], a[120:123], a[76:79], v[208:211]
v_exp_f32 v192, v192
v_mfma_f32_16x16x32_bf16 v[212:215], a[124:127], a[76:79], v[212:215]
v_exp_f32 v193, v193
v_mfma_f32_16x16x32_bf16 v[208:211], a[128:131], a[80:83], v[208:211]
v_exp_f32 v194, v194
v_mfma_f32_16x16x32_bf16 v[212:215], a[132:135], a[80:83], v[212:215]
v_exp_f32 v195, v195
v_mfma_f32_16x16x32_bf16 v[208:211], a[136:139], a[84:87], v[208:211]
v_exp_f32 v196, v196
v_mfma_f32_16x16x32_bf16 v[212:215], a[140:143], a[84:87], v[212:215]
v_exp_f32 v197, v197
v_mfma_f32_16x16x32_bf16 v[208:211], a[144:147], a[88:91], v[208:211]
v_exp_f32 v198, v198
v_mfma_f32_16x16x32_bf16 v[212:215], a[148:151], a[88:91], v[212:215]
v_exp_f32 v199, v199
v_mfma_f32_16x16x32_bf16 v[208:211], a[152:155], a[92:95], v[208:211]
v_cvt_pk_bf16_f32 v216, v192, v193
v_cvt_pk_bf16_f32 v217, v194, v195
v_mfma_f32_16x16x32_bf16 v[212:215], a[156:159], a[92:95], v[212:215]
v_cvt_pk_bf16_f32 v218, v196, v197
v_cvt_pk_bf16_f32 v219, v198, v199
s_waitcnt lgkmcnt(0)
s_nop 0
v_mfma_f32_16x16x32_bf16 v[0:3], a[160:163], v[216:219], 0
v_max3_f32 v236, v200, v201, v202
v_max3_f32 v237, v204, v205, v206
v_mfma_f32_16x16x32_bf16 v[4:7], a[164:167], v[216:219], 0
v_max3_f32 v236, v236, v203, v207
v_max_f32 v236, v236, v237
v_mfma_f32_16x16x32_bf16 v[8:11], a[168:171], v[216:219], 0
v_mov_b32 v237, v236
s_nop 1
v_mfma_f32_16x16x32_bf16 v[12:15], a[172:175], v[216:219], 0
v_permlane32_swap_b32 v236, v237
s_nop 1
v_mfma_f32_16x16x32_bf16 v[16:19], a[176:179], v[216:219], 0
v_max_f32 v236, v236, v237
v_mov_b32 v237, v236
v_mfma_f32_16x16x32_bf16 v[20:23], a[180:183], v[216:219], 0
s_nop 1
v_permlane16_swap_b32 v236, v237
v_mfma_f32_16x16x32_bf16 v[24:27], a[184:187], v[216:219], 0
s_nop 1
v_max_f32 v236, v236, v237
v_mfma_f32_16x16x32_bf16 v[28:31], a[188:191], v[216:219], 0
v_mul_f32 v230, s32, v236
v_add_f32 v231, s34, v236
v_mfma_f32_16x16x32_bf16 v[32:35], a[192:195], v[216:219], 0
v_sub_f32 v230, 0, v230
v_fma_f32 v200, v200, s32, v230
v_mfma_f32_16x16x32_bf16 v[36:39], a[196:199], v[216:219], 0
v_fma_f32 v201, v201, s32, v230
v_fma_f32 v202, v202, s32, v230
v_mfma_f32_16x16x32_bf16 v[40:43], a[200:203], v[216:219], 0
v_fma_f32 v203, v203, s32, v230
v_fma_f32 v204, v204, s32, v230
v_mfma_f32_16x16x32_bf16 v[44:47], a[204:207], v[216:219], 0
v_fma_f32 v205, v205, s32, v230
v_fma_f32 v206, v206, s32, v230
v_mfma_f32_16x16x32_bf16 v[48:51], a[208:211], v[216:219], 0
v_fma_f32 v207, v207, s32, v230
v_add_u32 v249, s38, v251
v_mfma_f32_16x16x32_bf16 v[52:55], a[212:215], v[216:219], 0
v_exp_f32 v200, v200
v_mfma_f32_16x16x32_bf16 v[56:59], a[216:219], v[216:219], 0
v_exp_f32 v201, v201
v_mfma_f32_16x16x32_bf16 v[60:63], a[220:223], v[216:219], 0
v_exp_f32 v202, v202
v_mfma_f32_16x16x32_bf16 a[224:227], a[236:239], v[216:219], 0
v_exp_f32 v203, v203
v_exp_f32 v204, v204
v_exp_f32 v205, v205
v_exp_f32 v206, v206
v_exp_f32 v207, v207
v_cvt_pk_bf16_f32 v220, v200, v201
v_cvt_pk_bf16_f32 v221, v202, v203
v_cvt_pk_bf16_f32 v222, v204, v205
v_cvt_pk_bf16_f32 v223, v206, v207
s_nop 1
v_mfma_f32_16x16x32_bf16 v[64:67], a[160:163], v[220:223], 0
v_max3_f32 v234, v208, v209, v210
v_max3_f32 v235, v212, v213, v214
v_mfma_f32_16x16x32_bf16 v[68:71], a[164:167], v[220:223], 0
v_max3_f32 v234, v234, v211, v215
v_max_f32 v234, v234, v235
v_mfma_f32_16x16x32_bf16 v[72:75], a[168:171], v[220:223], 0
v_mov_b32 v235, v234
s_nop 1
v_mfma_f32_16x16x32_bf16 v[76:79], a[172:175], v[220:223], 0
v_permlane32_swap_b32 v234, v235
s_nop 1
v_mfma_f32_16x16x32_bf16 v[80:83], a[176:179], v[220:223], 0
v_max_f32 v234, v234, v235
v_mov_b32 v235, v234
v_mfma_f32_16x16x32_bf16 v[84:87], a[180:183], v[220:223], 0
s_nop 1
v_permlane16_swap_b32 v234, v235
v_mfma_f32_16x16x32_bf16 v[88:91], a[184:187], v[220:223], 0
s_nop 1
v_max_f32 v234, v234, v235
v_mfma_f32_16x16x32_bf16 v[92:95], a[188:191], v[220:223], 0
v_mul_f32 v232, s32, v234
v_add_f32 v233, s34, v234
v_mfma_f32_16x16x32_bf16 v[96:99], a[192:195], v[220:223], 0
v_sub_f32 v232, 0, v232
v_fma_f32 v208, v208, s32, v232
v_mfma_f32_16x16x32_bf16 v[100:103], a[196:199], v[220:223], 0
v_fma_f32 v209, v209, s32, v232
v_fma_f32 v210, v210, s32, v232
v_mfma_f32_16x16x32_bf16 v[104:107], a[200:203], v[220:223], 0
v_fma_f32 v211, v211, s32, v232
v_fma_f32 v212, v212, s32, v232
v_mfma_f32_16x16x32_bf16 v[108:111], a[204:207], v[220:223], 0
v_fma_f32 v213, v213, s32, v232
v_fma_f32 v214, v214, s32, v232
v_mfma_f32_16x16x32_bf16 v[112:115], a[208:211], v[220:223], 0
v_fma_f32 v215, v215, s32, v232
v_add_u32 v248, s38, v250
v_mfma_f32_16x16x32_bf16 v[116:119], a[212:215], v[220:223], 0
s_waitcnt vmcnt(9)
s_barrier
ds_read_b128 a[96:99], v249 offset:0
v_mfma_f32_16x16x32_bf16 v[120:123], a[216:219], v[220:223], 0
ds_read_b128 a[100:103], v249 offset:8448
v_mfma_f32_16x16x32_bf16 v[124:127], a[220:223], v[220:223], 0
ds_read_b128 a[104:107], v249 offset:64
v_mfma_f32_16x16x32_bf16 a[228:231], a[236:239], v[220:223], 0
ds_read_b128 a[108:111], v249 offset:8512
v_exp_f32 v208, v208
v_exp_f32 v209, v209
v_exp_f32 v210, v210
v_exp_f32 v211, v211
v_exp_f32 v212, v212
v_exp_f32 v213, v213
v_exp_f32 v214, v214
v_exp_f32 v215, v215
v_cvt_pk_bf16_f32 v224, v208, v209
v_cvt_pk_bf16_f32 v225, v210, v211
v_cvt_pk_bf16_f32 v226, v212, v213
v_cvt_pk_bf16_f32 v227, v214, v215
s_nop 1
v_mfma_f32_16x16x32_bf16 v[128:131], a[160:163], v[224:227], 0
ds_read_b128 a[112:115], v249 offset:128
v_mfma_f32_16x16x32_bf16 v[132:135], a[164:167], v[224:227], 0
ds_read_b128 a[116:119], v249 offset:8576
v_mfma_f32_16x16x32_bf16 v[136:139], a[168:171], v[224:227], 0
ds_read_b128 a[120:123], v249 offset:192
v_mfma_f32_16x16x32_bf16 v[140:143], a[172:175], v[224:227], 0
ds_read_b128 a[124:127], v249 offset:8640
v_mfma_f32_16x16x32_bf16 v[144:147], a[176:179], v[224:227], 0
ds_read_b128 a[128:131], v249 offset:256
v_mfma_f32_16x16x32_bf16 v[148:151], a[180:183], v[224:227], 0
ds_read_b128 a[132:135], v249 offset:8704
v_mfma_f32_16x16x32_bf16 v[152:155], a[184:187], v[224:227], 0
ds_read_b128 a[136:139], v249 offset:320
v_mfma_f32_16x16x32_bf16 v[156:159], a[188:191], v[224:227], 0
ds_read_b128 a[140:143], v249 offset:8768
v_mfma_f32_16x16x32_bf16 v[160:163], a[192:195], v[224:227], 0
ds_read_b128 a[144:147], v249 offset:384
v_mfma_f32_16x16x32_bf16 v[164:167], a[196:199], v[224:227], 0
ds_read_b128 a[148:151], v249 offset:8832
v_mfma_f32_16x16x32_bf16 v[168:171], a[200:203], v[224:227], 0
ds_read_b128 a[152:155], v249 offset:448
v_mfma_f32_16x16x32_bf16 v[172:175], a[204:207], v[224:227], 0
ds_read_b128 a[156:159], v249 offset:8896
s_add_u32 s38, s38, 33792
s_cmp_ge_u32 s38, 135168
s_cselect_b32 s38, 0, s38
v_mfma_f32_16x16x32_bf16 v[176:179], a[208:211], v[224:227], 0
v_mfma_f32_16x16x32_bf16 v[180:183], a[212:215], v[224:227], 0
v_mfma_f32_16x16x32_bf16 v[184:187], a[216:219], v[224:227], 0
v_mfma_f32_16x16x32_bf16 v[188:191], a[220:223], v[224:227], 0
v_mfma_f32_16x16x32_bf16 a[232:235], a[236:239], v[224:227], 0
s_waitcnt vmcnt(0)
v_and_b32 v247, s41, v245
v_cmp_ne_u32 vcc, s41, v247
s_cbranch_vccz L_dpoll_ok
s_mov_b32 s35, 0
L_dpoll:
buffer_load_dword v245, v243, s[92:95], s97 offen sc1
s_waitcnt vmcnt(0)
v_and_b32 v247, s41, v245
v_cmp_ne_u32 vcc, s41, v247
s_add_u32 s35, s35, 1
s_cbranch_vccz L_dpoll_ok
s_sleep 2
s_cmp_lt_u32 s35, 0x200000
s_cbranch_scc1 L_dpoll
L_dpoll_ok:
s_lshr_b32 s40, s83, 2
s_and_b32 s40, s40, 7
v_readlane_b32 s40, v245, s40
s_and_b32 s41, s83, 2
s_lshl_b32 s41, s41, 3
s_lshr_b32 s40, s40, s41
s_lshr_b32 s41, s40, 8
s_xor_b32 s40, s40, s41
s_and_b32 s40, s40, 0xff
v_mov_b32 v247, s40
v_mov_b32 v246, 143344
ds_write_b32 v246, v247
s_mov_b32 s35, 1
L_loop0:
s_waitcnt lgkmcnt(6)
v_mfma_f32_16x16x32_bf16 v[192:195], a[96:99], a[0:3], 0
ds_read_b64_tr_b16 a[160:161], v248 offset:16896
v_mfma_f32_16x16x32_bf16 v[196:199], a[100:103], a[0:3], 0
ds_read_b64_tr_b16 a[162:163], v248 offset:25344
v_mfma_f32_16x16x32_bf16 v[192:195], a[104:107], a[4:7], v[192:195]
ds_read_b64_tr_b16 a[164:165], v248 offset:16928
v_mfma_f32_16x16x32_bf16 v[196:199], a[108:111], a[4:7], v[196:199]
ds_read_b64_tr_b16 a[166:167], v248 offset:25376
v_mfma_f32_16x16x32_bf16 v[192:195], a[112:115], a[8:11], v[192:195]
ds_read_b64_tr_b16 a[168:169], v248 offset:16960
v_mfma_f32_16x16x32_bf16 v[196:199], a[116:119], a[8:11], v[196:199]
ds_read_b64_tr_b16 a[170:171], v248 offset:25408
v_mfma_f32_16x16x32_bf16 v[192:195], a[120:123], a[12:15], v[192:195]
ds_read_b64_tr_b16 a[172:173], v248 offset:16992
v_mfma_f32_16x16x32_bf16 v[196:199], a[124:127], a[12:15], v[196:199]
ds_read_b64_tr_b16 a[174:175], v248 offset:25440
v_mfma_f32_16x16x32_bf16 v[192:195], a[128:131], a[16:19], v[192:195]
ds_read_b64_tr_b16 a[176:177], v248 offset:17024
v_mfma_f32_16x16x32_bf16 v[196:199], a[132:135], a[16:19], v[196:199]
ds_read_b64_tr_b16 a[178:179], v248 offset:25472
s_waitcnt lgkmcnt(10)
v_mfma_f32_16x16x32_bf16 v[192:195], a[136:139], a[20:23], v[192:195]
ds_read_b64_tr_b16 a[180:181], v248 offset:17056
v_mfma_f32_16x16x32_bf16 v[196:199], a[140:143], a[20:23], v[196:199]
ds_read_b64_tr_b16 a[182:183], v248 offset:25504
v_mfma_f32_16x16x32_bf16 v[192:195], a[144:147], a[24:27], v[192:195]
ds_read_b64_tr_b16 a[184:185], v248 offset:17088
v_mfma_f32_16x16x32_bf16 v[196:199], a[148:151], a[24:27], v[196:199]
ds_read_b64_tr_b16 a[186:187], v248 offset:25536
v_mfma_f32_16x16x32_bf16 v[192:195], a[152:155], a[28:31], v[192:195]
ds_read_b64_tr_b16 a[188:189], v248 offset:17120
v_mfma_f32_16x16x32_bf16 v[196:199], a[156:159], a[28:31], v[196:199]
ds_read_b64_tr_b16 a[190:191], v248 offset:25568
v_mfma_f32_16x16x32_bf16 v[200:203], a[96:99], a[32:35], 0
ds_read_b64_tr_b16 a[192:193], v248 offset:17152
v_mfma_f32_16x16x32_bf16 v[204:207], a[100:103], a[32:35], 0
ds_read_b64_tr_b16 a[194:195], v248 offset:25600
v_mfma_f32_16x16x32_bf16 v[200:203], a[104:107], a[36:39], v[200:203]
ds_read_b64_tr_b16 a[196:197], v248 offset:17184
v_mfma_f32_16x16x32_bf16 v[204:207], a[108:111], a[36:39], v[204:207]
ds_read_b64_tr_b16 a[198:199], v248 offset:25632
v_max3_f32 v234, v192, v193, v194
v_mfma_f32_16x16x32_bf16 v[200:203], a[112:115], a[40:43], v[200:203]
ds_read_b64_tr_b16 a[200:201], v248 offset:17216
v_max3_f32 v235, v196, v197, v198
v_mfma_f32_16x16x32_bf16 v[204:207], a[116:119], a[40:43], v[204:207]
ds_read_b64_tr_b16 a[202:203], v248 offset:25664
v_max3_f32 v234, v234, v195, v199
v_mfma_f32_16x16x32_bf16 v[200:203], a[120:123], a[44:47], v[200:203]
ds_read_b64_tr_b16 a[204:205], v248 offset:17248
v_max_f32 v234, v234, v235
v_mfma_f32_16x16x32_bf16 v[204:207], a[124:127], a[44:47], v[204:207]
ds_read_b64_tr_b16 a[206:207], v248 offset:25696
v_cmp_gt_f32 vcc, v234, v229
s_cbranch_vccnz L_rare0_0
L_ret0_0:
v_mfma_f32_16x16x32_bf16 v[200:203], a[128:131], a[48:51], v[200:203]
ds_read_b64_tr_b16 a[208:209], v248 offset:17280
v_fma_f32 v192, v192, s32, v228
v_mfma_f32_16x16x32_bf16 v[204:207], a[132:135], a[48:51], v[204:207]
ds_read_b64_tr_b16 a[210:211], v248 offset:25728
v_fma_f32 v193, v193, s32, v228
v_mfma_f32_16x16x32_bf16 v[200:203], a[136:139], a[52:55], v[200:203]
ds_read_b64_tr_b16 a[212:213], v248 offset:17312
v_fma_f32 v194, v194, s32, v228
v_mfma_f32_16x16x32_bf16 v[204:207], a[140:143], a[52:55], v[204:207]
ds_read_b64_tr_b16 a[214:215], v248 offset:25760
v_fma_f32 v195, v195, s32, v228
v_mfma_f32_16x16x32_bf16 v[200:203], a[144:147], a[56:59], v[200:203]
ds_read_b64_tr_b16 a[216:217], v248 offset:17344
v_fma_f32 v196, v196, s32, v228
v_mfma_f32_16x16x32_bf16 v[204:207], a[148:151], a[56:59], v[204:207]
ds_read_b64_tr_b16 a[218:219], v248 offset:25792
v_fma_f32 v197, v197, s32, v228
v_mfma_f32_16x16x32_bf16 v[200:203], a[152:155], a[60:63], v[200:203]
ds_read_b64_tr_b16 a[220:221], v248 offset:17376
v_fma_f32 v198, v198, s32, v228
v_mfma_f32_16x16x32_bf16 v[204:207], a[156:159], a[60:63], v[204:207]
ds_read_b64_tr_b16 a[222:223], v248 offset:25824
v_fma_f32 v199, v199, s32, v228
v_mfma_f32_16x16x32_bf16 v[208:211], a[96:99], a[64:67], 0
v_exp_f32 v192, v192
v_mfma_f32_16x16x32_bf16 v[212:215], a[100:103], a[64:67], 0
v_exp_f32 v193, v193
v_mfma_f32_16x16x32_bf16 v[208:211], a[104:107], a[68:71], v[208:211]
v_exp_f32 v194, v194
v_mfma_f32_16x16x32_bf16 v[212:215], a[108:111], a[68:71], v[212:215]
v_exp_f32 v195, v195
v_mfma_f32_16x16x32_bf16 v[208:211], a[112:115], a[72:75], v[208:211]
v_exp_f32 v196, v196
v_mfma_f32_16x16x32_bf16 v[212:215], a[116:119], a[72:75], v[212:215]
v_exp_f32 v197, v197
v_mfma_f32_16x16x32_bf16 v[208:211], a[120:123], a[76:79], v[208:211]
v_exp_f32 v198, v198
v_mfma_f32_16x16x32_bf16 v[212:215], a[124:127], a[76:79], v[212:215]
v_exp_f32 v199, v199
v_mfma_f32_16x16x32_bf16 v[208:211], a[128:131], a[80:83], v[208:211]
v_cvt_pk_bf16_f32 v216, v192, v193
v_cvt_pk_bf16_f32 v217, v194, v195
v_mfma_f32_16x16x32_bf16 v[212:215], a[132:135], a[80:83], v[212:215]
v_cvt_pk_bf16_f32 v218, v196, v197
v_cvt_pk_bf16_f32 v219, v198, v199
v_mfma_f32_16x16x32_bf16 v[208:211], a[136:139], a[84:87], v[208:211]
v_max3_f32 v236, v200, v201, v202
v_max3_f32 v237, v204, v205, v206
v_mfma_f32_16x16x32_bf16 v[212:215], a[140:143], a[84:87], v[212:215]
v_max3_f32 v236, v236, v203, v207
v_max_f32 v236, v236, v237
v_mfma_f32_16x16x32_bf16 v[208:211], a[144:147], a[88:91], v[208:211]
v_cmp_gt_f32 vcc, v236, v231
s_cbranch_vccnz L_rare0_1
L_ret0_1:
v_fma_f32 v200, v200, s32, v230
v_mfma_f32_16x16x32_bf16 v[212:215], a[148:151], a[88:91], v[212:215]
v_fma_f32 v201, v201, s32, v230
v_fma_f32 v202, v202, s32, v230
v_mfma_f32_16x16x32_bf16 v[208:211], a[152:155], a[92:95], v[208:211]
v_fma_f32 v203, v203, s32, v230
v_fma_f32 v204, v204, s32, v230
v_mfma_f32_16x16x32_bf16 v[212:215], a[156:159], a[92:95], v[212:215]
v_fma_f32 v205, v205, s32, v230
v_fma_f32 v206, v206, s32, v230
s_waitcnt lgkmcnt(0)
v_mfma_f32_16x16x32_bf16 v[0:3], a[160:163], v[216:219], v[0:3]
v_fma_f32 v207, v207, s32, v230
v_add_u32 v249, s38, v251
v_mfma_f32_16x16x32_bf16 v[4:7], a[164:167], v[216:219], v[4:7]
v_exp_f32 v200, v200
v_mfma_f32_16x16x32_bf16 v[8:11], a[168:171], v[216:219], v[8:11]
v_exp_f32 v201, v201
v_mfma_f32_16x16x32_bf16 v[12:15], a[172:175], v[216:219], v[12:15]
v_exp_f32 v202, v202
v_mfma_f32_16x16x32_bf16 v[16:19], a[176:179], v[216:219], v[16:19]
v_exp_f32 v203, v203
v_mfma_f32_16x16x32_bf16 v[20:23], a[180:183], v[216:219], v[20:23]
v_exp_f32 v204, v204
v_mfma_f32_16x16x32_bf16 v[24:27], a[184:187], v[216:219], v[24:27]
v_exp_f32 v205, v205
v_mfma_f32_16x16x32_bf16 v[28:31], a[188:191], v[216:219], v[28:31]
v_exp_f32 v206, v206
v_mfma_f32_16x16x32_bf16 v[32:35], a[192:195], v[216:219], v[32:35]
v_exp_f32 v207, v207
v_mfma_f32_16x16x32_bf16 v[36:39], a[196:199], v[216:219], v[36:39]
v_cvt_pk_bf16_f32 v220, v200, v201
v_cvt_pk_bf16_f32 v221, v202, v203
v_mfma_f32_16x16x32_bf16 v[40:43], a[200:203], v[216:219], v[40:43]
v_cvt_pk_bf16_f32 v222, v204, v205
v_cvt_pk_bf16_f32 v223, v206, v207
v_mfma_f32_16x16x32_bf16 v[44:47], a[204:207], v[216:219], v[44:47]
v_max3_f32 v234, v208, v209, v210
v_max3_f32 v235, v212, v213, v214
v_mfma_f32_16x16x32_bf16 v[48:51], a[208:211], v[216:219], v[48:51]
v_max3_f32 v234, v234, v211, v215
v_max_f32 v234, v234, v235
v_mfma_f32_16x16x32_bf16 v[52:55], a[212:215], v[216:219], v[52:55]
v_cmp_gt_f32 vcc, v234, v233
s_cbranch_vccnz L_rare0_2
L_ret0_2:
v_fma_f32 v208, v208, s32, v232
v_mfma_f32_16x16x32_bf16 v[56:59], a[216:219], v[216:219], v[56:59]
v_fma_f32 v209, v209, s32, v232
v_fma_f32 v210, v210, s32, v232
v_mfma_f32_16x16x32_bf16 v[60:63], a[220:223], v[216:219], v[60:63]
v_fma_f32 v211, v211, s32, v232
v_fma_f32 v212, v212, s32, v232
v_mfma_f32_16x16x32_bf16 a[224:227], a[236:239], v[216:219], a[224:227]
v_fma_f32 v213, v213, s32, v232
v_fma_f32 v214, v214, s32, v232
v_mfma_f32_16x16x32_bf16 v[64:67], a[160:163], v[220:223], v[64:67]
v_fma_f32 v215, v215, s32, v232
v_add_u32 v248, s38, v250
v_mfma_f32_16x16x32_bf16 v[68:71], a[164:167], v[220:223], v[68:71]
v_exp_f32 v208, v208
v_mfma_f32_16x16x32_bf16 v[72:75], a[168:171], v[220:223], v[72:75]
v_exp_f32 v209, v209
v_mfma_f32_16x16x32_bf16 v[76:79], a[172:175], v[220:223], v[76:79]
v_exp_f32 v210, v210
v_mfma_f32_16x16x32_bf16 v[80:83], a[176:179], v[220:223], v[80:83]
v_exp_f32 v211, v211
v_mfma_f32_16x16x32_bf16 v[84:87], a[180:183], v[220:223], v[84:87]
v_exp_f32 v212, v212
v_mfma_f32_16x16x32_bf16 v[88:91], a[184:187], v[220:223], v[88:91]
v_exp_f32 v213, v213
v_mfma_f32_16x16x32_bf16 v[92:95], a[188:191], v[220:223], v[92:95]
v_exp_f32 v214, v214
v_mfma_f32_16x16x32_bf16 v[96:99], a[192:195], v[220:223], v[96:99]
v_exp_f32 v215, v215
v_mfma_f32_16x16x32_bf16 v[100:103], a[196:199], v[220:223], v[100:103]
v_cvt_pk_bf16_f32 v224, v208, v209
v_cvt_pk_bf16_f32 v225, v210, v211
v_mfma_f32_16x16x32_bf16 v[104:107], a[200:203], v[220:223], v[104:107]
v_cvt_pk_bf16_f32 v226, v212, v213
v_cvt_pk_bf16_f32 v227, v214, v215
v_mfma_f32_16x16x32_bf16 v[108:111], a[204:207], v[220:223], v[108:111]
v_mfma_f32_16x16x32_bf16 v[112:115], a[208:211], v[220:223], v[112:115]
v_mfma_f32_16x16x32_bf16 v[116:119], a[212:215], v[220:223], v[116:119]
s_barrier
ds_read_b128 a[96:99], v249 offset:0
v_mfma_f32_16x16x32_bf16 v[120:123], a[216:219], v[220:223], v[120:123]
ds_read_b128 a[100:103], v249 offset:8448
v_mfma_f32_16x16x32_bf16 v[124:127], a[220:223], v[220:223], v[124:127]
ds_read_b128 a[104:107], v249 offset:64
v_mfma_f32_16x16x32_bf16 a[228:231], a[236:239], v[220:223], a[228:231]
ds_read_b128 a[108:111], v249 offset:8512
v_mfma_f32_16x16x32_bf16 v[128:131], a[160:163], v[224:227], v[128:131]
ds_read_b128 a[112:115], v249 offset:128
v_mfma_f32_16x16x32_bf16 v[132:135], a[164:167], v[224:227], v[132:135]
ds_read_b128 a[116:119], v249 offset:8576
v_mfma_f32_16x16x32_bf16 v[136:139], a[168:171], v[224:227], v[136:139]
ds_read_b128 a[120:123], v249 offset:192
v_mfma_f32_16x16x32_bf16 v[140:143], a[172:175], v[224:227], v[140:143]
ds_read_b128 a[124:127], v249 offset:8640
v_mfma_f32_16x16x32_bf16 v[144:147], a[176:179], v[224:227], v[144:147]
ds_read_b128 a[128:131], v249 offset:256
v_mfma_f32_16x16x32_bf16 v[148:151], a[180:183], v[224:227], v[148:151]
ds_read_b128 a[132:135], v249 offset:8704
v_mfma_f32_16x16x32_bf16 v[152:155], a[184:187], v[224:227], v[152:155]
ds_read_b128 a[136:139], v249 offset:320
v_mfma_f32_16x16x32_bf16 v[156:159], a[188:191], v[224:227], v[156:159]
ds_read_b128 a[140:143], v249 offset:8768
v_mfma_f32_16x16x32_bf16 v[160:163], a[192:195], v[224:227], v[160:163]
ds_read_b128 a[144:147], v249 offset:384
v_mfma_f32_16x16x32_bf16 v[164:167], a[196:199], v[224:227], v[164:167]
ds_read_b128 a[148:151], v249 offset:8832
v_mfma_f32_16x16x32_bf16 v[168:171], a[200:203], v[224:227], v[168:171]
ds_read_b128 a[152:155], v249 offset:448
v_mfma_f32_16x16x32_bf16 v[172:175], a[204:207], v[224:227], v[172:175]
ds_read_b128 a[156:159], v249 offset:8896
s_add_u32 s38, s38, 33792
s_cmp_ge_u32 s38, 135168
s_cselect_b32 s38, 0, s38
v_mfma_f32_16x16x32_bf16 v[176:179], a[208:211], v[224:227], v[176:179]
s_add_u32 s35, s35, 1
v_mfma_f32_16x16x32_bf16 v[180:183], a[212:215], v[224:227], v[180:183]
s_cmp_lt_u32 s35, 32
v_mfma_f32_16x16x32_bf16 v[184:187], a[216:219], v[224:227], v[184:187]
v_mfma_f32_16x16x32_bf16 v[188:191], a[220:223], v[224:227], v[188:191]
v_mfma_f32_16x16x32_bf16 a[232:235], a[236:239], v[224:227], a[232:235]
s_cbranch_scc1 L_loop0
v_mov_b32 v246, 143344
ds_read_b32 v247, v246
v_mov_b32 v250, 61440
v_mov_b32 v238, s96
v_cmp_eq_u32 vcc, 0, v255
v_lshlrev_b32 v242, 4, v255
v_lshlrev_b32 v241, 3, v255
s_lshl_b32 s85, s3, 13
s_lshl_b32 s86, s3, 9
s_add_u32 s86, s86, 40960
s_mov_b32 s87, 32768
s_mov_b32 s88, 43008
v_add_u32 v240, 143360, v242
v_add_u32 v252, 159744, v241
v_cndmask_b32 v250, v250, v238, vcc
buffer_load_dword v245, v250, s[12:15], 0 offen sc1
s_waitcnt lgkmcnt(0)
v_readfirstlane_b32 s38, v247
s_mov_b32 s38, 1
s_cmp_eq_u32 s38, 0
s_cbranch_scc1 L_loc0
v_sub_f32 v192, 0, v230
v_accvgpr_read_b32 v193, a228
v_cvt_pk_bf16_f32 v64, v64, v65
v_cvt_pk_bf16_f32 v65, v66, v67
v_cvt_pk_bf16_f32 v66, v68, v69
v_cvt_pk_bf16_f32 v67, v70, v71
buffer_store_dwordx4 v[64:67], v242, s[28:31], s85 offen offset:0 sc1
v_cvt_pk_bf16_f32 v68, v72, v73
v_cvt_pk_bf16_f32 v69, v74, v75
v_cvt_pk_bf16_f32 v70, v76, v77
v_cvt_pk_bf16_f32 v71, v78, v79
buffer_store_dwordx4 v[68:71], v242, s[28:31], s85 offen offset:1024 sc1
v_cvt_pk_bf16_f32 v72, v80, v81
v_cvt_pk_bf16_f32 v73, v82, v83
v_cvt_pk_bf16_f32 v74, v84, v85
v_cvt_pk_bf16_f32 v75, v86, v87
buffer_store_dwordx4 v[72:75], v242, s[28:31], s85 offen offset:2048 sc1
v_cvt_pk_bf16_f32 v76, v88, v89
v_cvt_pk_bf16_f32 v77, v90, v91
v_cvt_pk_bf16_f32 v78, v92, v93
v_cvt_pk_bf16_f32 v79, v94, v95
buffer_store_dwordx4 v[76:79], v242, s[28:31], s85 offen offset:3072 sc1
v_cvt_pk_bf16_f32 v80, v96, v97
v_cvt_pk_bf16_f32 v81, v98, v99
v_cvt_pk_bf16_f32 v82, v100, v101
v_cvt_pk_bf16_f32 v83, v102, v103
s_add_u32 s40, s85, 4096
buffer_store_dwordx4 v[80:83], v242, s[28:31], s40 offen offset:0 sc1
v_cvt_pk_bf16_f32 v84, v104, v105
v_cvt_pk_bf16_f32 v85, v106, v107
v_cvt_pk_bf16_f32 v86, v108, v109
v_cvt_pk_bf16_f32 v87, v110, v111
buffer_store_dwordx4 v[84:87], v242, s[28:31], s40 offen offset:1024 sc1
v_cvt_pk_bf16_f32 v88, v112, v113
v_cvt_pk_bf16_f32 v89, v114, v115
v_cvt_pk_bf16_f32 v90, v116, v117
v_cvt_pk_bf16_f32 v91, v118, v119
buffer_store_dwordx4 v[88:91], v242, s[28:31], s40 offen offset:2048 sc1
v_cvt_pk_bf16_f32 v92, v120, v121
v_cvt_pk_bf16_f32 v93, v122, v123
v_cvt_pk_bf16_f32 v94, v124, v125
v_cvt_pk_bf16_f32 v95, v126, v127
buffer_store_dwordx4 v[92:95], v242, s[28:31], s40 offen offset:3072 sc1
buffer_store_dwordx2 v[192:193], v241, s[28:31], s86 offen sc1
v_sub_f32 v194, 0, v232
v_accvgpr_read_b32 v195, a232
v_cvt_pk_bf16_f32 v96, v128, v129
v_cvt_pk_bf16_f32 v97, v130, v131
v_cvt_pk_bf16_f32 v98, v132, v133
v_cvt_pk_bf16_f32 v99, v134, v135
buffer_store_dwordx4 v[96:99], v242, s[28:31], s87 offen offset:0 sc1
v_cvt_pk_bf16_f32 v100, v136, v137
v_cvt_pk_bf16_f32 v101, v138, v139
v_cvt_pk_bf16_f32 v102, v140, v141
v_cvt_pk_bf16_f32 v103, v142, v143
buffer_store_dwordx4 v[100:103], v242, s[28:31], s87 offen offset:1024 sc1
v_cvt_pk_bf16_f32 v104, v144, v145
v_cvt_pk_bf16_f32 v105, v146, v147
v_cvt_pk_bf16_f32 v106, v148, v149
v_cvt_pk_bf16_f32 v107, v150, v151
buffer_store_dwordx4 v[104:107], v242, s[28:31], s87 offen offset:2048 sc1
v_cvt_pk_bf16_f32 v108, v152, v153
v_cvt_pk_bf16_f32 v109, v154, v155
v_cvt_pk_bf16_f32 v110, v156, v157
v_cvt_pk_bf16_f32 v111, v158, v159
buffer_store_dwordx4 v[108:111], v242, s[28:31], s87 offen offset:3072 sc1
v_cvt_pk_bf16_f32 v112, v160, v161
v_cvt_pk_bf16_f32 v113, v162, v163
v_cvt_pk_bf16_f32 v114, v164, v165
v_cvt_pk_bf16_f32 v115, v166, v167
s_add_u32 s40, s87, 4096
buffer_store_dwordx4 v[112:115], v242, s[28:31], s40 offen offset:0 sc1
v_cvt_pk_bf16_f32 v116, v168, v169
v_cvt_pk_bf16_f32 v117, v170, v171
v_cvt_pk_bf16_f32 v118, v172, v173
v_cvt_pk_bf16_f32 v119, v174, v175
buffer_store_dwordx4 v[116:119], v242, s[28:31], s40 offen offset:1024 sc1
v_cvt_pk_bf16_f32 v120, v176, v177
v_cvt_pk_bf16_f32 v121, v178, v179
v_cvt_pk_bf16_f32 v122, v180, v181
v_cvt_pk_bf16_f32 v123, v182, v183
buffer_store_dwordx4 v[120:123], v242, s[28:31], s40 offen offset:2048 sc1
v_cvt_pk_bf16_f32 v124, v184, v185
v_cvt_pk_bf16_f32 v125, v186, v187
v_cvt_pk_bf16_f32 v126, v188, v189
v_cvt_pk_bf16_f32 v127, v190, v191
buffer_store_dwordx4 v[124:127], v242, s[28:31], s40 offen offset:3072 sc1
buffer_store_dwordx2 v[194:195], v241, s[28:31], s88 offen sc1
s_branch L_sent0
L_loc0:
v_sub_f32 v192, 0, v230
v_accvgpr_read_b32 v193, a228
v_cvt_pk_bf16_f32 v64, v64, v65
v_cvt_pk_bf16_f32 v65, v66, v67
v_cvt_pk_bf16_f32 v66, v68, v69
v_cvt_pk_bf16_f32 v67, v70, v71
buffer_store_dwordx4 v[64:67], v242, s[28:31], s85 offen offset:0
v_cvt_pk_bf16_f32 v68, v72, v73
v_cvt_pk_bf16_f32 v69, v74, v75
v_cvt_pk_bf16_f32 v70, v76, v77
v_cvt_pk_bf16_f32 v71, v78, v79
buffer_store_dwordx4 v[68:71], v242, s[28:31], s85 offen offset:1024
v_cvt_pk_bf16_f32 v72, v80, v81
v_cvt_pk_bf16_f32 v73, v82, v83
v_cvt_pk_bf16_f32 v74, v84, v85
v_cvt_pk_bf16_f32 v75, v86, v87
buffer_store_dwordx4 v[72:75], v242, s[28:31], s85 offen offset:2048
v_cvt_pk_bf16_f32 v76, v88, v89
v_cvt_pk_bf16_f32 v77, v90, v91
v_cvt_pk_bf16_f32 v78, v92, v93
v_cvt_pk_bf16_f32 v79, v94, v95
buffer_store_dwordx4 v[76:79], v242, s[28:31], s85 offen offset:3072
v_cvt_pk_bf16_f32 v80, v96, v97
v_cvt_pk_bf16_f32 v81, v98, v99
v_cvt_pk_bf16_f32 v82, v100, v101
v_cvt_pk_bf16_f32 v83, v102, v103
s_add_u32 s40, s85, 4096
buffer_store_dwordx4 v[80:83], v242, s[28:31], s40 offen offset:0
v_cvt_pk_bf16_f32 v84, v104, v105
v_cvt_pk_bf16_f32 v85, v106, v107
v_cvt_pk_bf16_f32 v86, v108, v109
v_cvt_pk_bf16_f32 v87, v110, v111
buffer_store_dwordx4 v[84:87], v242, s[28:31], s40 offen offset:1024
v_cvt_pk_bf16_f32 v88, v112, v113
v_cvt_pk_bf16_f32 v89, v114, v115
v_cvt_pk_bf16_f32 v90, v116, v117
v_cvt_pk_bf16_f32 v91, v118, v119
buffer_store_dwordx4 v[88:91], v242, s[28:31], s40 offen offset:2048
v_cvt_pk_bf16_f32 v92, v120, v121
v_cvt_pk_bf16_f32 v93, v122, v123
v_cvt_pk_bf16_f32 v94, v124, v125
v_cvt_pk_bf16_f32 v95, v126, v127
buffer_store_dwordx4 v[92:95], v242, s[28:31], s40 offen offset:3072
buffer_store_dwordx2 v[192:193], v241, s[28:31], s86 offen
v_sub_f32 v194, 0, v232
v_accvgpr_read_b32 v195, a232
v_cvt_pk_bf16_f32 v96, v128, v129
v_cvt_pk_bf16_f32 v97, v130, v131
v_cvt_pk_bf16_f32 v98, v132, v133
v_cvt_pk_bf16_f32 v99, v134, v135
buffer_store_dwordx4 v[96:99], v242, s[28:31], s87 offen offset:0
v_cvt_pk_bf16_f32 v100, v136, v137
v_cvt_pk_bf16_f32 v101, v138, v139
v_cvt_pk_bf16_f32 v102, v140, v141
v_cvt_pk_bf16_f32 v103, v142, v143
buffer_store_dwordx4 v[100:103], v242, s[28:31], s87 offen offset:1024
v_cvt_pk_bf16_f32 v104, v144, v145
v_cvt_pk_bf16_f32 v105, v146, v147
v_cvt_pk_bf16_f32 v106, v148, v149
v_cvt_pk_bf16_f32 v107, v150, v151
buffer_store_dwordx4 v[104:107], v242, s[28:31], s87 offen offset:2048
v_cvt_pk_bf16_f32 v108, v152, v153
v_cvt_pk_bf16_f32 v109, v154, v155
v_cvt_pk_bf16_f32 v110, v156, v157
v_cvt_pk_bf16_f32 v111, v158, v159
buffer_store_dwordx4 v[108:111], v242, s[28:31], s87 offen offset:3072
v_cvt_pk_bf16_f32 v112, v160, v161
v_cvt_pk_bf16_f32 v113, v162, v163
v_cvt_pk_bf16_f32 v114, v164, v165
v_cvt_pk_bf16_f32 v115, v166, v167
s_add_u32 s40, s87, 4096
buffer_store_dwordx4 v[112:115], v242, s[28:31], s40 offen offset:0
v_cvt_pk_bf16_f32 v116, v168, v169
v_cvt_pk_bf16_f32 v117, v170, v171
v_cvt_pk_bf16_f32 v118, v172, v173
v_cvt_pk_bf16_f32 v119, v174, v175
buffer_store_dwordx4 v[116:119], v242, s[28:31], s40 offen offset:1024
v_cvt_pk_bf16_f32 v120, v176, v177
v_cvt_pk_bf16_f32 v121, v178, v179
v_cvt_pk_bf16_f32 v122, v180, v181
v_cvt_pk_bf16_f32 v123, v182, v183
buffer_store_dwordx4 v[120:123], v242, s[28:31], s40 offen offset:2048
v_cvt_pk_bf16_f32 v124, v184, v185
v_cvt_pk_bf16_f32 v125, v186, v187
v_cvt_pk_bf16_f32 v126, v188, v189
v_cvt_pk_bf16_f32 v127, v190, v191
buffer_store_dwordx4 v[124:127], v242, s[28:31], s40 offen offset:3072
buffer_store_dwordx2 v[194:195], v241, s[28:31], s88 offen
L_sent0:
ds_write_b128 v240, v[128:131] offset:0
ds_write_b128 v240, v[132:135] offset:1024
ds_write_b128 v240, v[136:139] offset:2048
ds_write_b128 v240, v[140:143] offset:3072
ds_write_b128 v240, v[144:147] offset:4096
ds_write_b128 v240, v[148:151] offset:5120
ds_write_b128 v240, v[152:155] offset:6144
ds_write_b128 v240, v[156:159] offset:7168
ds_write_b128 v240, v[160:163] offset:8192
ds_write_b128 v240, v[164:167] offset:9216
ds_write_b128 v240, v[168:171] offset:10240
ds_write_b128 v240, v[172:175] offset:11264
ds_write_b128 v240, v[176:179] offset:12288
ds_write_b128 v240, v[180:183] offset:13312
ds_write_b128 v240, v[184:187] offset:14336
ds_write_b128 v240, v[188:191] offset:15360
ds_write_b64 v252, v[194:195]
s_branch L_tail
L_type1:
s_xor_b64 s[8:9], s[4:5], s[8:9]
s_mul_i32 s40, s3, 24
s_sub_u32 s40, s40, 24
s_mov_b64 s[20:21], 0xffffff
s_lshl_b64 s[20:21], s[20:21], s40
s_mul_i32 s40, s3, 5120
s_sub_u32 s10, 20480, s40
s_cmp_eq_u32 s3, 2
s_cbranch_scc1 L_qw2
s_cmp_eq_u32 s3, 3
s_cbranch_scc1 L_qw3
v_accvgpr_write_b32 a8, v0
v_accvgpr_write_b32 a9, v1
v_accvgpr_write_b32 a10, v2
v_accvgpr_write_b32 a11, v3
v_accvgpr_write_b32 a12, v8
v_accvgpr_write_b32 a13, v9
v_accvgpr_write_b32 a14, v10
v_accvgpr_write_b32 a15, v11
v_accvgpr_write_b32 a16, v16
v_accvgpr_write_b32 a17, v17
v_accvgpr_write_b32 a18, v18
v_accvgpr_write_b32 a19, v19
v_accvgpr_write_b32 a20, v24
v_accvgpr_write_b32 a21, v25
v_accvgpr_write_b32 a22, v26
v_accvgpr_write_b32 a23, v27
v_accvgpr_write_b32 a24, v32
v_accvgpr_write_b32 a25, v33
v_accvgpr_write_b32 a26, v34
v_accvgpr_write_b32 a27, v35
v_accvgpr_write_b32 a28, v40
v_accvgpr_write_b32 a29, v41
v_accvgpr_write_b32 a30, v42
v_accvgpr_write_b32 a31, v43
v_accvgpr_write_b32 a0, v48
v_accvgpr_write_b32 a1, v49
v_accvgpr_write_b32 a2, v50
v_accvgpr_write_b32 a3, v51
v_accvgpr_write_b32 a4, v56
v_accvgpr_write_b32 a5, v57
v_accvgpr_write_b32 a6, v58
v_accvgpr_write_b32 a7, v59
v_accvgpr_write_b32 a40, v64
v_accvgpr_write_b32 a41, v65
v_accvgpr_write_b32 a42, v66
v_accvgpr_write_b32 a43, v67
v_accvgpr_write_b32 a44, v72
v_accvgpr_write_b32 a45, v73
v_accvgpr_write_b32 a46, v74
v_accvgpr_write_b32 a47, v75
v_accvgpr_write_b32 a48, v80
v_accvgpr_write_b32 a49, v81
v_accvgpr_write_b32 a50, v82
v_accvgpr_write_b32 a51, v83
v_accvgpr_write_b32 a52, v88
v_accvgpr_write_b32 a53, v89
v_accvgpr_write_b32 a54, v90
v_accvgpr_write_b32 a55, v91
v_accvgpr_write_b32 a56, v96
v_accvgpr_write_b32 a57, v97
v_accvgpr_write_b32 a58, v98
v_accvgpr_write_b32 a59, v99
v_accvgpr_write_b32 a60, v104
v_accvgpr_write_b32 a61, v105
v_accvgpr_write_b32 a62, v106
v_accvgpr_write_b32 a63, v107
v_accvgpr_write_b32 a32, v112
v_accvgpr_write_b32 a33, v113
v_accvgpr_write_b32 a34, v114
v_accvgpr_write_b32 a35, v115
v_accvgpr_write_b32 a36, v120
v_accvgpr_write_b32 a37, v121
v_accvgpr_write_b32 a38, v122
v_accvgpr_write_b32 a39, v123
s_branch L_qwd
L_qw2:
v_accvgpr_write_b32 a16, v0
v_accvgpr_write_b32 a17, v1
v_accvgpr_write_b32 a18, v2
v_accvgpr_write_b32 a19, v3
v_accvgpr_write_b32 a20, v8
v_accvgpr_write_b32 a21, v9
v_accvgpr_write_b32 a22, v10
v_accvgpr_write_b32 a23, v11
v_accvgpr_write_b32 a24, v16
v_accvgpr_write_b32 a25, v17
v_accvgpr_write_b32 a26, v18
v_accvgpr_write_b32 a27, v19
v_accvgpr_write_b32 a28, v24
v_accvgpr_write_b32 a29, v25
v_accvgpr_write_b32 a30, v26
v_accvgpr_write_b32 a31, v27
v_accvgpr_write_b32 a0, v32
v_accvgpr_write_b32 a1, v33
v_accvgpr_write_b32 a2, v34
v_accvgpr_write_b32 a3, v35
v_accvgpr_write_b32 a4, v40
v_accvgpr_write_b32 a5, v41
v_accvgpr_write_b32 a6, v42
v_accvgpr_write_b32 a7, v43
v_accvgpr_write_b32 a8, v48
v_accvgpr_write_b32 a9, v49
v_accvgpr_write_b32 a10, v50
v_accvgpr_write_b32 a11, v51
v_accvgpr_write_b32 a12, v56
v_accvgpr_write_b32 a13, v57
v_accvgpr_write_b32 a14, v58
v_accvgpr_write_b32 a15, v59
v_accvgpr_write_b32 a48, v64
v_accvgpr_write_b32 a49, v65
v_accvgpr_write_b32 a50, v66
v_accvgpr_write_b32 a51, v67
v_accvgpr_write_b32 a52, v72
v_accvgpr_write_b32 a53, v73
v_accvgpr_write_b32 a54, v74
v_accvgpr_write_b32 a55, v75
v_accvgpr_write_b32 a56, v80
v_accvgpr_write_b32 a57, v81
v_accvgpr_write_b32 a58, v82
v_accvgpr_write_b32 a59, v83
v_accvgpr_write_b32 a60, v88
v_accvgpr_write_b32 a61, v89
v_accvgpr_write_b32 a62, v90
v_accvgpr_write_b32 a63, v91
v_accvgpr_write_b32 a32, v96
v_accvgpr_write_b32 a33, v97
v_accvgpr_write_b32 a34, v98
v_accvgpr_write_b32 a35, v99
v_accvgpr_write_b32 a36, v104
v_accvgpr_write_b32 a37, v105
v_accvgpr_write_b32 a38, v106
v_accvgpr_write_b32 a39, v107
v_accvgpr_write_b32 a40, v112
v_accvgpr_write_b32 a41, v113
v_accvgpr_write_b32 a42, v114
v_accvgpr_write_b32 a43, v115
v_accvgpr_write_b32 a44, v120
v_accvgpr_write_b32 a45, v121
v_accvgpr_write_b32 a46, v122
v_accvgpr_write_b32 a47, v123
s_branch L_qwd
L_qw3:
v_accvgpr_write_b32 a24, v0
v_accvgpr_write_b32 a25, v1
v_accvgpr_write_b32 a26, v2
v_accvgpr_write_b32 a27, v3
v_accvgpr_write_b32 a28, v8
v_accvgpr_write_b32 a29, v9
v_accvgpr_write_b32 a30, v10
v_accvgpr_write_b32 a31, v11
v_accvgpr_write_b32 a0, v16
v_accvgpr_write_b32 a1, v17
v_accvgpr_write_b32 a2, v18
v_accvgpr_write_b32 a3, v19
v_accvgpr_write_b32 a4, v24
v_accvgpr_write_b32 a5, v25
v_accvgpr_write_b32 a6, v26
v_accvgpr_write_b32 a7, v27
v_accvgpr_write_b32 a8, v32
v_accvgpr_write_b32 a9, v33
v_accvgpr_write_b32 a10, v34
v_accvgpr_write_b32 a11, v35
v_accvgpr_write_b32 a12, v40
v_accvgpr_write_b32 a13, v41
v_accvgpr_write_b32 a14, v42
v_accvgpr_write_b32 a15, v43
v_accvgpr_write_b32 a16, v48
v_accvgpr_write_b32 a17, v49
v_accvgpr_write_b32 a18, v50
v_accvgpr_write_b32 a19, v51
v_accvgpr_write_b32 a20, v56
v_accvgpr_write_b32 a21, v57
v_accvgpr_write_b32 a22, v58
v_accvgpr_write_b32 a23, v59
v_accvgpr_write_b32 a56, v64
v_accvgpr_write_b32 a57, v65
v_accvgpr_write_b32 a58, v66
v_accvgpr_write_b32 a59, v67
v_accvgpr_write_b32 a60, v72
v_accvgpr_write_b32 a61, v73
v_accvgpr_write_b32 a62, v74
v_accvgpr_write_b32 a63, v75
v_accvgpr_write_b32 a32, v80
v_accvgpr_write_b32 a33, v81
v_accvgpr_write_b32 a34, v82
v_accvgpr_write_b32 a35, v83
v_accvgpr_write_b32 a36, v88
v_accvgpr_write_b32 a37, v89
v_accvgpr_write_b32 a38, v90
v_accvgpr_write_b32 a39, v91
v_accvgpr_write_b32 a40, v96
v_accvgpr_write_b32 a41, v97
v_accvgpr_write_b32 a42, v98
v_accvgpr_write_b32 a43, v99
v_accvgpr_write_b32 a44, v104
v_accvgpr_write_b32 a45, v105
v_accvgpr_write_b32 a46, v106
v_accvgpr_write_b32 a47, v107
v_accvgpr_write_b32 a48, v112
v_accvgpr_write_b32 a49, v113
v_accvgpr_write_b32 a50, v114
v_accvgpr_write_b32 a51, v115
v_accvgpr_write_b32 a52, v120
v_accvgpr_write_b32 a53, v121
v_accvgpr_write_b32 a54, v122
v_accvgpr_write_b32 a55, v123
L_qwd:
s_nop 1
s_waitcnt lgkmcnt(6)
v_mfma_f32_16x16x32_bf16 v[192:195], a[96:99], a[0:3], 0
ds_read_b64_tr_b16 a[160:161], v248 offset:16896
ds_read_b64_tr_b16 a[162:163], v248 offset:25344
s_add_u32 s41, s37, s39
s_add_u32 m0, s41, 0
s_nop 0
buffer_load_dwordx4 v246, s[4:7], s36 offen offset:0 nt lds
v_mfma_f32_16x16x32_bf16 v[196:199], a[100:103], a[0:3], 0
ds_read_b64_tr_b16 a[164:165], v248 offset:16928
ds_read_b64_tr_b16 a[166:167], v248 offset:25376
v_mfma_f32_16x16x32_bf16 v[192:195], a[104:107], a[4:7], v[192:195]
ds_read_b64_tr_b16 a[168:169], v248 offset:16960
ds_read_b64_tr_b16 a[170:171], v248 offset:25408
v_mfma_f32_16x16x32_bf16 v[196:199], a[108:111], a[4:7], v[196:199]
ds_read_b64_tr_b16 a[172:173], v248 offset:16992
ds_read_b64_tr_b16 a[174:175], v248 offset:25440
s_add_u32 m0, s41, 32
s_nop 0
buffer_load_dwordx4 v246, s[4:7], s36 offen offset:1024 nt lds
v_mfma_f32_16x16x32_bf16 v[192:195], a[112:115], a[8:11], v[192:195]
ds_read_b64_tr_b16 a[176:177], v248 offset:17024
ds_read_b64_tr_b16 a[178:179], v248 offset:25472
v_mfma_f32_16x16x32_bf16 v[196:199], a[116:119], a[8:11], v[196:199]
ds_read_b64_tr_b16 a[180:181], v248 offset:17056
ds_read_b64_tr_b16 a[182:183], v248 offset:25504
v_mfma_f32_16x16x32_bf16 v[192:195], a[120:123], a[12:15], v[192:195]
ds_read_b64_tr_b16 a[184:185], v248 offset:17088
ds_read_b64_tr_b16 a[186:187], v248 offset:25536
s_add_u32 m0, s41, 64
s_nop 0
buffer_load_dwordx4 v246, s[4:7], s36 offen offset:2048 nt lds
v_mfma_f32_16x16x32_bf16 v[196:199], a[124:127], a[12:15], v[196:199]
ds_read_b64_tr_b16 a[188:189], v248 offset:17120
ds_read_b64_tr_b16 a[190:191], v248 offset:25568
v_mfma_f32_16x16x32_bf16 v[192:195], a[128:131], a[16:19], v[192:195]
ds_read_b64_tr_b16 a[192:193], v248 offset:17152
ds_read_b64_tr_b16 a[194:195], v248 offset:25600
v_mfma_f32_16x16x32_bf16 v[196:199], a[132:135], a[16:19], v[196:199]
ds_read_b64_tr_b16 a[196:197], v248 offset:17184
ds_read_b64_tr_b16 a[198:199], v248 offset:25632
s_add_u32 m0, s41, 96
s_nop 0
buffer_load_dwordx4 v246, s[4:7], s36 offen offset:3072 nt lds
s_waitcnt lgkmcnt(15)
v_mfma_f32_16x16x32_bf16 v[192:195], a[136:139], a[20:23], v[192:195]
ds_read_b64_tr_b16 a[200:201], v248 offset:17216
ds_read_b64_tr_b16 a[202:203], v248 offset:25664
v_mfma_f32_16x16x32_bf16 v[196:199], a[140:143], a[20:23], v[196:199]
ds_read_b64_tr_b16 a[204:205], v248 offset:17248
ds_read_b64_tr_b16 a[206:207], v248 offset:25696
v_mfma_f32_16x16x32_bf16 v[192:195], a[144:147], a[24:27], v[192:195]
ds_read_b64_tr_b16 a[208:209], v248 offset:17280
ds_read_b64_tr_b16 a[210:211], v248 offset:25728
s_add_u32 m0, s41, 4224
s_add_u32 s40, s36, 4096
buffer_load_dwordx4 v246, s[4:7], s40 offen nt lds
v_mfma_f32_16x16x32_bf16 v[196:199], a[148:151], a[24:27], v[196:199]
ds_read_b64_tr_b16 a[212:213], v248 offset:17312
v_mfma_f32_16x16x32_bf16 v[192:195], a[152:155], a[28:31], v[192:195]
ds_read_b64_tr_b16 a[214:215], v248 offset:25760
v_mfma_f32_16x16x32_bf16 v[196:199], a[156:159], a[28:31], v[196:199]
ds_read_b64_tr_b16 a[216:217], v248 offset:17344
s_add_u32 m0, s37, 15840
s_add_u32 s40, s36, s10
s_mov_b64 exec, s[20:21]
buffer_load_dwordx4 v246, s[4:7], s40 offen nt lds
s_mov_b64 exec, -1
v_mfma_f32_16x16x32_bf16 v[200:203], a[96:99], a[32:35], 0
ds_read_b64_tr_b16 a[218:219], v248 offset:25792
v_max3_f32 v234, v192, v193, v194
v_mfma_f32_16x16x32_bf16 v[204:207], a[100:103], a[32:35], 0
ds_read_b64_tr_b16 a[220:221], v248 offset:17376
v_max3_f32 v235, v196, v197, v198
v_mfma_f32_16x16x32_bf16 v[200:203], a[104:107], a[36:39], v[200:203]
ds_read_b64_tr_b16 a[222:223], v248 offset:25824
s_xor_b64 s[4:5], s[4:5], s[8:9]
s_add_u32 s45, s45, 8192
s_and_b32 s36, s45, 0x7c000
v_max3_f32 v234, v234, v195, v199
v_mfma_f32_16x16x32_bf16 v[204:207], a[108:111], a[36:39], v[204:207]
v_max_f32 v234, v234, v235
v_mov_b32 v235, v234
v_mfma_f32_16x16x32_bf16 v[200:203], a[112:115], a[40:43], v[200:203]
s_nop 1
v_permlane32_swap_b32 v234, v235
v_mfma_f32_16x16x32_bf16 v[204:207], a[116:119], a[40:43], v[204:207]
s_add_u32 s37, s37, 16896
s_cmp_ge_u32 s37, 135168
s_cselect_b32 s37, 0, s37
s_nop 1
v_max_f32 v234, v234, v235
v_mfma_f32_16x16x32_bf16 v[200:203], a[120:123], a[44:47], v[200:203]
v_mov_b32 v235, v234
s_nop 1
v_mfma_f32_16x16x32_bf16 v[204:207], a[124:127], a[44:47], v[204:207]
v_permlane16_swap_b32 v234, v235
s_nop 1
v_mfma_f32_16x16x32_bf16 v[200:203], a[128:131], a[48:51], v[200:203]
s_add_u32 s41, s37, s39
s_add_u32 m0, s41, 0
s_nop 0
buffer_load_dwordx4 v246, s[4:7], s36 offen offset:0 nt lds
v_max_f32 v234, v234, v235
v_mul_f32 v228, s32, v234
v_mfma_f32_16x16x32_bf16 v[204:207], a[132:135], a[48:51], v[204:207]
v_add_f32 v229, s34, v234
v_sub_f32 v228, 0, v228
v_mfma_f32_16x16x32_bf16 v[200:203], a[136:139], a[52:55], v[200:203]
v_fma_f32 v192, v192, s32, v228
v_fma_f32 v193, v193, s32, v228
v_mfma_f32_16x16x32_bf16 v[204:207], a[140:143], a[52:55], v[204:207]
s_add_u32 m0, s41, 32
s_nop 0
buffer_load_dwordx4 v246, s[4:7], s36 offen offset:1024 nt lds
v_fma_f32 v194, v194, s32, v228
v_fma_f32 v195, v195, s32, v228
v_mfma_f32_16x16x32_bf16 v[200:203], a[144:147], a[56:59], v[200:203]
v_fma_f32 v196, v196, s32, v228
v_fma_f32 v197, v197, s32, v228
v_mfma_f32_16x16x32_bf16 v[204:207], a[148:151], a[56:59], v[204:207]
v_fma_f32 v198, v198, s32, v228
v_fma_f32 v199, v199, s32, v228
v_mfma_f32_16x16x32_bf16 v[200:203], a[152:155], a[60:63], v[200:203]
s_add_u32 m0, s41, 64
s_nop 0
buffer_load_dwordx4 v246, s[4:7], s36 offen offset:2048 nt lds
v_exp_f32 v192, v192
v_mfma_f32_16x16x32_bf16 v[204:207], a[156:159], a[60:63], v[204:207]
v_exp_f32 v193, v193
s_waitcnt lgkmcnt(0)
v_exp_f32 v194, v194
v_exp_f32 v195, v195
v_exp_f32 v196, v196
v_exp_f32 v197, v197
v_exp_f32 v198, v198
v_exp_f32 v199, v199
v_cvt_pk_bf16_f32 v216, v192, v193
v_cvt_pk_bf16_f32 v217, v194, v195
v_cvt_pk_bf16_f32 v218, v196, v197
v_cvt_pk_bf16_f32 v219, v198, v199
s_nop 1
v_mfma_f32_16x16x32_bf16 v[0:3], a[160:163], v[216:219], 0
v_max3_f32 v236, v200, v201, v202
v_max3_f32 v237, v204, v205, v206
v_mfma_f32_16x16x32_bf16 v[4:7], a[164:167], v[216:219], 0
s_add_u32 m0, s41, 96
s_nop 0
buffer_load_dwordx4 v246, s[4:7], s36 offen offset:3072 nt lds
v_max3_f32 v236, v236, v203, v207
v_max_f32 v236, v236, v237
v_mfma_f32_16x16x32_bf16 v[8:11], a[168:171], v[216:219], 0
v_mov_b32 v237, v236
s_nop 1
v_mfma_f32_16x16x32_bf16 v[12:15], a[172:175], v[216:219], 0
v_permlane32_swap_b32 v236, v237
s_nop 1
v_mfma_f32_16x16x32_bf16 v[16:19], a[176:179], v[216:219], 0
s_add_u32 m0, s41, 4224
s_add_u32 s40, s36, 4096
buffer_load_dwordx4 v246, s[4:7], s40 offen nt lds
v_max_f32 v236, v236, v237
v_mov_b32 v237, v236
v_mfma_f32_16x16x32_bf16 v[20:23], a[180:183], v[216:219], 0
s_nop 1
v_permlane16_swap_b32 v236, v237
v_mfma_f32_16x16x32_bf16 v[24:27], a[184:187], v[216:219], 0
s_nop 1
v_max_f32 v236, v236, v237
v_mfma_f32_16x16x32_bf16 v[28:31], a[188:191], v[216:219], 0
s_add_u32 m0, s37, 15840
s_add_u32 s40, s36, s10
s_mov_b64 exec, s[20:21]
buffer_load_dwordx4 v246, s[4:7], s40 offen nt lds
s_mov_b64 exec, -1
v_mul_f32 v230, s32, v236
v_add_f32 v231, s34, v236
v_mfma_f32_16x16x32_bf16 v[32:35], a[192:195], v[216:219], 0
v_sub_f32 v230, 0, v230
v_fma_f32 v200, v200, s32, v230
v_mfma_f32_16x16x32_bf16 v[36:39], a[196:199], v[216:219], 0
v_fma_f32 v201, v201, s32, v230
v_fma_f32 v202, v202, s32, v230
v_mfma_f32_16x16x32_bf16 v[40:43], a[200:203], v[216:219], 0
s_xor_b64 s[4:5], s[4:5], s[8:9]
s_add_u32 s45, s45, 8192
s_and_b32 s36, s45, 0x7c000
v_fma_f32 v203, v203, s32, v230
v_fma_f32 v204, v204, s32, v230
v_mfma_f32_16x16x32_bf16 v[44:47], a[204:207], v[216:219], 0
v_fma_f32 v205, v205, s32, v230
v_fma_f32 v206, v206, s32, v230
v_mfma_f32_16x16x32_bf16 v[48:51], a[208:211], v[216:219], 0
v_fma_f32 v207, v207, s32, v230
v_add_u32 v249, s38, v251
v_mfma_f32_16x16x32_bf16 v[52:55], a[212:215], v[216:219], 0
s_add_u32 s37, s37, 16896
s_cmp_ge_u32 s37, 135168
s_cselect_b32 s37, 0, s37
v_exp_f32 v200, v200
v_mfma_f32_16x16x32_bf16 v[56:59], a[216:219], v[216:219], 0
v_exp_f32 v201, v201
v_mfma_f32_16x16x32_bf16 v[60:63], a[220:223], v[216:219], 0
v_exp_f32 v202, v202
v_mfma_f32_16x16x32_bf16 a[224:227], a[236:239], v[216:219], 0
v_exp_f32 v203, v203
v_exp_f32 v204, v204
v_exp_f32 v205, v205
v_exp_f32 v206, v206
v_exp_f32 v207, v207
v_cvt_pk_bf16_f32 v220, v200, v201
v_cvt_pk_bf16_f32 v221, v202, v203
v_cvt_pk_bf16_f32 v222, v204, v205
v_cvt_pk_bf16_f32 v223, v206, v207
s_nop 1
v_mfma_f32_16x16x32_bf16 v[64:67], a[160:163], v[220:223], 0
v_add_u32 v248, s38, v250
s_waitcnt vmcnt(20)
s_barrier
s_add_u32 s41, s37, s39
s_add_u32 m0, s41, 0
s_nop 0
buffer_load_dwordx4 v246, s[4:7], s36 offen offset:0 nt lds
ds_read_b128 a[96:99], v249 offset:0
v_mfma_f32_16x16x32_bf16 v[68:71], a[164:167], v[220:223], 0
ds_read_b128 a[100:103], v249 offset:8448
v_mfma_f32_16x16x32_bf16 v[72:75], a[168:171], v[220:223], 0
s_add_u32 m0, s41, 32
s_nop 0
buffer_load_dwordx4 v246, s[4:7], s36 offen offset:1024 nt lds
ds_read_b128 a[104:107], v249 offset:64
v_mfma_f32_16x16x32_bf16 v[76:79], a[172:175], v[220:223], 0
ds_read_b128 a[108:111], v249 offset:8512
v_mfma_f32_16x16x32_bf16 v[80:83], a[176:179], v[220:223], 0
s_add_u32 m0, s41, 64
s_nop 0
buffer_load_dwordx4 v246, s[4:7], s36 offen offset:2048 nt lds
ds_read_b128 a[112:115], v249 offset:128
v_mfma_f32_16x16x32_bf16 v[84:87], a[180:183], v[220:223], 0
ds_read_b128 a[116:119], v249 offset:8576
v_mfma_f32_16x16x32_bf16 v[88:91], a[184:187], v[220:223], 0
s_add_u32 m0, s41, 96
s_nop 0
buffer_load_dwordx4 v246, s[4:7], s36 offen offset:3072 nt lds
ds_read_b128 a[120:123], v249 offset:192
v_mfma_f32_16x16x32_bf16 v[92:95], a[188:191], v[220:223], 0
ds_read_b128 a[124:127], v249 offset:8640
v_mfma_f32_16x16x32_bf16 v[96:99], a[192:195], v[220:223], 0
s_add_u32 m0, s41, 4224
s_add_u32 s40, s36, 4096
buffer_load_dwordx4 v246, s[4:7], s40 offen nt lds
ds_read_b128 a[128:131], v249 offset:256
v_mfma_f32_16x16x32_bf16 v[100:103], a[196:199], v[220:223], 0
ds_read_b128 a[132:135], v249 offset:8704
v_mfma_f32_16x16x32_bf16 v[104:107], a[200:203], v[220:223], 0
s_add_u32 m0, s37, 15840
s_add_u32 s40, s36, s10
s_mov_b64 exec, s[20:21]
buffer_load_dwordx4 v246, s[4:7], s40 offen nt lds
s_mov_b64 exec, -1
ds_read_b128 a[136:139], v249 offset:320
v_mfma_f32_16x16x32_bf16 v[108:111], a[204:207], v[220:223], 0
ds_read_b128 a[140:143], v249 offset:8768
v_mfma_f32_16x16x32_bf16 v[112:115], a[208:211], v[220:223], 0
s_xor_b64 s[4:5], s[4:5], s[8:9]
s_add_u32 s45, s45, 8192
s_and_b32 s36, s45, 0x7c000
ds_read_b128 a[144:147], v249 offset:384
v_mfma_f32_16x16x32_bf16 v[116:119], a[212:215], v[220:223], 0
ds_read_b128 a[148:151], v249 offset:8832
v_mfma_f32_16x16x32_bf16 v[120:123], a[216:219], v[220:223], 0
s_add_u32 s37, s37, 16896
s_cmp_ge_u32 s37, 135168
s_cselect_b32 s37, 0, s37
ds_read_b128 a[152:155], v249 offset:448
v_mfma_f32_16x16x32_bf16 v[124:127], a[220:223], v[220:223], 0
ds_read_b128 a[156:159], v249 offset:8896
s_add_u32 s38, s38, 33792
s_cmp_ge_u32 s38, 135168
s_cselect_b32 s38, 0, s38
v_mfma_f32_16x16x32_bf16 a[228:231], a[236:239], v[220:223], 0
s_mov_b32 s35, 1
s_mov_b32 s98, 4
s_cmp_lt_u32 s81, 4
s_cselect_b32 s22, 8, 8
s_lshr_b32 s40, s2, 3
s_and_b32 s40, s40, 7
s_add_u32 s98, s98, s40
s_lshl_b32 s23, s22, 1
s_add_u32 s23, s23, s98
s_add_u32 s23, s23, 1
L_loop1:
s_waitcnt lgkmcnt(6)
v_mfma_f32_16x16x32_bf16 v[192:195], a[96:99], a[0:3], 0
ds_read_b64_tr_b16 a[160:161], v248 offset:16896
ds_read_b64_tr_b16 a[162:163], v248 offset:25344
v_mfma_f32_16x16x32_bf16 v[196:199], a[100:103], a[0:3], 0
ds_read_b64_tr_b16 a[164:165], v248 offset:16928
ds_read_b64_tr_b16 a[166:167], v248 offset:25376
v_mfma_f32_16x16x32_bf16 v[192:195], a[104:107], a[4:7], v[192:195]
ds_read_b64_tr_b16 a[168:169], v248 offset:16960
ds_read_b64_tr_b16 a[170:171], v248 offset:25408
v_mfma_f32_16x16x32_bf16 v[196:199], a[108:111], a[4:7], v[196:199]
ds_read_b64_tr_b16 a[172:173], v248 offset:16992
ds_read_b64_tr_b16 a[174:175], v248 offset:25440
v_mfma_f32_16x16x32_bf16 v[192:195], a[112:115], a[8:11], v[192:195]
ds_read_b64_tr_b16 a[176:177], v248 offset:17024
ds_read_b64_tr_b16 a[178:179], v248 offset:25472
v_mfma_f32_16x16x32_bf16 v[196:199], a[116:119], a[8:11], v[196:199]
ds_read_b64_tr_b16 a[180:181], v248 offset:17056
ds_read_b64_tr_b16 a[182:183], v248 offset:25504
v_mfma_f32_16x16x32_bf16 v[192:195], a[120:123], a[12:15], v[192:195]
ds_read_b64_tr_b16 a[184:185], v248 offset:17088
ds_read_b64_tr_b16 a[186:187], v248 offset:25536
v_mfma_f32_16x16x32_bf16 v[196:199], a[124:127], a[12:15], v[196:199]
ds_read_b64_tr_b16 a[188:189], v248 offset:17120
ds_read_b64_tr_b16 a[190:191], v248 offset:25568
v_mfma_f32_16x16x32_bf16 v[192:195], a[128:131], a[16:19], v[192:195]
ds_read_b64_tr_b16 a[192:193], v248 offset:17152
ds_read_b64_tr_b16 a[194:195], v248 offset:25600
v_mfma_f32_16x16x32_bf16 v[196:199], a[132:135], a[16:19], v[196:199]
ds_read_b64_tr_b16 a[196:197], v248 offset:17184
ds_read_b64_tr_b16 a[198:199], v248 offset:25632
s_waitcnt lgkmcnt(15)
v_mfma_f32_16x16x32_bf16 v[192:195], a[136:139], a[20:23], v[192:195]
ds_read_b64_tr_b16 a[200:201], v248 offset:17216
ds_read_b64_tr_b16 a[202:203], v248 offset:25664
v_mfma_f32_16x16x32_bf16 v[196:199], a[140:143], a[20:23], v[196:199]
ds_read_b64_tr_b16 a[204:205], v248 offset:17248
ds_read_b64_tr_b16 a[206:207], v248 offset:25696
v_mfma_f32_16x16x32_bf16 v[192:195], a[144:147], a[24:27], v[192:195]
ds_read_b64_tr_b16 a[208:209], v248 offset:17280
ds_read_b64_tr_b16 a[210:211], v248 offset:25728
s_waitcnt vmcnt(7)
s_add_u32 s41, s37, s39
s_add_u32 m0, s41, 0
s_nop 0
buffer_load_dwordx4 v246, s[4:7], s36 offen offset:0 nt lds
v_mfma_f32_16x16x32_bf16 v[196:199], a[148:151], a[24:27], v[196:199]
ds_read_b64_tr_b16 a[212:213], v248 offset:17312
v_mfma_f32_16x16x32_bf16 v[192:195], a[152:155], a[28:31], v[192:195]
ds_read_b64_tr_b16 a[214:215], v248 offset:25760
s_add_u32 m0, s41, 32
s_nop 0
buffer_load_dwordx4 v246, s[4:7], s36 offen offset:1024 nt lds
v_mfma_f32_16x16x32_bf16 v[196:199], a[156:159], a[28:31], v[196:199]
ds_read_b64_tr_b16 a[216:217], v248 offset:17344
v_mfma_f32_16x16x32_bf16 v[200:203], a[96:99], a[32:35], 0
ds_read_b64_tr_b16 a[218:219], v248 offset:25792
s_add_u32 m0, s41, 64
s_nop 0
buffer_load_dwordx4 v246, s[4:7], s36 offen offset:2048 nt lds
v_mfma_f32_16x16x32_bf16 v[204:207], a[100:103], a[32:35], 0
ds_read_b64_tr_b16 a[220:221], v248 offset:17376
v_max3_f32 v234, v192, v193, v194
v_mfma_f32_16x16x32_bf16 v[200:203], a[104:107], a[36:39], v[200:203]
ds_read_b64_tr_b16 a[222:223], v248 offset:25824
s_add_u32 m0, s41, 96
s_nop 0
buffer_load_dwordx4 v246, s[4:7], s36 offen offset:3072 nt lds
v_max3_f32 v235, v196, v197, v198
v_mfma_f32_16x16x32_bf16 v[204:207], a[108:111], a[36:39], v[204:207]
v_max3_f32 v234, v234, v195, v199
v_max_f32 v234, v234, v235
v_mfma_f32_16x16x32_bf16 v[200:203], a[112:115], a[40:43], v[200:203]
s_add_u32 m0, s41, 4224
s_add_u32 s40, s36, 4096
buffer_load_dwordx4 v246, s[4:7], s40 offen nt lds
v_cmp_gt_f32 vcc, v234, v229
s_cbranch_vccnz L_rare1_0
L_ret1_0:
v_fma_f32 v192, v192, s32, v228
v_mfma_f32_16x16x32_bf16 v[204:207], a[116:119], a[40:43], v[204:207]
v_fma_f32 v193, v193, s32, v228
v_fma_f32 v194, v194, s32, v228
v_mfma_f32_16x16x32_bf16 v[200:203], a[120:123], a[44:47], v[200:203]
s_add_u32 m0, s37, 15840
s_add_u32 s40, s36, s10
s_mov_b64 exec, s[20:21]
buffer_load_dwordx4 v246, s[4:7], s40 offen nt lds
s_mov_b64 exec, -1
v_fma_f32 v195, v195, s32, v228
v_fma_f32 v196, v196, s32, v228
v_mfma_f32_16x16x32_bf16 v[204:207], a[124:127], a[44:47], v[204:207]
v_fma_f32 v197, v197, s32, v228
v_fma_f32 v198, v198, s32, v228
v_mfma_f32_16x16x32_bf16 v[200:203], a[128:131], a[48:51], v[200:203]
s_xor_b64 s[4:5], s[4:5], s[8:9]
s_add_u32 s45, s45, 8192
s_and_b32 s36, s45, 0x7c000
v_fma_f32 v199, v199, s32, v228
v_mfma_f32_16x16x32_bf16 v[204:207], a[132:135], a[48:51], v[204:207]
v_exp_f32 v192, v192
v_mfma_f32_16x16x32_bf16 v[200:203], a[136:139], a[52:55], v[200:203]
s_add_u32 s37, s37, 16896
s_cmp_ge_u32 s37, 135168
s_cselect_b32 s37, 0, s37
v_exp_f32 v193, v193
v_mfma_f32_16x16x32_bf16 v[204:207], a[140:143], a[52:55], v[204:207]
v_exp_f32 v194, v194
v_mfma_f32_16x16x32_bf16 v[200:203], a[144:147], a[56:59], v[200:203]
v_exp_f32 v195, v195
v_mfma_f32_16x16x32_bf16 v[204:207], a[148:151], a[56:59], v[204:207]
v_exp_f32 v196, v196
v_mfma_f32_16x16x32_bf16 v[200:203], a[152:155], a[60:63], v[200:203]
v_exp_f32 v197, v197
v_mfma_f32_16x16x32_bf16 v[204:207], a[156:159], a[60:63], v[204:207]
v_exp_f32 v198, v198
s_waitcnt lgkmcnt(0)
v_exp_f32 v199, v199
v_cvt_pk_bf16_f32 v216, v192, v193
v_cvt_pk_bf16_f32 v217, v194, v195
v_cvt_pk_bf16_f32 v218, v196, v197
v_cvt_pk_bf16_f32 v219, v198, v199
s_nop 1
v_mfma_f32_16x16x32_bf16 v[0:3], a[160:163], v[216:219], v[0:3]
v_max3_f32 v236, v200, v201, v202
v_max3_f32 v237, v204, v205, v206
v_mfma_f32_16x16x32_bf16 v[4:7], a[164:167], v[216:219], v[4:7]
v_max3_f32 v236, v236, v203, v207
v_max_f32 v236, v236, v237
v_mfma_f32_16x16x32_bf16 v[8:11], a[168:171], v[216:219], v[8:11]
v_cmp_gt_f32 vcc, v236, v231
s_cbranch_vccnz L_rare1_1
L_ret1_1:
v_fma_f32 v200, v200, s32, v230
v_mfma_f32_16x16x32_bf16 v[12:15], a[172:175], v[216:219], v[12:15]
v_fma_f32 v201, v201, s32, v230
v_fma_f32 v202, v202, s32, v230
v_mfma_f32_16x16x32_bf16 v[16:19], a[176:179], v[216:219], v[16:19]
v_fma_f32 v203, v203, s32, v230
v_fma_f32 v204, v204, s32, v230
v_mfma_f32_16x16x32_bf16 v[20:23], a[180:183], v[216:219], v[20:23]
v_fma_f32 v205, v205, s32, v230
v_fma_f32 v206, v206, s32, v230
v_mfma_f32_16x16x32_bf16 v[24:27], a[184:187], v[216:219], v[24:27]
v_fma_f32 v207, v207, s32, v230
v_add_u32 v249, s38, v251
v_mfma_f32_16x16x32_bf16 v[28:31], a[188:191], v[216:219], v[28:31]
v_exp_f32 v200, v200
v_mfma_f32_16x16x32_bf16 v[32:35], a[192:195], v[216:219], v[32:35]
v_exp_f32 v201, v201
v_mfma_f32_16x16x32_bf16 v[36:39], a[196:199], v[216:219], v[36:39]
v_exp_f32 v202, v202
v_mfma_f32_16x16x32_bf16 v[40:43], a[200:203], v[216:219], v[40:43]
v_exp_f32 v203, v203
v_mfma_f32_16x16x32_bf16 v[44:47], a[204:207], v[216:219], v[44:47]
v_exp_f32 v204, v204
v_mfma_f32_16x16x32_bf16 v[48:51], a[208:211], v[216:219], v[48:51]
v_exp_f32 v205, v205
v_mfma_f32_16x16x32_bf16 v[52:55], a[212:215], v[216:219], v[52:55]
v_exp_f32 v206, v206
v_mfma_f32_16x16x32_bf16 v[56:59], a[216:219], v[216:219], v[56:59]
v_exp_f32 v207, v207
v_mfma_f32_16x16x32_bf16 v[60:63], a[220:223], v[216:219], v[60:63]
v_cvt_pk_bf16_f32 v220, v200, v201
v_cvt_pk_bf16_f32 v221, v202, v203
v_mfma_f32_16x16x32_bf16 a[224:227], a[236:239], v[216:219], a[224:227]
v_cvt_pk_bf16_f32 v222, v204, v205
v_cvt_pk_bf16_f32 v223, v206, v207
s_nop 1
v_mfma_f32_16x16x32_bf16 v[64:67], a[160:163], v[220:223], v[64:67]
v_add_u32 v248, s38, v250
s_waitcnt vmcnt(7)
s_barrier
s_add_u32 s41, s37, s39
s_add_u32 m0, s41, 0
s_nop 0
buffer_load_dwordx4 v246, s[4:7], s36 offen offset:0 nt lds
ds_read_b128 a[96:99], v249 offset:0
v_mfma_f32_16x16x32_bf16 v[68:71], a[164:167], v[220:223], v[68:71]
ds_read_b128 a[100:103], v249 offset:8448
v_mfma_f32_16x16x32_bf16 v[72:75], a[168:171], v[220:223], v[72:75]
s_add_u32 m0, s41, 32
s_nop 0
buffer_load_dwordx4 v246, s[4:7], s36 offen offset:1024 nt lds
ds_read_b128 a[104:107], v249 offset:64
v_mfma_f32_16x16x32_bf16 v[76:79], a[172:175], v[220:223], v[76:79]
ds_read_b128 a[108:111], v249 offset:8512
v_mfma_f32_16x16x32_bf16 v[80:83], a[176:179], v[220:223], v[80:83]
s_add_u32 m0, s41, 64
s_nop 0
buffer_load_dwordx4 v246, s[4:7], s36 offen offset:2048 nt lds
ds_read_b128 a[112:115], v249 offset:128
v_mfma_f32_16x16x32_bf16 v[84:87], a[180:183], v[220:223], v[84:87]
ds_read_b128 a[116:119], v249 offset:8576
v_mfma_f32_16x16x32_bf16 v[88:91], a[184:187], v[220:223], v[88:91]
s_add_u32 m0, s41, 96
s_nop 0
buffer_load_dwordx4 v246, s[4:7], s36 offen offset:3072 nt lds
ds_read_b128 a[120:123], v249 offset:192
v_mfma_f32_16x16x32_bf16 v[92:95], a[188:191], v[220:223], v[92:95]
ds_read_b128 a[124:127], v249 offset:8640
v_mfma_f32_16x16x32_bf16 v[96:99], a[192:195], v[220:223], v[96:99]
s_add_u32 m0, s41, 4224
s_add_u32 s40, s36, 4096
buffer_load_dwordx4 v246, s[4:7], s40 offen nt lds
ds_read_b128 a[128:131], v249 offset:256
v_mfma_f32_16x16x32_bf16 v[100:103], a[196:199], v[220:223], v[100:103]
ds_read_b128 a[132:135], v249 offset:8704
v_mfma_f32_16x16x32_bf16 v[104:107], a[200:203], v[220:223], v[104:107]
s_add_u32 m0, s37, 15840
s_add_u32 s40, s36, s10
s_mov_b64 exec, s[20:21]
buffer_load_dwordx4 v246, s[4:7], s40 offen nt lds
s_mov_b64 exec, -1
ds_read_b128 a[136:139], v249 offset:320
v_mfma_f32_16x16x32_bf16 v[108:111], a[204:207], v[220:223], v[108:111]
ds_read_b128 a[140:143], v249 offset:8768
v_mfma_f32_16x16x32_bf16 v[112:115], a[208:211], v[220:223], v[112:115]
s_xor_b64 s[4:5], s[4:5], s[8:9]
s_add_u32 s45, s45, 8192
s_and_b32 s36, s45, 0x7c000
ds_read_b128 a[144:147], v249 offset:384
v_mfma_f32_16x16x32_bf16 v[116:119], a[212:215], v[220:223], v[116:119]
ds_read_b128 a[148:151], v249 offset:8832
v_mfma_f32_16x16x32_bf16 v[120:123], a[216:219], v[220:223], v[120:123]
s_add_u32 s37, s37, 16896
s_cmp_ge_u32 s37, 135168
s_cselect_b32 s37, 0, s37
ds_read_b128 a[152:155], v249 offset:448
v_mfma_f32_16x16x32_bf16 v[124:127], a[220:223], v[220:223], v[124:127]
ds_read_b128 a[156:159], v249 offset:8896
s_add_u32 s38, s38, 33792
s_cmp_ge_u32 s38, 135168
s_cselect_b32 s38, 0, s38
v_mfma_f32_16x16x32_bf16 a[228:231], a[236:239], v[220:223], a[228:231]
s_add_u32 s35, s35, 1
s_cmp_lt_u32 s35, s98
s_cbranch_scc1 L_loop1
s_waitcnt lgkmcnt(6)
v_mfma_f32_16x16x32_bf16 v[192:195], a[96:99], a[0:3], 0
ds_read_b64_tr_b16 a[160:161], v248 offset:16896
ds_read_b64_tr_b16 a[162:163], v248 offset:25344
v_mfma_f32_16x16x32_bf16 v[196:199], a[100:103], a[0:3], 0
ds_read_b64_tr_b16 a[164:165], v248 offset:16928
ds_read_b64_tr_b16 a[166:167], v248 offset:25376
v_mfma_f32_16x16x32_bf16 v[192:195], a[104:107], a[4:7], v[192:195]
ds_read_b64_tr_b16 a[168:169], v248 offset:16960
ds_read_b64_tr_b16 a[170:171], v248 offset:25408
v_mfma_f32_16x16x32_bf16 v[196:199], a[108:111], a[4:7], v[196:199]
ds_read_b64_tr_b16 a[172:173], v248 offset:16992
ds_read_b64_tr_b16 a[174:175], v248 offset:25440
v_mfma_f32_16x16x32_bf16 v[192:195], a[112:115], a[8:11], v[192:195]
ds_read_b64_tr_b16 a[176:177], v248 offset:17024
ds_read_b64_tr_b16 a[178:179], v248 offset:25472
v_mfma_f32_16x16x32_bf16 v[196:199], a[116:119], a[8:11], v[196:199]
ds_read_b64_tr_b16 a[180:181], v248 offset:17056
ds_read_b64_tr_b16 a[182:183], v248 offset:25504
v_mfma_f32_16x16x32_bf16 v[192:195], a[120:123], a[12:15], v[192:195]
ds_read_b64_tr_b16 a[184:185], v248 offset:17088
ds_read_b64_tr_b16 a[186:187], v248 offset:25536
v_mfma_f32_16x16x32_bf16 v[196:199], a[124:127], a[12:15], v[196:199]
ds_read_b64_tr_b16 a[188:189], v248 offset:17120
ds_read_b64_tr_b16 a[190:191], v248 offset:25568
v_mfma_f32_16x16x32_bf16 v[192:195], a[128:131], a[16:19], v[192:195]
ds_read_b64_tr_b16 a[192:193], v248 offset:17152
ds_read_b64_tr_b16 a[194:195], v248 offset:25600
v_mfma_f32_16x16x32_bf16 v[196:199], a[132:135], a[16:19], v[196:199]
ds_read_b64_tr_b16 a[196:197], v248 offset:17184
ds_read_b64_tr_b16 a[198:199], v248 offset:25632
s_waitcnt lgkmcnt(15)
v_mfma_f32_16x16x32_bf16 v[192:195], a[136:139], a[20:23], v[192:195]
ds_read_b64_tr_b16 a[200:201], v248 offset:17216
ds_read_b64_tr_b16 a[202:203], v248 offset:25664
v_mfma_f32_16x16x32_bf16 v[196:199], a[140:143], a[20:23], v[196:199]
ds_read_b64_tr_b16 a[204:205], v248 offset:17248
ds_read_b64_tr_b16 a[206:207], v248 offset:25696
v_mfma_f32_16x16x32_bf16 v[192:195], a[144:147], a[24:27], v[192:195]
ds_read_b64_tr_b16 a[208:209], v248 offset:17280
ds_read_b64_tr_b16 a[210:211], v248 offset:25728
v_mfma_f32_16x16x32_bf16 v[196:199], a[148:151], a[24:27], v[196:199]
ds_read_b64_tr_b16 a[212:213], v248 offset:17312
v_mfma_f32_16x16x32_bf16 v[192:195], a[152:155], a[28:31], v[192:195]
ds_read_b64_tr_b16 a[214:215], v248 offset:25760
v_mfma_f32_16x16x32_bf16 v[196:199], a[156:159], a[28:31], v[196:199]
ds_read_b64_tr_b16 a[216:217], v248 offset:17344
v_mfma_f32_16x16x32_bf16 v[200:203], a[96:99], a[32:35], 0
ds_read_b64_tr_b16 a[218:219], v248 offset:25792
v_mfma_f32_16x16x32_bf16 v[204:207], a[100:103], a[32:35], 0
ds_read_b64_tr_b16 a[220:221], v248 offset:17376
v_mfma_f32_16x16x32_bf16 v[200:203], a[104:107], a[36:39], v[200:203]
ds_read_b64_tr_b16 a[222:223], v248 offset:25824
v_mfma_f32_16x16x32_bf16 v[204:207], a[108:111], a[36:39], v[204:207]
v_max3_f32 v234, v192, v193, v194
v_max3_f32 v235, v196, v197, v198
v_mfma_f32_16x16x32_bf16 v[200:203], a[112:115], a[40:43], v[200:203]
v_max3_f32 v234, v234, v195, v199
v_max_f32 v234, v234, v235
v_mfma_f32_16x16x32_bf16 v[204:207], a[116:119], a[40:43], v[204:207]
v_cmp_gt_f32 vcc, v234, v229
s_cbranch_vccnz L_rare2_0
L_ret2_0:
v_fma_f32 v192, v192, s32, v228
v_mfma_f32_16x16x32_bf16 v[200:203], a[120:123], a[44:47], v[200:203]
v_fma_f32 v193, v193, s32, v228
v_fma_f32 v194, v194, s32, v228
v_mfma_f32_16x16x32_bf16 v[204:207], a[124:127], a[44:47], v[204:207]
v_fma_f32 v195, v195, s32, v228
v_fma_f32 v196, v196, s32, v228
v_mfma_f32_16x16x32_bf16 v[200:203], a[128:131], a[48:51], v[200:203]
v_fma_f32 v197, v197, s32, v228
v_fma_f32 v198, v198, s32, v228
v_mfma_f32_16x16x32_bf16 v[204:207], a[132:135], a[48:51], v[204:207]
v_fma_f32 v199, v199, s32, v228
v_mfma_f32_16x16x32_bf16 v[200:203], a[136:139], a[52:55], v[200:203]
v_exp_f32 v192, v192
v_mfma_f32_16x16x32_bf16 v[204:207], a[140:143], a[52:55], v[204:207]
v_exp_f32 v193, v193
v_mfma_f32_16x16x32_bf16 v[200:203], a[144:147], a[56:59], v[200:203]
v_exp_f32 v194, v194
v_mfma_f32_16x16x32_bf16 v[204:207], a[148:151], a[56:59], v[204:207]
v_exp_f32 v195, v195
v_mfma_f32_16x16x32_bf16 v[200:203], a[152:155], a[60:63], v[200:203]
v_exp_f32 v196, v196
v_mfma_f32_16x16x32_bf16 v[204:207], a[156:159], a[60:63], v[204:207]
v_exp_f32 v197, v197
s_waitcnt lgkmcnt(0)
v_exp_f32 v198, v198
v_exp_f32 v199, v199
v_cvt_pk_bf16_f32 v216, v192, v193
v_cvt_pk_bf16_f32 v217, v194, v195
v_cvt_pk_bf16_f32 v218, v196, v197
v_cvt_pk_bf16_f32 v219, v198, v199
s_nop 1
v_mfma_f32_16x16x32_bf16 v[0:3], a[160:163], v[216:219], v[0:3]
v_max3_f32 v236, v200, v201, v202
v_max3_f32 v237, v204, v205, v206
v_mfma_f32_16x16x32_bf16 v[4:7], a[164:167], v[216:219], v[4:7]
v_max3_f32 v236, v236, v203, v207
v_max_f32 v236, v236, v237
v_mfma_f32_16x16x32_bf16 v[8:11], a[168:171], v[216:219], v[8:11]
v_cmp_gt_f32 vcc, v236, v231
s_cbranch_vccnz L_rare2_1
L_ret2_1:
v_fma_f32 v200, v200, s32, v230
v_mfma_f32_16x16x32_bf16 v[12:15], a[172:175], v[216:219], v[12:15]
v_fma_f32 v201, v201, s32, v230
v_fma_f32 v202, v202, s32, v230
v_mfma_f32_16x16x32_bf16 v[16:19], a[176:179], v[216:219], v[16:19]
v_fma_f32 v203, v203, s32, v230
v_fma_f32 v204, v204, s32, v230
v_mfma_f32_16x16x32_bf16 v[20:23], a[180:183], v[216:219], v[20:23]
v_fma_f32 v205, v205, s32, v230
v_fma_f32 v206, v206, s32, v230
v_mfma_f32_16x16x32_bf16 v[24:27], a[184:187], v[216:219], v[24:27]
v_fma_f32 v207, v207, s32, v230
v_add_u32 v249, s38, v251
v_mfma_f32_16x16x32_bf16 v[28:31], a[188:191], v[216:219], v[28:31]
v_exp_f32 v200, v200
v_mfma_f32_16x16x32_bf16 v[32:35], a[192:195], v[216:219], v[32:35]
v_exp_f32 v201, v201
v_mfma_f32_16x16x32_bf16 v[36:39], a[196:199], v[216:219], v[36:39]
v_exp_f32 v202, v202
v_mfma_f32_16x16x32_bf16 v[40:43], a[200:203], v[216:219], v[40:43]
v_exp_f32 v203, v203
v_mfma_f32_16x16x32_bf16 v[44:47], a[204:207], v[216:219], v[44:47]
v_exp_f32 v204, v204
v_mfma_f32_16x16x32_bf16 v[48:51], a[208:211], v[216:219], v[48:51]
v_exp_f32 v205, v205
v_mfma_f32_16x16x32_bf16 v[52:55], a[212:215], v[216:219], v[52:55]
v_exp_f32 v206, v206
v_mfma_f32_16x16x32_bf16 v[56:59], a[216:219], v[216:219], v[56:59]
v_exp_f32 v207, v207
v_mfma_f32_16x16x32_bf16 v[60:63], a[220:223], v[216:219], v[60:63]
v_cvt_pk_bf16_f32 v220, v200, v201
v_cvt_pk_bf16_f32 v221, v202, v203
v_mfma_f32_16x16x32_bf16 a[224:227], a[236:239], v[216:219], a[224:227]
v_cvt_pk_bf16_f32 v222, v204, v205
v_cvt_pk_bf16_f32 v223, v206, v207
s_nop 1
v_mfma_f32_16x16x32_bf16 v[64:67], a[160:163], v[220:223], v[64:67]
v_add_u32 v248, s38, v250
s_waitcnt vmcnt(6)
s_barrier
s_add_u32 s41, s37, s39
s_add_u32 m0, s41, 0
s_nop 0
buffer_load_dwordx4 v246, s[4:7], s36 offen offset:0 nt lds
ds_read_b128 a[96:99], v249 offset:0
v_mfma_f32_16x16x32_bf16 v[68:71], a[164:167], v[220:223], v[68:71]
ds_read_b128 a[100:103], v249 offset:8448
v_mfma_f32_16x16x32_bf16 v[72:75], a[168:171], v[220:223], v[72:75]
s_add_u32 m0, s41, 32
s_nop 0
buffer_load_dwordx4 v246, s[4:7], s36 offen offset:1024 nt lds
ds_read_b128 a[104:107], v249 offset:64
v_mfma_f32_16x16x32_bf16 v[76:79], a[172:175], v[220:223], v[76:79]
ds_read_b128 a[108:111], v249 offset:8512
v_mfma_f32_16x16x32_bf16 v[80:83], a[176:179], v[220:223], v[80:83]
s_add_u32 m0, s41, 64
s_nop 0
buffer_load_dwordx4 v246, s[4:7], s36 offen offset:2048 nt lds
ds_read_b128 a[112:115], v249 offset:128
v_mfma_f32_16x16x32_bf16 v[84:87], a[180:183], v[220:223], v[84:87]
ds_read_b128 a[116:119], v249 offset:8576
v_mfma_f32_16x16x32_bf16 v[88:91], a[184:187], v[220:223], v[88:91]
s_add_u32 m0, s41, 96
s_nop 0
buffer_load_dwordx4 v246, s[4:7], s36 offen offset:3072 nt lds
ds_read_b128 a[120:123], v249 offset:192
v_mfma_f32_16x16x32_bf16 v[92:95], a[188:191], v[220:223], v[92:95]
ds_read_b128 a[124:127], v249 offset:8640
v_mfma_f32_16x16x32_bf16 v[96:99], a[192:195], v[220:223], v[96:99]
s_add_u32 m0, s41, 4224
s_add_u32 s40, s36, 4096
buffer_load_dwordx4 v246, s[4:7], s40 offen nt lds
ds_read_b128 a[128:131], v249 offset:256
v_mfma_f32_16x16x32_bf16 v[100:103], a[196:199], v[220:223], v[100:103]
ds_read_b128 a[132:135], v249 offset:8704
v_mfma_f32_16x16x32_bf16 v[104:107], a[200:203], v[220:223], v[104:107]
s_add_u32 m0, s37, 15840
s_add_u32 s40, s36, s10
s_mov_b64 exec, s[20:21]
buffer_load_dwordx4 v246, s[4:7], s40 offen nt lds
s_mov_b64 exec, -1
ds_read_b128 a[136:139], v249 offset:320
v_mfma_f32_16x16x32_bf16 v[108:111], a[204:207], v[220:223], v[108:111]
ds_read_b128 a[140:143], v249 offset:8768
v_mfma_f32_16x16x32_bf16 v[112:115], a[208:211], v[220:223], v[112:115]
s_xor_b64 s[4:5], s[4:5], s[8:9]
s_add_u32 s45, s45, 8192
s_and_b32 s36, s45, 0x7c000
ds_read_b128 a[144:147], v249 offset:384
v_mfma_f32_16x16x32_bf16 v[116:119], a[212:215], v[220:223], v[116:119]
ds_read_b128 a[148:151], v249 offset:8832
v_mfma_f32_16x16x32_bf16 v[120:123], a[216:219], v[220:223], v[120:123]
s_add_u32 s37, s37, 16896
s_cmp_ge_u32 s37, 135168
s_cselect_b32 s37, 0, s37
ds_read_b128 a[152:155], v249 offset:448
v_mfma_f32_16x16x32_bf16 v[124:127], a[220:223], v[220:223], v[124:127]
ds_read_b128 a[156:159], v249 offset:8896
s_add_u32 s38, s38, 33792
s_cmp_ge_u32 s38, 135168
s_cselect_b32 s38, 0, s38
v_mfma_f32_16x16x32_bf16 a[228:231], a[236:239], v[220:223], a[228:231]
s_add_u32 s98, s98, s22
s_add_u32 s35, s35, 1
s_cmp_lt_u32 s35, s23
s_cbranch_scc1 L_loop1
L_loop3:
s_waitcnt lgkmcnt(6)
v_mfma_f32_16x16x32_bf16 v[192:195], a[96:99], a[0:3], 0
ds_read_b64_tr_b16 a[160:161], v248 offset:16896
ds_read_b64_tr_b16 a[162:163], v248 offset:25344
v_mfma_f32_16x16x32_bf16 v[196:199], a[100:103], a[0:3], 0
ds_read_b64_tr_b16 a[164:165], v248 offset:16928
ds_read_b64_tr_b16 a[166:167], v248 offset:25376
v_mfma_f32_16x16x32_bf16 v[192:195], a[104:107], a[4:7], v[192:195]
ds_read_b64_tr_b16 a[168:169], v248 offset:16960
ds_read_b64_tr_b16 a[170:171], v248 offset:25408
v_mfma_f32_16x16x32_bf16 v[196:199], a[108:111], a[4:7], v[196:199]
ds_read_b64_tr_b16 a[172:173], v248 offset:16992
ds_read_b64_tr_b16 a[174:175], v248 offset:25440
v_mfma_f32_16x16x32_bf16 v[192:195], a[112:115], a[8:11], v[192:195]
ds_read_b64_tr_b16 a[176:177], v248 offset:17024
ds_read_b64_tr_b16 a[178:179], v248 offset:25472
v_mfma_f32_16x16x32_bf16 v[196:199], a[116:119], a[8:11], v[196:199]
ds_read_b64_tr_b16 a[180:181], v248 offset:17056
ds_read_b64_tr_b16 a[182:183], v248 offset:25504
v_mfma_f32_16x16x32_bf16 v[192:195], a[120:123], a[12:15], v[192:195]
ds_read_b64_tr_b16 a[184:185], v248 offset:17088
ds_read_b64_tr_b16 a[186:187], v248 offset:25536
v_mfma_f32_16x16x32_bf16 v[196:199], a[124:127], a[12:15], v[196:199]
ds_read_b64_tr_b16 a[188:189], v248 offset:17120
ds_read_b64_tr_b16 a[190:191], v248 offset:25568
v_mfma_f32_16x16x32_bf16 v[192:195], a[128:131], a[16:19], v[192:195]
ds_read_b64_tr_b16 a[192:193], v248 offset:17152
ds_read_b64_tr_b16 a[194:195], v248 offset:25600
v_mfma_f32_16x16x32_bf16 v[196:199], a[132:135], a[16:19], v[196:199]
ds_read_b64_tr_b16 a[196:197], v248 offset:17184
ds_read_b64_tr_b16 a[198:199], v248 offset:25632
s_waitcnt lgkmcnt(15)
v_mfma_f32_16x16x32_bf16 v[192:195], a[136:139], a[20:23], v[192:195]
ds_read_b64_tr_b16 a[200:201], v248 offset:17216
ds_read_b64_tr_b16 a[202:203], v248 offset:25664
v_mfma_f32_16x16x32_bf16 v[196:199], a[140:143], a[20:23], v[196:199]
ds_read_b64_tr_b16 a[204:205], v248 offset:17248
ds_read_b64_tr_b16 a[206:207], v248 offset:25696
v_mfma_f32_16x16x32_bf16 v[192:195], a[144:147], a[24:27], v[192:195]
ds_read_b64_tr_b16 a[208:209], v248 offset:17280
ds_read_b64_tr_b16 a[210:211], v248 offset:25728
s_waitcnt vmcnt(6)
s_add_u32 s41, s37, s39
s_add_u32 m0, s41, 0
s_nop 0
buffer_load_dwordx4 v246, s[4:7], s36 offen offset:0 nt lds
v_mfma_f32_16x16x32_bf16 v[196:199], a[148:151], a[24:27], v[196:199]
ds_read_b64_tr_b16 a[212:213], v248 offset:17312
v_mfma_f32_16x16x32_bf16 v[192:195], a[152:155], a[28:31], v[192:195]
ds_read_b64_tr_b16 a[214:215], v248 offset:25760
s_add_u32 m0, s41, 32
s_nop 0
buffer_load_dwordx4 v246, s[4:7], s36 offen offset:1024 nt lds
v_mfma_f32_16x16x32_bf16 v[196:199], a[156:159], a[28:31], v[196:199]
ds_read_b64_tr_b16 a[216:217], v248 offset:17344
v_mfma_f32_16x16x32_bf16 v[200:203], a[96:99], a[32:35], 0
ds_read_b64_tr_b16 a[218:219], v248 offset:25792
s_add_u32 m0, s41, 64
s_nop 0
buffer_load_dwordx4 v246, s[4:7], s36 offen offset:2048 nt lds
v_mfma_f32_16x16x32_bf16 v[204:207], a[100:103], a[32:35], 0
ds_read_b64_tr_b16 a[220:221], v248 offset:17376
v_max3_f32 v234, v192, v193, v194
v_mfma_f32_16x16x32_bf16 v[200:203], a[104:107], a[36:39], v[200:203]
ds_read_b64_tr_b16 a[222:223], v248 offset:25824
s_add_u32 m0, s41, 96
s_nop 0
buffer_load_dwordx4 v246, s[4:7], s36 offen offset:3072 nt lds
v_max3_f32 v235, v196, v197, v198
v_mfma_f32_16x16x32_bf16 v[204:207], a[108:111], a[36:39], v[204:207]
v_max3_f32 v234, v234, v195, v199
v_max_f32 v234, v234, v235
v_mfma_f32_16x16x32_bf16 v[200:203], a[112:115], a[40:43], v[200:203]
s_add_u32 m0, s41, 4224
s_add_u32 s40, s36, 4096
buffer_load_dwordx4 v246, s[4:7], s40 offen nt lds
v_cmp_gt_f32 vcc, v234, v229
s_cbranch_vccnz L_rare3_0
L_ret3_0:
v_fma_f32 v192, v192, s32, v228
v_mfma_f32_16x16x32_bf16 v[204:207], a[116:119], a[40:43], v[204:207]
v_fma_f32 v193, v193, s32, v228
v_fma_f32 v194, v194, s32, v228
v_mfma_f32_16x16x32_bf16 v[200:203], a[120:123], a[44:47], v[200:203]
s_add_u32 m0, s37, 15840
s_add_u32 s40, s36, s10
s_mov_b64 exec, s[20:21]
buffer_load_dwordx4 v246, s[4:7], s40 offen nt lds
s_mov_b64 exec, -1
v_fma_f32 v195, v195, s32, v228
v_fma_f32 v196, v196, s32, v228
v_mfma_f32_16x16x32_bf16 v[204:207], a[124:127], a[44:47], v[204:207]
v_fma_f32 v197, v197, s32, v228
v_fma_f32 v198, v198, s32, v228
v_mfma_f32_16x16x32_bf16 v[200:203], a[128:131], a[48:51], v[200:203]
s_xor_b64 s[4:5], s[4:5], s[8:9]
s_add_u32 s45, s45, 8192
s_and_b32 s36, s45, 0x7c000
v_fma_f32 v199, v199, s32, v228
v_mfma_f32_16x16x32_bf16 v[204:207], a[132:135], a[48:51], v[204:207]
v_exp_f32 v192, v192
v_mfma_f32_16x16x32_bf16 v[200:203], a[136:139], a[52:55], v[200:203]
s_add_u32 s37, s37, 16896
s_cmp_ge_u32 s37, 135168
s_cselect_b32 s37, 0, s37
v_exp_f32 v193, v193
v_mfma_f32_16x16x32_bf16 v[204:207], a[140:143], a[52:55], v[204:207]
v_exp_f32 v194, v194
v_mfma_f32_16x16x32_bf16 v[200:203], a[144:147], a[56:59], v[200:203]
v_exp_f32 v195, v195
v_mfma_f32_16x16x32_bf16 v[204:207], a[148:151], a[56:59], v[204:207]
v_exp_f32 v196, v196
v_mfma_f32_16x16x32_bf16 v[200:203], a[152:155], a[60:63], v[200:203]
v_exp_f32 v197, v197
v_mfma_f32_16x16x32_bf16 v[204:207], a[156:159], a[60:63], v[204:207]
v_exp_f32 v198, v198
s_waitcnt lgkmcnt(0)
v_exp_f32 v199, v199
v_cvt_pk_bf16_f32 v216, v192, v193
v_cvt_pk_bf16_f32 v217, v194, v195
v_cvt_pk_bf16_f32 v218, v196, v197
v_cvt_pk_bf16_f32 v219, v198, v199
s_nop 1
v_mfma_f32_16x16x32_bf16 v[0:3], a[160:163], v[216:219], v[0:3]
v_max3_f32 v236, v200, v201, v202
v_max3_f32 v237, v204, v205, v206
v_mfma_f32_16x16x32_bf16 v[4:7], a[164:167], v[216:219], v[4:7]
v_max3_f32 v236, v236, v203, v207
v_max_f32 v236, v236, v237
v_mfma_f32_16x16x32_bf16 v[8:11], a[168:171], v[216:219], v[8:11]
v_cmp_gt_f32 vcc, v236, v231
s_cbranch_vccnz L_rare3_1
L_ret3_1:
v_fma_f32 v200, v200, s32, v230
v_mfma_f32_16x16x32_bf16 v[12:15], a[172:175], v[216:219], v[12:15]
v_fma_f32 v201, v201, s32, v230
v_fma_f32 v202, v202, s32, v230
v_mfma_f32_16x16x32_bf16 v[16:19], a[176:179], v[216:219], v[16:19]
v_fma_f32 v203, v203, s32, v230
v_fma_f32 v204, v204, s32, v230
v_mfma_f32_16x16x32_bf16 v[20:23], a[180:183], v[216:219], v[20:23]
v_fma_f32 v205, v205, s32, v230
v_fma_f32 v206, v206, s32, v230
v_mfma_f32_16x16x32_bf16 v[24:27], a[184:187], v[216:219], v[24:27]
v_fma_f32 v207, v207, s32, v230
v_add_u32 v249, s38, v251
v_mfma_f32_16x16x32_bf16 v[28:31], a[188:191], v[216:219], v[28:31]
v_exp_f32 v200, v200
v_mfma_f32_16x16x32_bf16 v[32:35], a[192:195], v[216:219], v[32:35]
v_exp_f32 v201, v201
v_mfma_f32_16x16x32_bf16 v[36:39], a[196:199], v[216:219], v[36:39]
v_exp_f32 v202, v202
v_mfma_f32_16x16x32_bf16 v[40:43], a[200:203], v[216:219], v[40:43]
v_exp_f32 v203, v203
v_mfma_f32_16x16x32_bf16 v[44:47], a[204:207], v[216:219], v[44:47]
v_exp_f32 v204, v204
v_mfma_f32_16x16x32_bf16 v[48:51], a[208:211], v[216:219], v[48:51]
v_exp_f32 v205, v205
v_mfma_f32_16x16x32_bf16 v[52:55], a[212:215], v[216:219], v[52:55]
v_exp_f32 v206, v206
v_mfma_f32_16x16x32_bf16 v[56:59], a[216:219], v[216:219], v[56:59]
v_exp_f32 v207, v207
v_mfma_f32_16x16x32_bf16 v[60:63], a[220:223], v[216:219], v[60:63]
v_cvt_pk_bf16_f32 v220, v200, v201
v_cvt_pk_bf16_f32 v221, v202, v203
v_mfma_f32_16x16x32_bf16 a[224:227], a[236:239], v[216:219], a[224:227]
v_cvt_pk_bf16_f32 v222, v204, v205
v_cvt_pk_bf16_f32 v223, v206, v207
s_nop 1
v_mfma_f32_16x16x32_bf16 v[64:67], a[160:163], v[220:223], v[64:67]
v_add_u32 v248, s38, v250
s_waitcnt vmcnt(6)
s_barrier
s_add_u32 s41, s37, s39
s_add_u32 m0, s41, 0
s_nop 0
buffer_load_dwordx4 v246, s[4:7], s36 offen offset:0 nt lds
ds_read_b128 a[96:99], v249 offset:0
v_mfma_f32_16x16x32_bf16 v[68:71], a[164:167], v[220:223], v[68:71]
ds_read_b128 a[100:103], v249 offset:8448
v_mfma_f32_16x16x32_bf16 v[72:75], a[168:171], v[220:223], v[72:75]
s_add_u32 m0, s41, 32
s_nop 0
buffer_load_dwordx4 v246, s[4:7], s36 offen offset:1024 nt lds
ds_read_b128 a[104:107], v249 offset:64
v_mfma_f32_16x16x32_bf16 v[76:79], a[172:175], v[220:223], v[76:79]
ds_read_b128 a[108:111], v249 offset:8512
v_mfma_f32_16x16x32_bf16 v[80:83], a[176:179], v[220:223], v[80:83]
s_add_u32 m0, s41, 64
s_nop 0
buffer_load_dwordx4 v246, s[4:7], s36 offen offset:2048 nt lds
ds_read_b128 a[112:115], v249 offset:128
v_mfma_f32_16x16x32_bf16 v[84:87], a[180:183], v[220:223], v[84:87]
ds_read_b128 a[116:119], v249 offset:8576
v_mfma_f32_16x16x32_bf16 v[88:91], a[184:187], v[220:223], v[88:91]
s_add_u32 m0, s41, 96
s_nop 0
buffer_load_dwordx4 v246, s[4:7], s36 offen offset:3072 nt lds
ds_read_b128 a[120:123], v249 offset:192
v_mfma_f32_16x16x32_bf16 v[92:95], a[188:191], v[220:223], v[92:95]
ds_read_b128 a[124:127], v249 offset:8640
v_mfma_f32_16x16x32_bf16 v[96:99], a[192:195], v[220:223], v[96:99]
s_add_u32 m0, s41, 4224
s_add_u32 s40, s36, 4096
buffer_load_dwordx4 v246, s[4:7], s40 offen nt lds
ds_read_b128 a[128:131], v249 offset:256
v_mfma_f32_16x16x32_bf16 v[100:103], a[196:199], v[220:223], v[100:103]
ds_read_b128 a[132:135], v249 offset:8704
v_mfma_f32_16x16x32_bf16 v[104:107], a[200:203], v[220:223], v[104:107]
s_add_u32 m0, s37, 15840
s_add_u32 s40, s36, s10
s_mov_b64 exec, s[20:21]
buffer_load_dwordx4 v246, s[4:7], s40 offen nt lds
s_mov_b64 exec, -1
ds_read_b128 a[136:139], v249 offset:320
v_mfma_f32_16x16x32_bf16 v[108:111], a[204:207], v[220:223], v[108:111]
ds_read_b128 a[140:143], v249 offset:8768
v_mfma_f32_16x16x32_bf16 v[112:115], a[208:211], v[220:223], v[112:115]
s_xor_b64 s[4:5], s[4:5], s[8:9]
s_add_u32 s45, s45, 8192
s_and_b32 s36, s45, 0x7c000
ds_read_b128 a[144:147], v249 offset:384
v_mfma_f32_16x16x32_bf16 v[116:119], a[212:215], v[220:223], v[116:119]
ds_read_b128 a[148:151], v249 offset:8832
v_mfma_f32_16x16x32_bf16 v[120:123], a[216:219], v[220:223], v[120:123]
s_add_u32 s37, s37, 16896
s_cmp_ge_u32 s37, 135168
s_cselect_b32 s37, 0, s37
ds_read_b128 a[152:155], v249 offset:448
v_mfma_f32_16x16x32_bf16 v[124:127], a[220:223], v[220:223], v[124:127]
ds_read_b128 a[156:159], v249 offset:8896
s_add_u32 s38, s38, 33792
s_cmp_ge_u32 s38, 135168
s_cselect_b32 s38, 0, s38
v_mfma_f32_16x16x32_bf16 a[228:231], a[236:239], v[220:223], a[228:231]
s_add_u32 s35, s35, 1
s_cmp_lt_u32 s35, 30
s_cbranch_scc1 L_loop3
s_waitcnt lgkmcnt(6)
v_mfma_f32_16x16x32_bf16 v[192:195], a[96:99], a[0:3], 0
ds_read_b64_tr_b16 a[160:161], v248 offset:16896
ds_read_b64_tr_b16 a[162:163], v248 offset:25344
v_mfma_f32_16x16x32_bf16 v[196:199], a[100:103], a[0:3], 0
ds_read_b64_tr_b16 a[164:165], v248 offset:16928
ds_read_b64_tr_b16 a[166:167], v248 offset:25376
v_mfma_f32_16x16x32_bf16 v[192:195], a[104:107], a[4:7], v[192:195]
ds_read_b64_tr_b16 a[168:169], v248 offset:16960
ds_read_b64_tr_b16 a[170:171], v248 offset:25408
v_mfma_f32_16x16x32_bf16 v[196:199], a[108:111], a[4:7], v[196:199]
ds_read_b64_tr_b16 a[172:173], v248 offset:16992
ds_read_b64_tr_b16 a[174:175], v248 offset:25440
v_mfma_f32_16x16x32_bf16 v[192:195], a[112:115], a[8:11], v[192:195]
ds_read_b64_tr_b16 a[176:177], v248 offset:17024
ds_read_b64_tr_b16 a[178:179], v248 offset:25472
v_mfma_f32_16x16x32_bf16 v[196:199], a[116:119], a[8:11], v[196:199]
ds_read_b64_tr_b16 a[180:181], v248 offset:17056
ds_read_b64_tr_b16 a[182:183], v248 offset:25504
v_mfma_f32_16x16x32_bf16 v[192:195], a[120:123], a[12:15], v[192:195]
ds_read_b64_tr_b16 a[184:185], v248 offset:17088
ds_read_b64_tr_b16 a[186:187], v248 offset:25536
v_mfma_f32_16x16x32_bf16 v[196:199], a[124:127], a[12:15], v[196:199]
ds_read_b64_tr_b16 a[188:189], v248 offset:17120
ds_read_b64_tr_b16 a[190:191], v248 offset:25568
v_mfma_f32_16x16x32_bf16 v[192:195], a[128:131], a[16:19], v[192:195]
ds_read_b64_tr_b16 a[192:193], v248 offset:17152
ds_read_b64_tr_b16 a[194:195], v248 offset:25600
v_mfma_f32_16x16x32_bf16 v[196:199], a[132:135], a[16:19], v[196:199]
ds_read_b64_tr_b16 a[196:197], v248 offset:17184
ds_read_b64_tr_b16 a[198:199], v248 offset:25632
s_waitcnt lgkmcnt(15)
v_mfma_f32_16x16x32_bf16 v[192:195], a[136:139], a[20:23], v[192:195]
ds_read_b64_tr_b16 a[200:201], v248 offset:17216
ds_read_b64_tr_b16 a[202:203], v248 offset:25664
v_mfma_f32_16x16x32_bf16 v[196:199], a[140:143], a[20:23], v[196:199]
ds_read_b64_tr_b16 a[204:205], v248 offset:17248
ds_read_b64_tr_b16 a[206:207], v248 offset:25696
v_mfma_f32_16x16x32_bf16 v[192:195], a[144:147], a[24:27], v[192:195]
ds_read_b64_tr_b16 a[208:209], v248 offset:17280
ds_read_b64_tr_b16 a[210:211], v248 offset:25728
s_add_u32 s89, s43, s100
s_add_u32 m0, s39, 0
s_add_u32 s40, s89, 0
buffer_load_dwordx4 v244, s[16:19], s40 offen lds
v_mfma_f32_16x16x32_bf16 v[196:199], a[148:151], a[24:27], v[196:199]
ds_read_b64_tr_b16 a[212:213], v248 offset:17312
v_mfma_f32_16x16x32_bf16 v[192:195], a[152:155], a[28:31], v[192:195]
ds_read_b64_tr_b16 a[214:215], v248 offset:25760
s_add_u32 m0, s39, 1056
s_add_u32 s40, s89, 896
buffer_load_dwordx4 v244, s[16:19], s40 offen lds
v_mfma_f32_16x16x32_bf16 v[196:199], a[156:159], a[28:31], v[196:199]
ds_read_b64_tr_b16 a[216:217], v248 offset:17344
v_mfma_f32_16x16x32_bf16 v[200:203], a[96:99], a[32:35], 0
ds_read_b64_tr_b16 a[218:219], v248 offset:25792
s_add_u32 m0, s39, 2112
s_add_u32 s40, s89, 1792
buffer_load_dwordx4 v244, s[16:19], s40 offen lds
v_mfma_f32_16x16x32_bf16 v[204:207], a[100:103], a[32:35], 0
ds_read_b64_tr_b16 a[220:221], v248 offset:17376
v_max3_f32 v234, v192, v193, v194
v_mfma_f32_16x16x32_bf16 v[200:203], a[104:107], a[36:39], v[200:203]
ds_read_b64_tr_b16 a[222:223], v248 offset:25824
s_add_u32 m0, s39, 3168
s_add_u32 s40, s89, 2688
buffer_load_dwordx4 v244, s[16:19], s40 offen lds
v_max3_f32 v235, v196, v197, v198
v_mfma_f32_16x16x32_bf16 v[204:207], a[108:111], a[36:39], v[204:207]
v_max3_f32 v234, v234, v195, v199
v_max_f32 v234, v234, v235
v_mfma_f32_16x16x32_bf16 v[200:203], a[112:115], a[40:43], v[200:203]
s_add_u32 m0, s39, 4224
s_add_u32 s40, s89, 3584
buffer_load_dwordx4 v244, s[16:19], s40 offen lds
v_cmp_gt_f32 vcc, v234, v229
s_cbranch_vccnz L_rare4_0
L_ret4_0:
v_fma_f32 v192, v192, s32, v228
v_mfma_f32_16x16x32_bf16 v[204:207], a[116:119], a[40:43], v[204:207]
v_fma_f32 v193, v193, s32, v228
v_fma_f32 v194, v194, s32, v228
v_mfma_f32_16x16x32_bf16 v[200:203], a[120:123], a[44:47], v[200:203]
s_add_u32 m0, s39, 16896
s_add_u32 s40, s89, 14336
buffer_load_dwordx4 v244, s[16:19], s40 offen lds
v_fma_f32 v195, v195, s32, v228
v_fma_f32 v196, v196, s32, v228
v_mfma_f32_16x16x32_bf16 v[204:207], a[124:127], a[44:47], v[204:207]
v_fma_f32 v197, v197, s32, v228
v_fma_f32 v198, v198, s32, v228
v_mfma_f32_16x16x32_bf16 v[200:203], a[128:131], a[48:51], v[200:203]
s_add_u32 m0, s39, 17952
s_add_u32 s40, s89, 15232
buffer_load_dwordx4 v244, s[16:19], s40 offen lds
v_fma_f32 v199, v199, s32, v228
v_mfma_f32_16x16x32_bf16 v[204:207], a[132:135], a[48:51], v[204:207]
v_exp_f32 v192, v192
v_mfma_f32_16x16x32_bf16 v[200:203], a[136:139], a[52:55], v[200:203]
s_add_u32 m0, s39, 19008
s_add_u32 s40, s89, 16128
buffer_load_dwordx4 v244, s[16:19], s40 offen lds
v_exp_f32 v193, v193
v_mfma_f32_16x16x32_bf16 v[204:207], a[140:143], a[52:55], v[204:207]
v_exp_f32 v194, v194
v_mfma_f32_16x16x32_bf16 v[200:203], a[144:147], a[56:59], v[200:203]
s_add_u32 m0, s39, 20064
s_add_u32 s40, s89, 17024
buffer_load_dwordx4 v244, s[16:19], s40 offen lds
v_exp_f32 v195, v195
v_mfma_f32_16x16x32_bf16 v[204:207], a[148:151], a[56:59], v[204:207]
v_exp_f32 v196, v196
v_mfma_f32_16x16x32_bf16 v[200:203], a[152:155], a[60:63], v[200:203]
s_add_u32 m0, s39, 21120
s_add_u32 s40, s89, 17920
buffer_load_dwordx4 v244, s[16:19], s40 offen lds
v_exp_f32 v197, v197
v_mfma_f32_16x16x32_bf16 v[204:207], a[156:159], a[60:63], v[204:207]
v_exp_f32 v198, v198
s_waitcnt lgkmcnt(0)
v_exp_f32 v199, v199
v_cvt_pk_bf16_f32 v216, v192, v193
v_cvt_pk_bf16_f32 v217, v194, v195
v_cvt_pk_bf16_f32 v218, v196, v197
v_cvt_pk_bf16_f32 v219, v198, v199
s_nop 1
v_mfma_f32_16x16x32_bf16 v[0:3], a[160:163], v[216:219], v[0:3]
s_cmp_eq_u32 s3, 3
s_cbranch_scc1 L_sk2
s_add_u32 m0, s44, 0
s_add_u32 s40, s100, s84
buffer_load_dwordx4 v244, s[16:19], s40 offen lds
L_sk2:
v_max3_f32 v236, v200, v201, v202
v_max3_f32 v237, v204, v205, v206
v_mfma_f32_16x16x32_bf16 v[4:7], a[164:167], v[216:219], v[4:7]
v_max3_f32 v236, v236, v203, v207
v_max_f32 v236, v236, v237
v_mfma_f32_16x16x32_bf16 v[8:11], a[168:171], v[216:219], v[8:11]
s_add_u32 s100, s100, 128
s_cmp_ge_u32 s100, 896
s_cselect_b32 s100, 0, s100
v_cmp_gt_f32 vcc, v236, v231
s_cbranch_vccnz L_rare4_1
L_ret4_1:
v_fma_f32 v200, v200, s32, v230
v_mfma_f32_16x16x32_bf16 v[12:15], a[172:175], v[216:219], v[12:15]
v_fma_f32 v201, v201, s32, v230
v_fma_f32 v202, v202, s32, v230
v_mfma_f32_16x16x32_bf16 v[16:19], a[176:179], v[216:219], v[16:19]
s_add_u32 s89, s43, s100
s_add_u32 m0, s39, 33792
s_add_u32 s40, s89, 0
buffer_load_dwordx4 v244, s[16:19], s40 offen lds
v_fma_f32 v203, v203, s32, v230
v_fma_f32 v204, v204, s32, v230
v_mfma_f32_16x16x32_bf16 v[20:23], a[180:183], v[216:219], v[20:23]
v_fma_f32 v205, v205, s32, v230
v_fma_f32 v206, v206, s32, v230
v_mfma_f32_16x16x32_bf16 v[24:27], a[184:187], v[216:219], v[24:27]
s_add_u32 m0, s39, 34848
s_add_u32 s40, s89, 896
buffer_load_dwordx4 v244, s[16:19], s40 offen lds
v_fma_f32 v207, v207, s32, v230
v_add_u32 v249, s38, v251
v_mfma_f32_16x16x32_bf16 v[28:31], a[188:191], v[216:219], v[28:31]
v_exp_f32 v200, v200
v_mfma_f32_16x16x32_bf16 v[32:35], a[192:195], v[216:219], v[32:35]
s_add_u32 m0, s39, 35904
s_add_u32 s40, s89, 1792
buffer_load_dwordx4 v244, s[16:19], s40 offen lds
v_exp_f32 v201, v201
v_mfma_f32_16x16x32_bf16 v[36:39], a[196:199], v[216:219], v[36:39]
v_exp_f32 v202, v202
v_mfma_f32_16x16x32_bf16 v[40:43], a[200:203], v[216:219], v[40:43]
s_add_u32 m0, s39, 36960
s_add_u32 s40, s89, 2688
buffer_load_dwordx4 v244, s[16:19], s40 offen lds
v_exp_f32 v203, v203
v_mfma_f32_16x16x32_bf16 v[44:47], a[204:207], v[216:219], v[44:47]
v_exp_f32 v204, v204
v_mfma_f32_16x16x32_bf16 v[48:51], a[208:211], v[216:219], v[48:51]
s_add_u32 m0, s39, 38016
s_add_u32 s40, s89, 3584
buffer_load_dwordx4 v244, s[16:19], s40 offen lds
v_exp_f32 v205, v205
v_mfma_f32_16x16x32_bf16 v[52:55], a[212:215], v[216:219], v[52:55]
v_exp_f32 v206, v206
v_mfma_f32_16x16x32_bf16 v[56:59], a[216:219], v[216:219], v[56:59]
s_add_u32 m0, s39, 50688
s_add_u32 s40, s89, 14336
buffer_load_dwordx4 v244, s[16:19], s40 offen lds
v_exp_f32 v207, v207
v_mfma_f32_16x16x32_bf16 v[60:63], a[220:223], v[216:219], v[60:63]
v_cvt_pk_bf16_f32 v220, v200, v201
v_cvt_pk_bf16_f32 v221, v202, v203
v_mfma_f32_16x16x32_bf16 a[224:227], a[236:239], v[216:219], a[224:227]
s_add_u32 m0, s39, 51744
s_add_u32 s40, s89, 15232
buffer_load_dwordx4 v244, s[16:19], s40 offen lds
v_cvt_pk_bf16_f32 v222, v204, v205
v_cvt_pk_bf16_f32 v223, v206, v207
s_nop 1
v_mfma_f32_16x16x32_bf16 v[64:67], a[160:163], v[220:223], v[64:67]
s_add_u32 m0, s39, 52800
s_add_u32 s40, s89, 16128
buffer_load_dwordx4 v244, s[16:19], s40 offen lds
s_add_u32 m0, s39, 53856
s_add_u32 s40, s89, 17024
buffer_load_dwordx4 v244, s[16:19], s40 offen lds
s_add_u32 m0, s39, 54912
s_add_u32 s40, s89, 17920
buffer_load_dwordx4 v244, s[16:19], s40 offen lds
s_cmp_eq_u32 s3, 3
s_cbranch_scc1 L_sk3
s_add_u32 m0, s44, 33792
s_add_u32 s40, s100, s84
buffer_load_dwordx4 v244, s[16:19], s40 offen lds
L_sk3:
s_add_u32 s100, s100, 128
s_cmp_ge_u32 s100, 896
s_cselect_b32 s100, 0, s100
v_add_u32 v248, s38, v250
s_waitcnt vmcnt(20)
s_barrier
s_add_u32 s89, s43, s100
s_add_u32 m0, s39, 67584
s_add_u32 s40, s89, 0
buffer_load_dwordx4 v244, s[16:19], s40 offen lds
ds_read_b128 a[96:99], v249 offset:0
v_mfma_f32_16x16x32_bf16 v[68:71], a[164:167], v[220:223], v[68:71]
ds_read_b128 a[100:103], v249 offset:8448
v_mfma_f32_16x16x32_bf16 v[72:75], a[168:171], v[220:223], v[72:75]
s_add_u32 m0, s39, 68640
s_add_u32 s40, s89, 896
buffer_load_dwordx4 v244, s[16:19], s40 offen lds
ds_read_b128 a[104:107], v249 offset:64
v_mfma_f32_16x16x32_bf16 v[76:79], a[172:175], v[220:223], v[76:79]
ds_read_b128 a[108:111], v249 offset:8512
v_mfma_f32_16x16x32_bf16 v[80:83], a[176:179], v[220:223], v[80:83]
s_add_u32 m0, s39, 69696
s_add_u32 s40, s89, 1792
buffer_load_dwordx4 v244, s[16:19], s40 offen lds
ds_read_b128 a[112:115], v249 offset:128
v_mfma_f32_16x16x32_bf16 v[84:87], a[180:183], v[220:223], v[84:87]
ds_read_b128 a[116:119], v249 offset:8576
v_mfma_f32_16x16x32_bf16 v[88:91], a[184:187], v[220:223], v[88:91]
s_add_u32 m0, s39, 70752
s_add_u32 s40, s89, 2688
buffer_load_dwordx4 v244, s[16:19], s40 offen lds
ds_read_b128 a[120:123], v249 offset:192
v_mfma_f32_16x16x32_bf16 v[92:95], a[188:191], v[220:223], v[92:95]
ds_read_b128 a[124:127], v249 offset:8640
v_mfma_f32_16x16x32_bf16 v[96:99], a[192:195], v[220:223], v[96:99]
s_add_u32 m0, s39, 71808
s_add_u32 s40, s89, 3584
buffer_load_dwordx4 v244, s[16:19], s40 offen lds
ds_read_b128 a[128:131], v249 offset:256
v_mfma_f32_16x16x32_bf16 v[100:103], a[196:199], v[220:223], v[100:103]
ds_read_b128 a[132:135], v249 offset:8704
v_mfma_f32_16x16x32_bf16 v[104:107], a[200:203], v[220:223], v[104:107]
s_add_u32 m0, s39, 84480
s_add_u32 s40, s89, 14336
buffer_load_dwordx4 v244, s[16:19], s40 offen lds
ds_read_b128 a[136:139], v249 offset:320
v_mfma_f32_16x16x32_bf16 v[108:111], a[204:207], v[220:223], v[108:111]
ds_read_b128 a[140:143], v249 offset:8768
v_mfma_f32_16x16x32_bf16 v[112:115], a[208:211], v[220:223], v[112:115]
s_add_u32 m0, s39, 85536
s_add_u32 s40, s89, 15232
buffer_load_dwordx4 v244, s[16:19], s40 offen lds
ds_read_b128 a[144:147], v249 offset:384
v_mfma_f32_16x16x32_bf16 v[116:119], a[212:215], v[220:223], v[116:119]
ds_read_b128 a[148:151], v249 offset:8832
v_mfma_f32_16x16x32_bf16 v[120:123], a[216:219], v[220:223], v[120:123]
s_add_u32 m0, s39, 86592
s_add_u32 s40, s89, 16128
buffer_load_dwordx4 v244, s[16:19], s40 offen lds
ds_read_b128 a[152:155], v249 offset:448
v_mfma_f32_16x16x32_bf16 v[124:127], a[220:223], v[220:223], v[124:127]
ds_read_b128 a[156:159], v249 offset:8896
v_mfma_f32_16x16x32_bf16 a[228:231], a[236:239], v[220:223], a[228:231]
s_add_u32 m0, s39, 87648
s_add_u32 s40, s89, 17024
buffer_load_dwordx4 v244, s[16:19], s40 offen lds
s_add_u32 m0, s39, 88704
s_add_u32 s40, s89, 17920
buffer_load_dwordx4 v244, s[16:19], s40 offen lds
s_cmp_eq_u32 s3, 3
s_cbranch_scc1 L_sk1
s_add_u32 m0, s44, 67584
s_add_u32 s40, s100, s84
buffer_load_dwordx4 v244, s[16:19], s40 offen lds
L_sk1:
s_add_u32 s100, s100, 128
s_cmp_ge_u32 s100, 896
s_cselect_b32 s100, 0, s100
s_add_u32 s38, s38, 33792
s_cmp_ge_u32 s38, 135168
s_cselect_b32 s38, 0, s38
s_waitcnt lgkmcnt(6)
v_mfma_f32_16x16x32_bf16 v[192:195], a[96:99], a[0:3], 0
ds_read_b64_tr_b16 a[160:161], v248 offset:16896
ds_read_b64_tr_b16 a[162:163], v248 offset:25344
v_mfma_f32_16x16x32_bf16 v[196:199], a[100:103], a[0:3], 0
ds_read_b64_tr_b16 a[164:165], v248 offset:16928
ds_read_b64_tr_b16 a[166:167], v248 offset:25376
v_mfma_f32_16x16x32_bf16 v[192:195], a[104:107], a[4:7], v[192:195]
ds_read_b64_tr_b16 a[168:169], v248 offset:16960
ds_read_b64_tr_b16 a[170:171], v248 offset:25408
v_mfma_f32_16x16x32_bf16 v[196:199], a[108:111], a[4:7], v[196:199]
ds_read_b64_tr_b16 a[172:173], v248 offset:16992
ds_read_b64_tr_b16 a[174:175], v248 offset:25440
v_mfma_f32_16x16x32_bf16 v[192:195], a[112:115], a[8:11], v[192:195]
ds_read_b64_tr_b16 a[176:177], v248 offset:17024
ds_read_b64_tr_b16 a[178:179], v248 offset:25472
v_mfma_f32_16x16x32_bf16 v[196:199], a[116:119], a[8:11], v[196:199]
ds_read_b64_tr_b16 a[180:181], v248 offset:17056
ds_read_b64_tr_b16 a[182:183], v248 offset:25504
v_mfma_f32_16x16x32_bf16 v[192:195], a[120:123], a[12:15], v[192:195]
ds_read_b64_tr_b16 a[184:185], v248 offset:17088
ds_read_b64_tr_b16 a[186:187], v248 offset:25536
v_mfma_f32_16x16x32_bf16 v[196:199], a[124:127], a[12:15], v[196:199]
ds_read_b64_tr_b16 a[188:189], v248 offset:17120
ds_read_b64_tr_b16 a[190:191], v248 offset:25568
v_mfma_f32_16x16x32_bf16 v[192:195], a[128:131], a[16:19], v[192:195]
ds_read_b64_tr_b16 a[192:193], v248 offset:17152
ds_read_b64_tr_b16 a[194:195], v248 offset:25600
v_mfma_f32_16x16x32_bf16 v[196:199], a[132:135], a[16:19], v[196:199]
ds_read_b64_tr_b16 a[196:197], v248 offset:17184
ds_read_b64_tr_b16 a[198:199], v248 offset:25632
s_waitcnt lgkmcnt(15)
v_mfma_f32_16x16x32_bf16 v[192:195], a[136:139], a[20:23], v[192:195]
ds_read_b64_tr_b16 a[200:201], v248 offset:17216
ds_read_b64_tr_b16 a[202:203], v248 offset:25664
v_mfma_f32_16x16x32_bf16 v[196:199], a[140:143], a[20:23], v[196:199]
ds_read_b64_tr_b16 a[204:205], v248 offset:17248
ds_read_b64_tr_b16 a[206:207], v248 offset:25696
v_mfma_f32_16x16x32_bf16 v[192:195], a[144:147], a[24:27], v[192:195]
ds_read_b64_tr_b16 a[208:209], v248 offset:17280
ds_read_b64_tr_b16 a[210:211], v248 offset:25728
v_mfma_f32_16x16x32_bf16 v[196:199], a[148:151], a[24:27], v[196:199]
ds_read_b64_tr_b16 a[212:213], v248 offset:17312
v_mfma_f32_16x16x32_bf16 v[192:195], a[152:155], a[28:31], v[192:195]
ds_read_b64_tr_b16 a[214:215], v248 offset:25760
v_mfma_f32_16x16x32_bf16 v[196:199], a[156:159], a[28:31], v[196:199]
ds_read_b64_tr_b16 a[216:217], v248 offset:17344
v_mfma_f32_16x16x32_bf16 v[200:203], a[96:99], a[32:35], 0
ds_read_b64_tr_b16 a[218:219], v248 offset:25792
v_mfma_f32_16x16x32_bf16 v[204:207], a[100:103], a[32:35], 0
ds_read_b64_tr_b16 a[220:221], v248 offset:17376
v_mfma_f32_16x16x32_bf16 v[200:203], a[104:107], a[36:39], v[200:203]
ds_read_b64_tr_b16 a[222:223], v248 offset:25824
v_mfma_f32_16x16x32_bf16 v[204:207], a[108:111], a[36:39], v[204:207]
v_max3_f32 v234, v192, v193, v194
v_max3_f32 v235, v196, v197, v198
v_mfma_f32_16x16x32_bf16 v[200:203], a[112:115], a[40:43], v[200:203]
v_max3_f32 v234, v234, v195, v199
v_max_f32 v234, v234, v235
v_mfma_f32_16x16x32_bf16 v[204:207], a[116:119], a[40:43], v[204:207]
v_cmp_gt_f32 vcc, v234, v229
s_cbranch_vccnz L_rare5_0
L_ret5_0:
v_fma_f32 v192, v192, s32, v228
v_mfma_f32_16x16x32_bf16 v[200:203], a[120:123], a[44:47], v[200:203]
v_fma_f32 v193, v193, s32, v228
v_fma_f32 v194, v194, s32, v228
v_mfma_f32_16x16x32_bf16 v[204:207], a[124:127], a[44:47], v[204:207]
v_fma_f32 v195, v195, s32, v228
v_fma_f32 v196, v196, s32, v228
v_mfma_f32_16x16x32_bf16 v[200:203], a[128:131], a[48:51], v[200:203]
v_fma_f32 v197, v197, s32, v228
v_fma_f32 v198, v198, s32, v228
v_mfma_f32_16x16x32_bf16 v[204:207], a[132:135], a[48:51], v[204:207]
v_fma_f32 v199, v199, s32, v228
v_mfma_f32_16x16x32_bf16 v[200:203], a[136:139], a[52:55], v[200:203]
v_exp_f32 v192, v192
v_mfma_f32_16x16x32_bf16 v[204:207], a[140:143], a[52:55], v[204:207]
v_exp_f32 v193, v193
v_mfma_f32_16x16x32_bf16 v[200:203], a[144:147], a[56:59], v[200:203]
v_exp_f32 v194, v194
v_mfma_f32_16x16x32_bf16 v[204:207], a[148:151], a[56:59], v[204:207]
v_exp_f32 v195, v195
v_mfma_f32_16x16x32_bf16 v[200:203], a[152:155], a[60:63], v[200:203]
v_exp_f32 v196, v196
v_mfma_f32_16x16x32_bf16 v[204:207], a[156:159], a[60:63], v[204:207]
v_exp_f32 v197, v197
s_waitcnt lgkmcnt(0)
v_exp_f32 v198, v198
v_exp_f32 v199, v199
v_cvt_pk_bf16_f32 v216, v192, v193
v_cvt_pk_bf16_f32 v217, v194, v195
v_cvt_pk_bf16_f32 v218, v196, v197
v_cvt_pk_bf16_f32 v219, v198, v199
s_nop 1
v_mfma_f32_16x16x32_bf16 v[0:3], a[160:163], v[216:219], v[0:3]
v_max3_f32 v236, v200, v201, v202
v_max3_f32 v237, v204, v205, v206
v_mfma_f32_16x16x32_bf16 v[4:7], a[164:167], v[216:219], v[4:7]
v_max3_f32 v236, v236, v203, v207
v_max_f32 v236, v236, v237
v_mfma_f32_16x16x32_bf16 v[8:11], a[168:171], v[216:219], v[8:11]
v_cmp_gt_f32 vcc, v236, v231
s_cbranch_vccnz L_rare5_1
L_ret5_1:
v_fma_f32 v200, v200, s32, v230
v_mfma_f32_16x16x32_bf16 v[12:15], a[172:175], v[216:219], v[12:15]
v_fma_f32 v201, v201, s32, v230
v_fma_f32 v202, v202, s32, v230
v_mfma_f32_16x16x32_bf16 v[16:19], a[176:179], v[216:219], v[16:19]
v_fma_f32 v203, v203, s32, v230
v_fma_f32 v204, v204, s32, v230
v_mfma_f32_16x16x32_bf16 v[20:23], a[180:183], v[216:219], v[20:23]
v_fma_f32 v205, v205, s32, v230
v_fma_f32 v206, v206, s32, v230
v_mfma_f32_16x16x32_bf16 v[24:27], a[184:187], v[216:219], v[24:27]
v_fma_f32 v207, v207, s32, v230
v_add_u32 v249, s38, v251
v_mfma_f32_16x16x32_bf16 v[28:31], a[188:191], v[216:219], v[28:31]
v_exp_f32 v200, v200
v_mfma_f32_16x16x32_bf16 v[32:35], a[192:195], v[216:219], v[32:35]
v_exp_f32 v201, v201
v_mfma_f32_16x16x32_bf16 v[36:39], a[196:199], v[216:219], v[36:39]
v_exp_f32 v202, v202
v_mfma_f32_16x16x32_bf16 v[40:43], a[200:203], v[216:219], v[40:43]
v_exp_f32 v203, v203
v_mfma_f32_16x16x32_bf16 v[44:47], a[204:207], v[216:219], v[44:47]
v_exp_f32 v204, v204
v_mfma_f32_16x16x32_bf16 v[48:51], a[208:211], v[216:219], v[48:51]
v_exp_f32 v205, v205
v_mfma_f32_16x16x32_bf16 v[52:55], a[212:215], v[216:219], v[52:55]
v_exp_f32 v206, v206
v_mfma_f32_16x16x32_bf16 v[56:59], a[216:219], v[216:219], v[56:59]
v_exp_f32 v207, v207
v_mfma_f32_16x16x32_bf16 v[60:63], a[220:223], v[216:219], v[60:63]
v_cvt_pk_bf16_f32 v220, v200, v201
v_cvt_pk_bf16_f32 v221, v202, v203
v_mfma_f32_16x16x32_bf16 a[224:227], a[236:239], v[216:219], a[224:227]
v_cvt_pk_bf16_f32 v222, v204, v205
v_cvt_pk_bf16_f32 v223, v206, v207
s_nop 1
v_mfma_f32_16x16x32_bf16 v[64:67], a[160:163], v[220:223], v[64:67]
v_add_u32 v248, s38, v250
s_barrier
s_add_u32 s89, s43, s100
s_add_u32 m0, s39, 101376
s_add_u32 s40, s89, 0
buffer_load_dwordx4 v244, s[16:19], s40 offen lds
ds_read_b128 a[96:99], v249 offset:0
v_mfma_f32_16x16x32_bf16 v[68:71], a[164:167], v[220:223], v[68:71]
ds_read_b128 a[100:103], v249 offset:8448
v_mfma_f32_16x16x32_bf16 v[72:75], a[168:171], v[220:223], v[72:75]
s_add_u32 m0, s39, 102432
s_add_u32 s40, s89, 896
buffer_load_dwordx4 v244, s[16:19], s40 offen lds
ds_read_b128 a[104:107], v249 offset:64
v_mfma_f32_16x16x32_bf16 v[76:79], a[172:175], v[220:223], v[76:79]
ds_read_b128 a[108:111], v249 offset:8512
v_mfma_f32_16x16x32_bf16 v[80:83], a[176:179], v[220:223], v[80:83]
s_add_u32 m0, s39, 103488
s_add_u32 s40, s89, 1792
buffer_load_dwordx4 v244, s[16:19], s40 offen lds
ds_read_b128 a[112:115], v249 offset:128
v_mfma_f32_16x16x32_bf16 v[84:87], a[180:183], v[220:223], v[84:87]
ds_read_b128 a[116:119], v249 offset:8576
v_mfma_f32_16x16x32_bf16 v[88:91], a[184:187], v[220:223], v[88:91]
s_add_u32 m0, s39, 104544
s_add_u32 s40, s89, 2688
buffer_load_dwordx4 v244, s[16:19], s40 offen lds
ds_read_b128 a[120:123], v249 offset:192
v_mfma_f32_16x16x32_bf16 v[92:95], a[188:191], v[220:223], v[92:95]
ds_read_b128 a[124:127], v249 offset:8640
v_mfma_f32_16x16x32_bf16 v[96:99], a[192:195], v[220:223], v[96:99]
s_add_u32 m0, s39, 105600
s_add_u32 s40, s89, 3584
buffer_load_dwordx4 v244, s[16:19], s40 offen lds
ds_read_b128 a[128:131], v249 offset:256
v_mfma_f32_16x16x32_bf16 v[100:103], a[196:199], v[220:223], v[100:103]
ds_read_b128 a[132:135], v249 offset:8704
v_mfma_f32_16x16x32_bf16 v[104:107], a[200:203], v[220:223], v[104:107]
s_add_u32 m0, s39, 118272
s_add_u32 s40, s89, 14336
buffer_load_dwordx4 v244, s[16:19], s40 offen lds
ds_read_b128 a[136:139], v249 offset:320
v_mfma_f32_16x16x32_bf16 v[108:111], a[204:207], v[220:223], v[108:111]
ds_read_b128 a[140:143], v249 offset:8768
v_mfma_f32_16x16x32_bf16 v[112:115], a[208:211], v[220:223], v[112:115]
s_add_u32 m0, s39, 119328
s_add_u32 s40, s89, 15232
buffer_load_dwordx4 v244, s[16:19], s40 offen lds
ds_read_b128 a[144:147], v249 offset:384
v_mfma_f32_16x16x32_bf16 v[116:119], a[212:215], v[220:223], v[116:119]
ds_read_b128 a[148:151], v249 offset:8832
v_mfma_f32_16x16x32_bf16 v[120:123], a[216:219], v[220:223], v[120:123]
s_add_u32 m0, s39, 120384
s_add_u32 s40, s89, 16128
buffer_load_dwordx4 v244, s[16:19], s40 offen lds
ds_read_b128 a[152:155], v249 offset:448
v_mfma_f32_16x16x32_bf16 v[124:127], a[220:223], v[220:223], v[124:127]
ds_read_b128 a[156:159], v249 offset:8896
v_mfma_f32_16x16x32_bf16 a[228:231], a[236:239], v[220:223], a[228:231]
s_add_u32 m0, s39, 121440
s_add_u32 s40, s89, 17024
buffer_load_dwordx4 v244, s[16:19], s40 offen lds
s_add_u32 m0, s39, 122496
s_add_u32 s40, s89, 17920
buffer_load_dwordx4 v244, s[16:19], s40 offen lds
s_cmp_eq_u32 s3, 3
s_cbranch_scc1 L_sk4
s_add_u32 m0, s44, 101376
s_add_u32 s40, s100, s84
buffer_load_dwordx4 v244, s[16:19], s40 offen lds
L_sk4:
s_add_u32 s100, s100, 128
s_cmp_ge_u32 s100, 896
s_cselect_b32 s100, 0, s100
s_add_u32 s38, s38, 33792
s_cmp_ge_u32 s38, 135168
s_cselect_b32 s38, 0, s38
v_mov_b32 v246, 143344
ds_read_b32 v247, v246
v_mov_b32 v250, 61440
v_mov_b32 v238, s96
v_cmp_eq_u32 vcc, 0, v255
v_lshlrev_b32 v242, 4, v255
v_lshlrev_b32 v241, 3, v255
s_lshl_b32 s85, s3, 13
s_lshl_b32 s86, s3, 9
s_add_u32 s86, s86, 40960
s_mov_b32 s87, 32768
s_mov_b32 s88, 43008
v_add_u32 v240, 143360, v242
v_add_u32 v252, 159744, v241
v_cndmask_b32 v250, v250, v238, vcc
buffer_load_dword v245, v250, s[12:15], 0 offen sc1
s_waitcnt lgkmcnt(0)
v_readfirstlane_b32 s38, v247
s_mov_b32 s38, 1
s_cmp_eq_u32 s38, 0
s_cbranch_scc1 L_loc1
v_sub_f32 v192, 0, v230
v_accvgpr_read_b32 v193, a228
v_cvt_pk_bf16_f32 v64, v64, v65
v_cvt_pk_bf16_f32 v65, v66, v67
v_cvt_pk_bf16_f32 v66, v68, v69
v_cvt_pk_bf16_f32 v67, v70, v71
buffer_store_dwordx4 v[64:67], v242, s[28:31], s85 offen offset:0 sc1
v_cvt_pk_bf16_f32 v68, v72, v73
v_cvt_pk_bf16_f32 v69, v74, v75
v_cvt_pk_bf16_f32 v70, v76, v77
v_cvt_pk_bf16_f32 v71, v78, v79
buffer_store_dwordx4 v[68:71], v242, s[28:31], s85 offen offset:1024 sc1
v_cvt_pk_bf16_f32 v72, v80, v81
v_cvt_pk_bf16_f32 v73, v82, v83
v_cvt_pk_bf16_f32 v74, v84, v85
v_cvt_pk_bf16_f32 v75, v86, v87
buffer_store_dwordx4 v[72:75], v242, s[28:31], s85 offen offset:2048 sc1
v_cvt_pk_bf16_f32 v76, v88, v89
v_cvt_pk_bf16_f32 v77, v90, v91
v_cvt_pk_bf16_f32 v78, v92, v93
v_cvt_pk_bf16_f32 v79, v94, v95
buffer_store_dwordx4 v[76:79], v242, s[28:31], s85 offen offset:3072 sc1
v_cvt_pk_bf16_f32 v80, v96, v97
v_cvt_pk_bf16_f32 v81, v98, v99
v_cvt_pk_bf16_f32 v82, v100, v101
v_cvt_pk_bf16_f32 v83, v102, v103
s_add_u32 s40, s85, 4096
buffer_store_dwordx4 v[80:83], v242, s[28:31], s40 offen offset:0 sc1
v_cvt_pk_bf16_f32 v84, v104, v105
v_cvt_pk_bf16_f32 v85, v106, v107
v_cvt_pk_bf16_f32 v86, v108, v109
v_cvt_pk_bf16_f32 v87, v110, v111
buffer_store_dwordx4 v[84:87], v242, s[28:31], s40 offen offset:1024 sc1
v_cvt_pk_bf16_f32 v88, v112, v113
v_cvt_pk_bf16_f32 v89, v114, v115
v_cvt_pk_bf16_f32 v90, v116, v117
v_cvt_pk_bf16_f32 v91, v118, v119
buffer_store_dwordx4 v[88:91], v242, s[28:31], s40 offen offset:2048 sc1
v_cvt_pk_bf16_f32 v92, v120, v121
v_cvt_pk_bf16_f32 v93, v122, v123
v_cvt_pk_bf16_f32 v94, v124, v125
v_cvt_pk_bf16_f32 v95, v126, v127
buffer_store_dwordx4 v[92:95], v242, s[28:31], s40 offen offset:3072 sc1
buffer_store_dwordx2 v[192:193], v241, s[28:31], s86 offen sc1
s_branch L_sent1
L_loc1:
v_sub_f32 v192, 0, v230
v_accvgpr_read_b32 v193, a228
v_cvt_pk_bf16_f32 v64, v64, v65
v_cvt_pk_bf16_f32 v65, v66, v67
v_cvt_pk_bf16_f32 v66, v68, v69
v_cvt_pk_bf16_f32 v67, v70, v71
buffer_store_dwordx4 v[64:67], v242, s[28:31], s85 offen offset:0
v_cvt_pk_bf16_f32 v68, v72, v73
v_cvt_pk_bf16_f32 v69, v74, v75
v_cvt_pk_bf16_f32 v70, v76, v77
v_cvt_pk_bf16_f32 v71, v78, v79
buffer_store_dwordx4 v[68:71], v242, s[28:31], s85 offen offset:1024
v_cvt_pk_bf16_f32 v72, v80, v81
v_cvt_pk_bf16_f32 v73, v82, v83
v_cvt_pk_bf16_f32 v74, v84, v85
v_cvt_pk_bf16_f32 v75, v86, v87
buffer_store_dwordx4 v[72:75], v242, s[28:31], s85 offen offset:2048
v_cvt_pk_bf16_f32 v76, v88, v89
v_cvt_pk_bf16_f32 v77, v90, v91
v_cvt_pk_bf16_f32 v78, v92, v93
v_cvt_pk_bf16_f32 v79, v94, v95
buffer_store_dwordx4 v[76:79], v242, s[28:31], s85 offen offset:3072
v_cvt_pk_bf16_f32 v80, v96, v97
v_cvt_pk_bf16_f32 v81, v98, v99
v_cvt_pk_bf16_f32 v82, v100, v101
v_cvt_pk_bf16_f32 v83, v102, v103
s_add_u32 s40, s85, 4096
buffer_store_dwordx4 v[80:83], v242, s[28:31], s40 offen offset:0
v_cvt_pk_bf16_f32 v84, v104, v105
v_cvt_pk_bf16_f32 v85, v106, v107
v_cvt_pk_bf16_f32 v86, v108, v109
v_cvt_pk_bf16_f32 v87, v110, v111
buffer_store_dwordx4 v[84:87], v242, s[28:31], s40 offen offset:1024
v_cvt_pk_bf16_f32 v88, v112, v113
v_cvt_pk_bf16_f32 v89, v114, v115
v_cvt_pk_bf16_f32 v90, v116, v117
v_cvt_pk_bf16_f32 v91, v118, v119
buffer_store_dwordx4 v[88:91], v242, s[28:31], s40 offen offset:2048
v_cvt_pk_bf16_f32 v92, v120, v121
v_cvt_pk_bf16_f32 v93, v122, v123
v_cvt_pk_bf16_f32 v94, v124, v125
v_cvt_pk_bf16_f32 v95, v126, v127
buffer_store_dwordx4 v[92:95], v242, s[28:31], s40 offen offset:3072
buffer_store_dwordx2 v[192:193], v241, s[28:31], s86 offen
L_sent1:
L_tail:
s_lshl_b32 s45, s3, 11
s_add_u32 s45, s45, 32768
v_mov_b32 v238, 1
s_waitcnt vmcnt(9)
v_cmp_eq_u32 vcc, 0, v245
s_mov_b32 s98, 0
s_cbranch_vccnz L_notyet
buffer_load_dwordx2 v[224:225], v241, s[12:15], s86 offen sc1
buffer_load_dwordx4 v[64:67], v242, s[12:15], s85 offen offset:0 sc1
buffer_load_dwordx4 v[68:71], v242, s[12:15], s85 offen offset:1024 sc1
buffer_load_dwordx4 v[72:75], v242, s[12:15], s85 offen offset:2048 sc1
buffer_load_dwordx4 v[76:79], v242, s[12:15], s85 offen offset:3072 sc1
s_add_u32 s40, s85, 4096
buffer_load_dwordx4 v[80:83], v242, s[12:15], s40 offen offset:0 sc1
buffer_load_dwordx4 v[84:87], v242, s[12:15], s40 offen offset:1024 sc1
buffer_load_dwordx4 v[88:91], v242, s[12:15], s40 offen offset:2048 sc1
buffer_load_dwordx4 v[92:95], v242, s[12:15], s40 offen offset:3072 sc1
buffer_load_dwordx2 v[226:227], v241, s[12:15], s88 offen sc1
buffer_load_dwordx4 v[112:115], v242, s[12:15], s45 offen offset:0 sc1
buffer_load_dwordx4 v[116:119], v242, s[12:15], s45 offen offset:1024 sc1
s_mov_b32 s98, 1
s_waitcnt vmcnt(12)
s_branch L_flag
L_notyet:
s_waitcnt vmcnt(0)
L_flag:
s_cmp_eq_u32 s38, 0
s_cbranch_scc1 L_flagl
buffer_store_dword v238, v239, s[28:31], s96 offen sc1
s_branch L_flagd
L_flagl:
buffer_store_dword v238, v239, s[28:31], s96 offen
L_flagd:
s_mul_i32 s100, s82, 512
s_sub_u32 s100, 512, s100
v_accvgpr_read_b32 v229, a224
s_lshl_b32 s89, s3, 5
v_add_u32 v254, s89, v254
v_add_u32 v253, 67584, v254
s_lshl_b32 s40, s3, 12
v_add_u32 v240, s40, v240
s_waitcnt lgkmcnt(0)
s_barrier
ds_read_b128 v[96:99], v240 offset:0
ds_read_b128 v[100:103], v240 offset:1024
ds_read_b128 v[104:107], v240 offset:2048
ds_read_b128 v[108:111], v240 offset:3072
ds_read_b64 v[120:121], v252
ds_read_b64_tr_b16 a[160:161], v254 offset:0
ds_read_b64_tr_b16 a[162:163], v254 offset:16896
ds_read_b64_tr_b16 a[164:165], v254 offset:128
ds_read_b64_tr_b16 a[166:167], v254 offset:17024
ds_read_b64_tr_b16 a[168:169], v254 offset:256
ds_read_b64_tr_b16 a[170:171], v254 offset:17152
ds_read_b64_tr_b16 a[172:173], v254 offset:384
ds_read_b64_tr_b16 a[174:175], v254 offset:17280
ds_read_b64_tr_b16 a[176:177], v254 offset:512
ds_read_b64_tr_b16 a[178:179], v254 offset:17408
ds_read_b64_tr_b16 a[180:181], v254 offset:640
ds_read_b64_tr_b16 a[182:183], v254 offset:17536
ds_read_b64_tr_b16 a[184:185], v254 offset:768
ds_read_b64_tr_b16 a[186:187], v254 offset:17664
ds_read_b64_tr_b16 a[188:189], v254 offset:896
ds_read_b64_tr_b16 a[190:191], v254 offset:17792
ds_read_b64_tr_b16 a[192:193], v254 offset:33792
ds_read_b64_tr_b16 a[194:195], v254 offset:50688
ds_read_b64_tr_b16 a[196:197], v254 offset:33920
ds_read_b64_tr_b16 a[198:199], v254 offset:50816
ds_read_b64_tr_b16 a[200:201], v254 offset:34048
ds_read_b64_tr_b16 a[202:203], v254 offset:50944
ds_read_b64_tr_b16 a[204:205], v254 offset:34176
ds_read_b64_tr_b16 a[206:207], v254 offset:51072
ds_read_b64_tr_b16 a[208:209], v254 offset:34304
ds_read_b64_tr_b16 a[210:211], v254 offset:51200
ds_read_b64_tr_b16 a[212:213], v254 offset:34432
ds_read_b64_tr_b16 a[214:215], v254 offset:51328
ds_read_b64_tr_b16 a[216:217], v254 offset:34560
ds_read_b64_tr_b16 a[218:219], v254 offset:51456
ds_read_b64_tr_b16 a[220:221], v254 offset:34688
ds_read_b64_tr_b16 a[222:223], v254 offset:51584
ds_read_b64_tr_b16 a[224:225], v253 offset:0
ds_read_b64_tr_b16 a[226:227], v253 offset:16896
ds_read_b64_tr_b16 a[228:229], v253 offset:128
ds_read_b64_tr_b16 a[230:231], v253 offset:17024
ds_read_b64_tr_b16 a[232:233], v253 offset:256
ds_read_b64_tr_b16 a[234:235], v253 offset:17152
ds_read_b64_tr_b16 a[236:237], v253 offset:384
ds_read_b64_tr_b16 a[238:239], v253 offset:17280
ds_read_b64_tr_b16 a[240:241], v253 offset:512
ds_read_b64_tr_b16 a[242:243], v253 offset:17408
ds_read_b64_tr_b16 a[244:245], v253 offset:640
ds_read_b64_tr_b16 a[246:247], v253 offset:17536
ds_read_b64_tr_b16 a[248:249], v253 offset:768
ds_read_b64_tr_b16 a[250:251], v253 offset:17664
ds_read_b64_tr_b16 a[252:253], v253 offset:896
ds_read_b64_tr_b16 a[254:255], v253 offset:17792
ds_read_b64_tr_b16 v[192:193], v253 offset:33792
ds_read_b64_tr_b16 v[194:195], v253 offset:50688
ds_read_b64_tr_b16 v[196:197], v253 offset:33920
ds_read_b64_tr_b16 v[198:199], v253 offset:50816
ds_read_b64_tr_b16 v[200:201], v253 offset:34048
ds_read_b64_tr_b16 v[202:203], v253 offset:50944
ds_read_b64_tr_b16 v[204:205], v253 offset:34176
ds_read_b64_tr_b16 v[206:207], v253 offset:51072
ds_read_b64_tr_b16 v[208:209], v253 offset:34304
ds_read_b64_tr_b16 v[210:211], v253 offset:51200
ds_read_b64_tr_b16 v[212:213], v253 offset:34432
ds_read_b64_tr_b16 v[214:215], v253 offset:51328
ds_read_b64_tr_b16 v[216:217], v253 offset:34560
ds_read_b64_tr_b16 v[218:219], v253 offset:51456
ds_read_b64_tr_b16 v[220:221], v253 offset:34688
ds_read_b64_tr_b16 v[222:223], v253 offset:51584
v_add_u32 v240, 101376, v242
v_add_u32 v251, s85, v240
v_add_u32 v252, s45, v240
buffer_load_dword v245, v250, s[12:15], 0 offen sc1
s_waitcnt lgkmcnt(0)
s_barrier
s_add_u32 s89, s42, s100
s_add_u32 s100, s100, 128
s_cmp_ge_u32 s100, 896
s_cselect_b32 s100, 0, s100
s_add_u32 m0, s46, 0
s_add_u32 s40, s89, 0
buffer_load_dwordx4 v244, s[16:19], s40 offen lds
s_add_u32 m0, s46, 1056
s_add_u32 s40, s89, 896
buffer_load_dwordx4 v244, s[16:19], s40 offen lds
s_add_u32 m0, s46, 2112
s_add_u32 s40, s89, 1792
buffer_load_dwordx4 v244, s[16:19], s40 offen lds
s_add_u32 m0, s46, 3168
s_add_u32 s40, s89, 2688
buffer_load_dwordx4 v244, s[16:19], s40 offen lds
s_add_u32 m0, s46, 4224
s_add_u32 s40, s89, 3584
buffer_load_dwordx4 v244, s[16:19], s40 offen lds
s_add_u32 m0, s46, 5280
s_add_u32 s40, s89, 4480
buffer_load_dwordx4 v244, s[16:19], s40 offen lds
s_add_u32 m0, s46, 6336
s_add_u32 s40, s89, 5376
buffer_load_dwordx4 v244, s[16:19], s40 offen lds
s_add_u32 m0, s46, 7392
s_add_u32 s40, s89, 6272
buffer_load_dwordx4 v244, s[16:19], s40 offen lds
s_cmp_eq_u32 s98, 1
s_cbranch_scc1 L_have
s_waitcnt vmcnt(8)
v_cmp_eq_u32 vcc, 0, v245
s_cbranch_vccz L_fpoll_ok
s_mov_b32 s35, 0
L_fpoll:
buffer_load_dword v245, v250, s[12:15], 0 offen sc1
s_waitcnt vmcnt(0)
v_cmp_eq_u32 vcc, 0, v245
s_add_u32 s35, s35, 1
s_cbranch_vccz L_fpoll_ok
s_sleep 2
s_cmp_lt_u32 s35, 0x200000
s_cbranch_scc1 L_fpoll
L_fpoll_ok:
buffer_load_dwordx2 v[224:225], v241, s[12:15], s86 offen sc1
buffer_load_dwordx4 v[64:67], v242, s[12:15], s85 offen offset:0 sc1
buffer_load_dwordx4 v[68:71], v242, s[12:15], s85 offen offset:1024 sc1
buffer_load_dwordx4 v[72:75], v242, s[12:15], s85 offen offset:2048 sc1
buffer_load_dwordx4 v[76:79], v242, s[12:15], s85 offen offset:3072 sc1
s_add_u32 s40, s85, 4096
buffer_load_dwordx4 v[80:83], v242, s[12:15], s40 offen offset:0 sc1
buffer_load_dwordx4 v[84:87], v242, s[12:15], s40 offen offset:1024 sc1
buffer_load_dwordx4 v[88:91], v242, s[12:15], s40 offen offset:2048 sc1
buffer_load_dwordx4 v[92:95], v242, s[12:15], s40 offen offset:3072 sc1
buffer_load_dwordx2 v[226:227], v241, s[12:15], s88 offen sc1
buffer_load_dwordx4 v[112:115], v242, s[12:15], s45 offen offset:0 sc1
buffer_load_dwordx4 v[116:119], v242, s[12:15], s45 offen offset:1024 sc1
L_have:
s_add_u32 s89, s42, s100
s_add_u32 s100, s100, 128
s_cmp_ge_u32 s100, 896
s_cselect_b32 s100, 0, s100
s_add_u32 m0, s46, 33792
s_add_u32 s40, s89, 0
buffer_load_dwordx4 v244, s[16:19], s40 offen lds
s_add_u32 m0, s46, 34848
s_add_u32 s40, s89, 896
buffer_load_dwordx4 v244, s[16:19], s40 offen lds
s_add_u32 m0, s46, 35904
s_add_u32 s40, s89, 1792
buffer_load_dwordx4 v244, s[16:19], s40 offen lds
s_add_u32 m0, s46, 36960
s_add_u32 s40, s89, 2688
buffer_load_dwordx4 v244, s[16:19], s40 offen lds
s_add_u32 m0, s46, 38016
s_add_u32 s40, s89, 3584
buffer_load_dwordx4 v244, s[16:19], s40 offen lds
s_add_u32 m0, s46, 39072
s_add_u32 s40, s89, 4480
buffer_load_dwordx4 v244, s[16:19], s40 offen lds
s_add_u32 m0, s46, 40128
s_add_u32 s40, s89, 5376
buffer_load_dwordx4 v244, s[16:19], s40 offen lds
s_add_u32 m0, s46, 41184
s_add_u32 s40, s89, 6272
buffer_load_dwordx4 v244, s[16:19], s40 offen lds
s_mul_i32 s85, s82, 57344
s_mul_i32 s86, s3, 14336
s_add_u32 s85, s85, s86
s_lshl_b32 s87, s3, 12
s_add_u32 s87, s87, 114688
s_cmp_eq_u32 s82, 0
s_cselect_b32 s87, s87, 1073741824
s_waitcnt vmcnt(19)
v_max_f32 v246, v224, -v228
v_sub_f32 v234, -v228, v246
v_sub_f32 v236, v224, v246
v_exp_f32 v234, v234
v_exp_f32 v236, v236
v_mul_f32 v246, v229, v234
v_fma_f32 v246, v225, v236, v246
v_rcp_f32 v246, v246
s_nop 0
v_mul_f32 v234, v234, v246
v_mul_f32 v236, v236, v246
v_mov_b32 v235, v234
v_mov_b32 v237, v236
s_waitcnt vmcnt(18)
v_pk_mul_f32 v[0:1], v[0:1], v[234:235]
v_lshlrev_b32 v246, 16, v64
v_and_b32 v247, 0xffff0000, v64
v_pk_fma_f32 v[0:1], v[246:247], v[236:237], v[0:1]
v_pk_mul_f32 v[2:3], v[2:3], v[234:235]
v_lshlrev_b32 v248, 16, v65
v_and_b32 v249, 0xffff0000, v65
v_pk_fma_f32 v[2:3], v[248:249], v[236:237], v[2:3]
v_pk_mul_f32 v[4:5], v[4:5], v[234:235]
v_lshlrev_b32 v246, 16, v66
v_and_b32 v247, 0xffff0000, v66
v_pk_fma_f32 v[4:5], v[246:247], v[236:237], v[4:5]
v_pk_mul_f32 v[6:7], v[6:7], v[234:235]
v_lshlrev_b32 v248, 16, v67
v_and_b32 v249, 0xffff0000, v67
v_pk_fma_f32 v[6:7], v[248:249], v[236:237], v[6:7]
v_cvt_pk_bf16_f32 v64, v0, v1
v_cvt_pk_bf16_f32 v65, v2, v3
v_cvt_pk_bf16_f32 v66, v4, v5
v_cvt_pk_bf16_f32 v67, v6, v7
ds_write_b128 v251, v[64:67] offset:0
s_waitcnt vmcnt(17)
v_pk_mul_f32 v[8:9], v[8:9], v[234:235]
v_lshlrev_b32 v246, 16, v68
v_and_b32 v247, 0xffff0000, v68
v_pk_fma_f32 v[8:9], v[246:247], v[236:237], v[8:9]
v_pk_mul_f32 v[10:11], v[10:11], v[234:235]
v_lshlrev_b32 v248, 16, v69
v_and_b32 v249, 0xffff0000, v69
v_pk_fma_f32 v[10:11], v[248:249], v[236:237], v[10:11]
v_pk_mul_f32 v[12:13], v[12:13], v[234:235]
v_lshlrev_b32 v246, 16, v70
v_and_b32 v247, 0xffff0000, v70
v_pk_fma_f32 v[12:13], v[246:247], v[236:237], v[12:13]
v_pk_mul_f32 v[14:15], v[14:15], v[234:235]
v_lshlrev_b32 v248, 16, v71
v_and_b32 v249, 0xffff0000, v71
v_pk_fma_f32 v[14:15], v[248:249], v[236:237], v[14:15]
v_cvt_pk_bf16_f32 v68, v8, v9
v_cvt_pk_bf16_f32 v69, v10, v11
v_cvt_pk_bf16_f32 v70, v12, v13
v_cvt_pk_bf16_f32 v71, v14, v15
ds_write_b128 v251, v[68:71] offset:1024
s_waitcnt vmcnt(16)
v_pk_mul_f32 v[16:17], v[16:17], v[234:235]
v_lshlrev_b32 v246, 16, v72
v_and_b32 v247, 0xffff0000, v72
v_pk_fma_f32 v[16:17], v[246:247], v[236:237], v[16:17]
v_pk_mul_f32 v[18:19], v[18:19], v[234:235]
v_lshlrev_b32 v248, 16, v73
v_and_b32 v249, 0xffff0000, v73
v_pk_fma_f32 v[18:19], v[248:249], v[236:237], v[18:19]
v_pk_mul_f32 v[20:21], v[20:21], v[234:235]
v_lshlrev_b32 v246, 16, v74
v_and_b32 v247, 0xffff0000, v74
v_pk_fma_f32 v[20:21], v[246:247], v[236:237], v[20:21]
v_pk_mul_f32 v[22:23], v[22:23], v[234:235]
v_lshlrev_b32 v248, 16, v75
v_and_b32 v249, 0xffff0000, v75
v_pk_fma_f32 v[22:23], v[248:249], v[236:237], v[22:23]
v_cvt_pk_bf16_f32 v72, v16, v17
v_cvt_pk_bf16_f32 v73, v18, v19
v_cvt_pk_bf16_f32 v74, v20, v21
v_cvt_pk_bf16_f32 v75, v22, v23
ds_write_b128 v251, v[72:75] offset:2048
s_waitcnt vmcnt(15)
v_pk_mul_f32 v[24:25], v[24:25], v[234:235]
v_lshlrev_b32 v246, 16, v76
v_and_b32 v247, 0xffff0000, v76
v_pk_fma_f32 v[24:25], v[246:247], v[236:237], v[24:25]
v_pk_mul_f32 v[26:27], v[26:27], v[234:235]
v_lshlrev_b32 v248, 16, v77
v_and_b32 v249, 0xffff0000, v77
v_pk_fma_f32 v[26:27], v[248:249], v[236:237], v[26:27]
v_pk_mul_f32 v[28:29], v[28:29], v[234:235]
v_lshlrev_b32 v246, 16, v78
v_and_b32 v247, 0xffff0000, v78
v_pk_fma_f32 v[28:29], v[246:247], v[236:237], v[28:29]
v_pk_mul_f32 v[30:31], v[30:31], v[234:235]
v_lshlrev_b32 v248, 16, v79
v_and_b32 v249, 0xffff0000, v79
v_pk_fma_f32 v[30:31], v[248:249], v[236:237], v[30:31]
v_cvt_pk_bf16_f32 v76, v24, v25
v_cvt_pk_bf16_f32 v77, v26, v27
v_cvt_pk_bf16_f32 v78, v28, v29
v_cvt_pk_bf16_f32 v79, v30, v31
ds_write_b128 v251, v[76:79] offset:3072
s_waitcnt vmcnt(14)
v_pk_mul_f32 v[32:33], v[32:33], v[234:235]
v_lshlrev_b32 v246, 16, v80
v_and_b32 v247, 0xffff0000, v80
v_pk_fma_f32 v[32:33], v[246:247], v[236:237], v[32:33]
v_pk_mul_f32 v[34:35], v[34:35], v[234:235]
v_lshlrev_b32 v248, 16, v81
v_and_b32 v249, 0xffff0000, v81
v_pk_fma_f32 v[34:35], v[248:249], v[236:237], v[34:35]
v_pk_mul_f32 v[36:37], v[36:37], v[234:235]
v_lshlrev_b32 v246, 16, v82
v_and_b32 v247, 0xffff0000, v82
v_pk_fma_f32 v[36:37], v[246:247], v[236:237], v[36:37]
v_pk_mul_f32 v[38:39], v[38:39], v[234:235]
v_lshlrev_b32 v248, 16, v83
v_and_b32 v249, 0xffff0000, v83
v_pk_fma_f32 v[38:39], v[248:249], v[236:237], v[38:39]
v_cvt_pk_bf16_f32 v80, v32, v33
v_cvt_pk_bf16_f32 v81, v34, v35
v_cvt_pk_bf16_f32 v82, v36, v37
v_cvt_pk_bf16_f32 v83, v38, v39
ds_write_b128 v251, v[80:83] offset:4096
s_waitcnt vmcnt(13)
v_pk_mul_f32 v[40:41], v[40:41], v[234:235]
v_lshlrev_b32 v246, 16, v84
v_and_b32 v247, 0xffff0000, v84
v_pk_fma_f32 v[40:41], v[246:247], v[236:237], v[40:41]
v_pk_mul_f32 v[42:43], v[42:43], v[234:235]
v_lshlrev_b32 v248, 16, v85
v_and_b32 v249, 0xffff0000, v85
v_pk_fma_f32 v[42:43], v[248:249], v[236:237], v[42:43]
v_pk_mul_f32 v[44:45], v[44:45], v[234:235]
v_lshlrev_b32 v246, 16, v86
v_and_b32 v247, 0xffff0000, v86
v_pk_fma_f32 v[44:45], v[246:247], v[236:237], v[44:45]
v_pk_mul_f32 v[46:47], v[46:47], v[234:235]
v_lshlrev_b32 v248, 16, v87
v_and_b32 v249, 0xffff0000, v87
v_pk_fma_f32 v[46:47], v[248:249], v[236:237], v[46:47]
v_cvt_pk_bf16_f32 v84, v40, v41
v_cvt_pk_bf16_f32 v85, v42, v43
v_cvt_pk_bf16_f32 v86, v44, v45
v_cvt_pk_bf16_f32 v87, v46, v47
ds_write_b128 v251, v[84:87] offset:5120
s_waitcnt vmcnt(12)
v_pk_mul_f32 v[48:49], v[48:49], v[234:235]
v_lshlrev_b32 v246, 16, v88
v_and_b32 v247, 0xffff0000, v88
v_pk_fma_f32 v[48:49], v[246:247], v[236:237], v[48:49]
v_pk_mul_f32 v[50:51], v[50:51], v[234:235]
v_lshlrev_b32 v248, 16, v89
v_and_b32 v249, 0xffff0000, v89
v_pk_fma_f32 v[50:51], v[248:249], v[236:237], v[50:51]
v_pk_mul_f32 v[52:53], v[52:53], v[234:235]
v_lshlrev_b32 v246, 16, v90
v_and_b32 v247, 0xffff0000, v90
v_pk_fma_f32 v[52:53], v[246:247], v[236:237], v[52:53]
v_pk_mul_f32 v[54:55], v[54:55], v[234:235]
v_lshlrev_b32 v248, 16, v91
v_and_b32 v249, 0xffff0000, v91
v_pk_fma_f32 v[54:55], v[248:249], v[236:237], v[54:55]
v_cvt_pk_bf16_f32 v88, v48, v49
v_cvt_pk_bf16_f32 v89, v50, v51
v_cvt_pk_bf16_f32 v90, v52, v53
v_cvt_pk_bf16_f32 v91, v54, v55
ds_write_b128 v251, v[88:91] offset:6144
s_waitcnt vmcnt(11)
v_pk_mul_f32 v[56:57], v[56:57], v[234:235]
v_lshlrev_b32 v246, 16, v92
v_and_b32 v247, 0xffff0000, v92
v_pk_fma_f32 v[56:57], v[246:247], v[236:237], v[56:57]
v_pk_mul_f32 v[58:59], v[58:59], v[234:235]
v_lshlrev_b32 v248, 16, v93
v_and_b32 v249, 0xffff0000, v93
v_pk_fma_f32 v[58:59], v[248:249], v[236:237], v[58:59]
v_pk_mul_f32 v[60:61], v[60:61], v[234:235]
v_lshlrev_b32 v246, 16, v94
v_and_b32 v247, 0xffff0000, v94
v_pk_fma_f32 v[60:61], v[246:247], v[236:237], v[60:61]
v_pk_mul_f32 v[62:63], v[62:63], v[234:235]
v_lshlrev_b32 v248, 16, v95
v_and_b32 v249, 0xffff0000, v95
v_pk_fma_f32 v[62:63], v[248:249], v[236:237], v[62:63]
v_cvt_pk_bf16_f32 v92, v56, v57
v_cvt_pk_bf16_f32 v93, v58, v59
v_cvt_pk_bf16_f32 v94, v60, v61
v_cvt_pk_bf16_f32 v95, v62, v63
ds_write_b128 v251, v[92:95] offset:7168
s_waitcnt vmcnt(8)
v_max_f32 v246, v226, v120
v_sub_f32 v234, v120, v246
v_sub_f32 v236, v226, v246
v_exp_f32 v234, v234
v_exp_f32 v236, v236
v_mul_f32 v246, v121, v234
v_fma_f32 v246, v227, v236, v246
v_rcp_f32 v246, v246
s_nop 0
v_mul_f32 v234, v234, v246
v_mul_f32 v236, v236, v246
v_mov_b32 v235, v234
v_mov_b32 v237, v236
v_pk_mul_f32 v[96:97], v[96:97], v[234:235]
v_lshlrev_b32 v246, 16, v112
v_and_b32 v247, 0xffff0000, v112
v_pk_fma_f32 v[96:97], v[246:247], v[236:237], v[96:97]
v_pk_mul_f32 v[98:99], v[98:99], v[234:235]
v_lshlrev_b32 v248, 16, v113
v_and_b32 v249, 0xffff0000, v113
v_pk_fma_f32 v[98:99], v[248:249], v[236:237], v[98:99]
v_pk_mul_f32 v[100:101], v[100:101], v[234:235]
v_lshlrev_b32 v246, 16, v114
v_and_b32 v247, 0xffff0000, v114
v_pk_fma_f32 v[100:101], v[246:247], v[236:237], v[100:101]
v_pk_mul_f32 v[102:103], v[102:103], v[234:235]
v_lshlrev_b32 v248, 16, v115
v_and_b32 v249, 0xffff0000, v115
v_pk_fma_f32 v[102:103], v[248:249], v[236:237], v[102:103]
v_cvt_pk_bf16_f32 v112, v96, v97
v_cvt_pk_bf16_f32 v113, v98, v99
v_cvt_pk_bf16_f32 v114, v100, v101
v_cvt_pk_bf16_f32 v115, v102, v103
ds_write_b128 v252, v[112:115] offset:0
v_pk_mul_f32 v[104:105], v[104:105], v[234:235]
v_lshlrev_b32 v246, 16, v116
v_and_b32 v247, 0xffff0000, v116
v_pk_fma_f32 v[104:105], v[246:247], v[236:237], v[104:105]
v_pk_mul_f32 v[106:107], v[106:107], v[234:235]
v_lshlrev_b32 v248, 16, v117
v_and_b32 v249, 0xffff0000, v117
v_pk_fma_f32 v[106:107], v[248:249], v[236:237], v[106:107]
v_pk_mul_f32 v[108:109], v[108:109], v[234:235]
v_lshlrev_b32 v246, 16, v118
v_and_b32 v247, 0xffff0000, v118
v_pk_fma_f32 v[108:109], v[246:247], v[236:237], v[108:109]
v_pk_mul_f32 v[110:111], v[110:111], v[234:235]
v_lshlrev_b32 v248, 16, v119
v_and_b32 v249, 0xffff0000, v119
v_pk_fma_f32 v[110:111], v[248:249], v[236:237], v[110:111]
v_cvt_pk_bf16_f32 v116, v104, v105
v_cvt_pk_bf16_f32 v117, v106, v107
v_cvt_pk_bf16_f32 v118, v108, v109
v_cvt_pk_bf16_f32 v119, v110, v111
ds_write_b128 v252, v[116:119] offset:1024
s_waitcnt vmcnt(0) lgkmcnt(0)
s_barrier
ds_read_b128 a[0:3], v240 offset:0
ds_read_b128 a[32:35], v240 offset:8192
ds_read_b128 a[64:67], v240 offset:16384
ds_read_b128 a[96:99], v240 offset:24576
ds_read_b128 a[128:131], v240 offset:32768
ds_read_b128 a[4:7], v240 offset:1024
ds_read_b128 a[36:39], v240 offset:9216
ds_read_b128 a[68:71], v240 offset:17408
ds_read_b128 a[100:103], v240 offset:25600
ds_read_b128 a[132:135], v240 offset:33792
s_waitcnt lgkmcnt(5)
v_mfma_f32_16x16x32_bf16 v[0:3], a[160:163], a[0:3], 0
ds_read_b128 a[8:11], v240 offset:2048
v_mfma_f32_16x16x32_bf16 v[4:7], a[160:163], a[32:35], 0
ds_read_b128 a[40:43], v240 offset:10240
v_mfma_f32_16x16x32_bf16 v[8:11], a[160:163], a[64:67], 0
ds_read_b128 a[72:75], v240 offset:18432
v_mfma_f32_16x16x32_bf16 v[12:15], a[160:163], a[96:99], 0
ds_read_b128 a[104:107], v240 offset:26624
v_mfma_f32_16x16x32_bf16 v[16:19], a[160:163], a[128:131], 0
ds_read_b128 a[136:139], v240 offset:34816
s_waitcnt lgkmcnt(5)
v_mfma_f32_16x16x32_bf16 v[0:3], a[164:167], a[4:7], v[0:3]
ds_read_b128 a[12:15], v240 offset:3072
v_mfma_f32_16x16x32_bf16 v[4:7], a[164:167], a[36:39], v[4:7]
ds_read_b128 a[44:47], v240 offset:11264
v_mfma_f32_16x16x32_bf16 v[8:11], a[164:167], a[68:71], v[8:11]
ds_read_b128 a[76:79], v240 offset:19456
v_mfma_f32_16x16x32_bf16 v[12:15], a[164:167], a[100:103], v[12:15]
ds_read_b128 a[108:111], v240 offset:27648
v_mfma_f32_16x16x32_bf16 v[16:19], a[164:167], a[132:135], v[16:19]
ds_read_b128 a[140:143], v240 offset:35840
s_waitcnt lgkmcnt(5)
v_mfma_f32_16x16x32_bf16 v[0:3], a[168:171], a[8:11], v[0:3]
ds_read_b128 a[16:19], v240 offset:4096
v_mfma_f32_16x16x32_bf16 v[4:7], a[168:171], a[40:43], v[4:7]
ds_read_b128 a[48:51], v240 offset:12288
v_mfma_f32_16x16x32_bf16 v[8:11], a[168:171], a[72:75], v[8:11]
ds_read_b128 a[80:83], v240 offset:20480
v_mfma_f32_16x16x32_bf16 v[12:15], a[168:171], a[104:107], v[12:15]
ds_read_b128 a[112:115], v240 offset:28672
v_mfma_f32_16x16x32_bf16 v[16:19], a[168:171], a[136:139], v[16:19]
ds_read_b128 a[144:147], v240 offset:36864
s_waitcnt lgkmcnt(5)
v_mfma_f32_16x16x32_bf16 v[0:3], a[172:175], a[12:15], v[0:3]
ds_read_b128 a[20:23], v240 offset:5120
v_mfma_f32_16x16x32_bf16 v[4:7], a[172:175], a[44:47], v[4:7]
ds_read_b128 a[52:55], v240 offset:13312
v_mfma_f32_16x16x32_bf16 v[8:11], a[172:175], a[76:79], v[8:11]
ds_read_b128 a[84:87], v240 offset:21504
v_mfma_f32_16x16x32_bf16 v[12:15], a[172:175], a[108:111], v[12:15]
ds_read_b128 a[116:119], v240 offset:29696
v_mfma_f32_16x16x32_bf16 v[16:19], a[172:175], a[140:143], v[16:19]
ds_read_b128 a[148:151], v240 offset:37888
s_waitcnt lgkmcnt(5)
v_mfma_f32_16x16x32_bf16 v[0:3], a[176:179], a[16:19], v[0:3]
ds_read_b128 a[24:27], v240 offset:6144
v_mfma_f32_16x16x32_bf16 v[4:7], a[176:179], a[48:51], v[4:7]
ds_read_b128 a[56:59], v240 offset:14336
v_mfma_f32_16x16x32_bf16 v[8:11], a[176:179], a[80:83], v[8:11]
ds_read_b128 a[88:91], v240 offset:22528
v_mfma_f32_16x16x32_bf16 v[12:15], a[176:179], a[112:115], v[12:15]
ds_read_b128 a[120:123], v240 offset:30720
v_mfma_f32_16x16x32_bf16 v[16:19], a[176:179], a[144:147], v[16:19]
ds_read_b128 a[152:155], v240 offset:38912
s_waitcnt lgkmcnt(5)
v_mfma_f32_16x16x32_bf16 v[0:3], a[180:183], a[20:23], v[0:3]
ds_read_b128 a[28:31], v240 offset:7168
v_mfma_f32_16x16x32_bf16 v[4:7], a[180:183], a[52:55], v[4:7]
ds_read_b128 a[60:63], v240 offset:15360
v_mfma_f32_16x16x32_bf16 v[8:11], a[180:183], a[84:87], v[8:11]
ds_read_b128 a[92:95], v240 offset:23552
v_mfma_f32_16x16x32_bf16 v[12:15], a[180:183], a[116:119], v[12:15]
ds_read_b128 a[124:127], v240 offset:31744
v_mfma_f32_16x16x32_bf16 v[16:19], a[180:183], a[148:151], v[16:19]
ds_read_b128 a[156:159], v240 offset:39936
s_waitcnt lgkmcnt(5)
v_mfma_f32_16x16x32_bf16 v[0:3], a[184:187], a[24:27], v[0:3]
v_mfma_f32_16x16x32_bf16 v[4:7], a[184:187], a[56:59], v[4:7]
v_mfma_f32_16x16x32_bf16 v[8:11], a[184:187], a[88:91], v[8:11]
v_mfma_f32_16x16x32_bf16 v[12:15], a[184:187], a[120:123], v[12:15]
v_mfma_f32_16x16x32_bf16 v[16:19], a[184:187], a[152:155], v[16:19]
s_waitcnt lgkmcnt(0)
v_mfma_f32_16x16x32_bf16 v[0:3], a[188:191], a[28:31], v[0:3]
v_mfma_f32_16x16x32_bf16 v[4:7], a[188:191], a[60:63], v[4:7]
v_mfma_f32_16x16x32_bf16 v[8:11], a[188:191], a[92:95], v[8:11]
v_mfma_f32_16x16x32_bf16 v[12:15], a[188:191], a[124:127], v[12:15]
v_mfma_f32_16x16x32_bf16 v[16:19], a[188:191], a[156:159], v[16:19]
v_mfma_f32_16x16x32_bf16 v[20:23], a[192:195], a[0:3], 0
v_mfma_f32_16x16x32_bf16 v[24:27], a[192:195], a[32:35], 0
v_mfma_f32_16x16x32_bf16 v[28:31], a[192:195], a[64:67], 0
v_mfma_f32_16x16x32_bf16 v[32:35], a[192:195], a[96:99], 0
v_mfma_f32_16x16x32_bf16 v[36:39], a[192:195], a[128:131], 0
v_mfma_f32_16x16x32_bf16 v[20:23], a[196:199], a[4:7], v[20:23]
v_mfma_f32_16x16x32_bf16 v[24:27], a[196:199], a[36:39], v[24:27]
v_mfma_f32_16x16x32_bf16 v[28:31], a[196:199], a[68:71], v[28:31]
v_mfma_f32_16x16x32_bf16 v[32:35], a[196:199], a[100:103], v[32:35]
v_cvt_pk_bf16_f32 v40, v0, v1
v_cvt_pk_bf16_f32 v41, v2, v3
v_mfma_f32_16x16x32_bf16 v[36:39], a[196:199], a[132:135], v[36:39]
v_cvt_pk_bf16_f32 v42, v4, v5
v_cvt_pk_bf16_f32 v43, v6, v7
v_mfma_f32_16x16x32_bf16 v[20:23], a[200:203], a[8:11], v[20:23]
s_add_u32 s41, s85, 0
buffer_store_dwordx4 v[40:43], v242, s[24:27], s41 offen sc1
v_mfma_f32_16x16x32_bf16 v[24:27], a[200:203], a[40:43], v[24:27]
v_cvt_pk_bf16_f32 v44, v8, v9
v_cvt_pk_bf16_f32 v45, v10, v11
v_mfma_f32_16x16x32_bf16 v[28:31], a[200:203], a[72:75], v[28:31]
v_cvt_pk_bf16_f32 v46, v12, v13
v_cvt_pk_bf16_f32 v47, v14, v15
v_mfma_f32_16x16x32_bf16 v[32:35], a[200:203], a[104:107], v[32:35]
s_add_u32 s41, s85, 1024
buffer_store_dwordx4 v[44:47], v242, s[24:27], s41 offen sc1
v_mfma_f32_16x16x32_bf16 v[36:39], a[200:203], a[136:139], v[36:39]
v_cvt_pk_bf16_f32 v56, v16, v17
v_cvt_pk_bf16_f32 v57, v18, v19
v_mfma_f32_16x16x32_bf16 v[20:23], a[204:207], a[12:15], v[20:23]
v_mfma_f32_16x16x32_bf16 v[24:27], a[204:207], a[44:47], v[24:27]
v_mfma_f32_16x16x32_bf16 v[28:31], a[204:207], a[76:79], v[28:31]
s_add_u32 s89, s42, s100
s_add_u32 s100, s100, 128
s_cmp_ge_u32 s100, 896
s_cselect_b32 s100, 0, s100
s_add_u32 m0, s46, 67584
s_add_u32 s40, s89, 0
buffer_load_dwordx4 v244, s[16:19], s40 offen lds
v_mfma_f32_16x16x32_bf16 v[32:35], a[204:207], a[108:111], v[32:35]
v_mfma_f32_16x16x32_bf16 v[36:39], a[204:207], a[140:143], v[36:39]
v_mfma_f32_16x16x32_bf16 v[20:23], a[208:211], a[16:19], v[20:23]
s_add_u32 m0, s46, 68640
s_add_u32 s40, s89, 896
buffer_load_dwordx4 v244, s[16:19], s40 offen lds
v_mfma_f32_16x16x32_bf16 v[24:27], a[208:211], a[48:51], v[24:27]
v_mfma_f32_16x16x32_bf16 v[28:31], a[208:211], a[80:83], v[28:31]
v_mfma_f32_16x16x32_bf16 v[32:35], a[208:211], a[112:115], v[32:35]
s_add_u32 m0, s46, 69696
s_add_u32 s40, s89, 1792
buffer_load_dwordx4 v244, s[16:19], s40 offen lds
v_mfma_f32_16x16x32_bf16 v[36:39], a[208:211], a[144:147], v[36:39]
v_mfma_f32_16x16x32_bf16 v[20:23], a[212:215], a[20:23], v[20:23]
v_mfma_f32_16x16x32_bf16 v[24:27], a[212:215], a[52:55], v[24:27]
s_add_u32 m0, s46, 70752
s_add_u32 s40, s89, 2688
buffer_load_dwordx4 v244, s[16:19], s40 offen lds
v_mfma_f32_16x16x32_bf16 v[28:31], a[212:215], a[84:87], v[28:31]
v_mfma_f32_16x16x32_bf16 v[32:35], a[212:215], a[116:119], v[32:35]
v_mfma_f32_16x16x32_bf16 v[36:39], a[212:215], a[148:151], v[36:39]
s_add_u32 m0, s46, 71808
s_add_u32 s40, s89, 3584
buffer_load_dwordx4 v244, s[16:19], s40 offen lds
v_mfma_f32_16x16x32_bf16 v[20:23], a[216:219], a[24:27], v[20:23]
v_mfma_f32_16x16x32_bf16 v[24:27], a[216:219], a[56:59], v[24:27]
v_mfma_f32_16x16x32_bf16 v[28:31], a[216:219], a[88:91], v[28:31]
s_add_u32 m0, s46, 72864
s_add_u32 s40, s89, 4480
buffer_load_dwordx4 v244, s[16:19], s40 offen lds
v_mfma_f32_16x16x32_bf16 v[32:35], a[216:219], a[120:123], v[32:35]
v_mfma_f32_16x16x32_bf16 v[36:39], a[216:219], a[152:155], v[36:39]
v_mfma_f32_16x16x32_bf16 v[20:23], a[220:223], a[28:31], v[20:23]
s_add_u32 m0, s46, 73920
s_add_u32 s40, s89, 5376
buffer_load_dwordx4 v244, s[16:19], s40 offen lds
v_mfma_f32_16x16x32_bf16 v[24:27], a[220:223], a[60:63], v[24:27]
v_mfma_f32_16x16x32_bf16 v[28:31], a[220:223], a[92:95], v[28:31]
v_mfma_f32_16x16x32_bf16 v[32:35], a[220:223], a[124:127], v[32:35]
s_add_u32 m0, s46, 74976
s_add_u32 s40, s89, 6272
buffer_load_dwordx4 v244, s[16:19], s40 offen lds
v_mfma_f32_16x16x32_bf16 v[36:39], a[220:223], a[156:159], v[36:39]
v_mfma_f32_16x16x32_bf16 v[0:3], a[224:227], a[0:3], 0
v_mfma_f32_16x16x32_bf16 v[4:7], a[224:227], a[32:35], 0
v_mfma_f32_16x16x32_bf16 v[8:11], a[224:227], a[64:67], 0
v_mfma_f32_16x16x32_bf16 v[12:15], a[224:227], a[96:99], 0
v_mfma_f32_16x16x32_bf16 v[16:19], a[224:227], a[128:131], 0
v_mfma_f32_16x16x32_bf16 v[0:3], a[228:231], a[4:7], v[0:3]
v_mfma_f32_16x16x32_bf16 v[4:7], a[228:231], a[36:39], v[4:7]
v_mfma_f32_16x16x32_bf16 v[8:11], a[228:231], a[68:71], v[8:11]
v_mfma_f32_16x16x32_bf16 v[12:15], a[228:231], a[100:103], v[12:15]
v_cvt_pk_bf16_f32 v48, v20, v21
v_cvt_pk_bf16_f32 v49, v22, v23
v_mfma_f32_16x16x32_bf16 v[16:19], a[228:231], a[132:135], v[16:19]
v_cvt_pk_bf16_f32 v50, v24, v25
v_cvt_pk_bf16_f32 v51, v26, v27
v_mfma_f32_16x16x32_bf16 v[0:3], a[232:235], a[8:11], v[0:3]
s_add_u32 s41, s85, 2048
buffer_store_dwordx4 v[48:51], v242, s[24:27], s41 offen sc1
v_mfma_f32_16x16x32_bf16 v[4:7], a[232:235], a[40:43], v[4:7]
v_cvt_pk_bf16_f32 v52, v28, v29
v_cvt_pk_bf16_f32 v53, v30, v31
v_mfma_f32_16x16x32_bf16 v[8:11], a[232:235], a[72:75], v[8:11]
v_cvt_pk_bf16_f32 v54, v32, v33
v_cvt_pk_bf16_f32 v55, v34, v35
v_mfma_f32_16x16x32_bf16 v[12:15], a[232:235], a[104:107], v[12:15]
s_add_u32 s41, s85, 3072
buffer_store_dwordx4 v[52:55], v242, s[24:27], s41 offen sc1
v_mfma_f32_16x16x32_bf16 v[16:19], a[232:235], a[136:139], v[16:19]
v_cvt_pk_bf16_f32 v58, v36, v37
v_cvt_pk_bf16_f32 v59, v38, v39
v_mfma_f32_16x16x32_bf16 v[0:3], a[236:239], a[12:15], v[0:3]
buffer_store_dwordx4 v[56:59], v242, s[24:27], s87 offen offset:0 sc1
v_mfma_f32_16x16x32_bf16 v[4:7], a[236:239], a[44:47], v[4:7]
v_mfma_f32_16x16x32_bf16 v[8:11], a[236:239], a[76:79], v[8:11]
v_mfma_f32_16x16x32_bf16 v[12:15], a[236:239], a[108:111], v[12:15]
v_mfma_f32_16x16x32_bf16 v[16:19], a[236:239], a[140:143], v[16:19]
v_mfma_f32_16x16x32_bf16 v[0:3], a[240:243], a[16:19], v[0:3]
v_mfma_f32_16x16x32_bf16 v[4:7], a[240:243], a[48:51], v[4:7]
v_mfma_f32_16x16x32_bf16 v[8:11], a[240:243], a[80:83], v[8:11]
v_mfma_f32_16x16x32_bf16 v[12:15], a[240:243], a[112:115], v[12:15]
v_mfma_f32_16x16x32_bf16 v[16:19], a[240:243], a[144:147], v[16:19]
v_mfma_f32_16x16x32_bf16 v[0:3], a[244:247], a[20:23], v[0:3]
v_mfma_f32_16x16x32_bf16 v[4:7], a[244:247], a[52:55], v[4:7]
v_mfma_f32_16x16x32_bf16 v[8:11], a[244:247], a[84:87], v[8:11]
v_mfma_f32_16x16x32_bf16 v[12:15], a[244:247], a[116:119], v[12:15]
v_mfma_f32_16x16x32_bf16 v[16:19], a[244:247], a[148:151], v[16:19]
v_mfma_f32_16x16x32_bf16 v[0:3], a[248:251], a[24:27], v[0:3]
v_mfma_f32_16x16x32_bf16 v[4:7], a[248:251], a[56:59], v[4:7]
v_mfma_f32_16x16x32_bf16 v[8:11], a[248:251], a[88:91], v[8:11]
v_mfma_f32_16x16x32_bf16 v[12:15], a[248:251], a[120:123], v[12:15]
v_mfma_f32_16x16x32_bf16 v[16:19], a[248:251], a[152:155], v[16:19]
v_mfma_f32_16x16x32_bf16 v[0:3], a[252:255], a[28:31], v[0:3]
v_mfma_f32_16x16x32_bf16 v[4:7], a[252:255], a[60:63], v[4:7]
v_mfma_f32_16x16x32_bf16 v[8:11], a[252:255], a[92:95], v[8:11]
v_mfma_f32_16x16x32_bf16 v[12:15], a[252:255], a[124:127], v[12:15]
v_mfma_f32_16x16x32_bf16 v[16:19], a[252:255], a[156:159], v[16:19]
v_mfma_f32_16x16x32_bf16 v[20:23], v[192:195], a[0:3], 0
ds_read_b64_tr_b16 a[160:161], v254 offset:0
v_mfma_f32_16x16x32_bf16 v[24:27], v[192:195], a[32:35], 0
ds_read_b64_tr_b16 a[162:163], v254 offset:16896
v_mfma_f32_16x16x32_bf16 v[28:31], v[192:195], a[64:67], 0
ds_read_b64_tr_b16 a[164:165], v254 offset:128
v_mfma_f32_16x16x32_bf16 v[32:35], v[192:195], a[96:99], 0
ds_read_b64_tr_b16 a[166:167], v254 offset:17024
v_mfma_f32_16x16x32_bf16 v[36:39], v[192:195], a[128:131], 0
ds_read_b64_tr_b16 a[168:169], v254 offset:256
v_mfma_f32_16x16x32_bf16 v[20:23], v[196:199], a[4:7], v[20:23]
ds_read_b64_tr_b16 a[170:171], v254 offset:17152
v_mfma_f32_16x16x32_bf16 v[24:27], v[196:199], a[36:39], v[24:27]
ds_read_b64_tr_b16 a[172:173], v254 offset:384
v_mfma_f32_16x16x32_bf16 v[28:31], v[196:199], a[68:71], v[28:31]
ds_read_b64_tr_b16 a[174:175], v254 offset:17280
v_mfma_f32_16x16x32_bf16 v[32:35], v[196:199], a[100:103], v[32:35]
v_cvt_pk_bf16_f32 v40, v0, v1
v_cvt_pk_bf16_f32 v41, v2, v3
v_mfma_f32_16x16x32_bf16 v[36:39], v[196:199], a[132:135], v[36:39]
v_cvt_pk_bf16_f32 v42, v4, v5
v_cvt_pk_bf16_f32 v43, v6, v7
v_mfma_f32_16x16x32_bf16 v[20:23], v[200:203], a[8:11], v[20:23]
s_add_u32 s41, s85, 4096
buffer_store_dwordx4 v[40:43], v242, s[24:27], s41 offen sc1
v_mfma_f32_16x16x32_bf16 v[24:27], v[200:203], a[40:43], v[24:27]
v_cvt_pk_bf16_f32 v44, v8, v9
v_cvt_pk_bf16_f32 v45, v10, v11
v_mfma_f32_16x16x32_bf16 v[28:31], v[200:203], a[72:75], v[28:31]
v_cvt_pk_bf16_f32 v46, v12, v13
v_cvt_pk_bf16_f32 v47, v14, v15
v_mfma_f32_16x16x32_bf16 v[32:35], v[200:203], a[104:107], v[32:35]
s_add_u32 s41, s85, 5120
buffer_store_dwordx4 v[44:47], v242, s[24:27], s41 offen sc1
v_mfma_f32_16x16x32_bf16 v[36:39], v[200:203], a[136:139], v[36:39]
v_cvt_pk_bf16_f32 v56, v16, v17
v_cvt_pk_bf16_f32 v57, v18, v19
v_mfma_f32_16x16x32_bf16 v[20:23], v[204:207], a[12:15], v[20:23]
ds_read_b64_tr_b16 a[176:177], v254 offset:512
v_mfma_f32_16x16x32_bf16 v[24:27], v[204:207], a[44:47], v[24:27]
ds_read_b64_tr_b16 a[178:179], v254 offset:17408
v_mfma_f32_16x16x32_bf16 v[28:31], v[204:207], a[76:79], v[28:31]
ds_read_b64_tr_b16 a[180:181], v254 offset:640
v_mfma_f32_16x16x32_bf16 v[32:35], v[204:207], a[108:111], v[32:35]
ds_read_b64_tr_b16 a[182:183], v254 offset:17536
v_mfma_f32_16x16x32_bf16 v[36:39], v[204:207], a[140:143], v[36:39]
ds_read_b64_tr_b16 a[184:185], v254 offset:768
v_mfma_f32_16x16x32_bf16 v[20:23], v[208:211], a[16:19], v[20:23]
ds_read_b64_tr_b16 a[186:187], v254 offset:17664
v_mfma_f32_16x16x32_bf16 v[24:27], v[208:211], a[48:51], v[24:27]
ds_read_b64_tr_b16 a[188:189], v254 offset:896
v_mfma_f32_16x16x32_bf16 v[28:31], v[208:211], a[80:83], v[28:31]
ds_read_b64_tr_b16 a[190:191], v254 offset:17792
v_mfma_f32_16x16x32_bf16 v[32:35], v[208:211], a[112:115], v[32:35]
v_mfma_f32_16x16x32_bf16 v[36:39], v[208:211], a[144:147], v[36:39]
v_mfma_f32_16x16x32_bf16 v[20:23], v[212:215], a[20:23], v[20:23]
v_mfma_f32_16x16x32_bf16 v[24:27], v[212:215], a[52:55], v[24:27]
v_mfma_f32_16x16x32_bf16 v[28:31], v[212:215], a[84:87], v[28:31]
v_mfma_f32_16x16x32_bf16 v[32:35], v[212:215], a[116:119], v[32:35]
v_mfma_f32_16x16x32_bf16 v[36:39], v[212:215], a[148:151], v[36:39]
v_mfma_f32_16x16x32_bf16 v[20:23], v[216:219], a[24:27], v[20:23]
v_mfma_f32_16x16x32_bf16 v[24:27], v[216:219], a[56:59], v[24:27]
v_mfma_f32_16x16x32_bf16 v[28:31], v[216:219], a[88:91], v[28:31]
v_mfma_f32_16x16x32_bf16 v[32:35], v[216:219], a[120:123], v[32:35]
v_mfma_f32_16x16x32_bf16 v[36:39], v[216:219], a[152:155], v[36:39]
v_mfma_f32_16x16x32_bf16 v[20:23], v[220:223], a[28:31], v[20:23]
v_mfma_f32_16x16x32_bf16 v[24:27], v[220:223], a[60:63], v[24:27]
v_mfma_f32_16x16x32_bf16 v[28:31], v[220:223], a[92:95], v[28:31]
v_mfma_f32_16x16x32_bf16 v[32:35], v[220:223], a[124:127], v[32:35]
v_mfma_f32_16x16x32_bf16 v[36:39], v[220:223], a[156:159], v[36:39]
s_waitcnt lgkmcnt(0)
v_mfma_f32_16x16x32_bf16 v[0:3], a[160:163], a[0:3], 0
ds_read_b64_tr_b16 a[192:193], v254 offset:33792
v_mfma_f32_16x16x32_bf16 v[4:7], a[160:163], a[32:35], 0
ds_read_b64_tr_b16 a[194:195], v254 offset:50688
v_mfma_f32_16x16x32_bf16 v[8:11], a[160:163], a[64:67], 0
ds_read_b64_tr_b16 a[196:197], v254 offset:33920
v_mfma_f32_16x16x32_bf16 v[12:15], a[160:163], a[96:99], 0
ds_read_b64_tr_b16 a[198:199], v254 offset:50816
v_mfma_f32_16x16x32_bf16 v[16:19], a[160:163], a[128:131], 0
ds_read_b64_tr_b16 a[200:201], v254 offset:34048
v_mfma_f32_16x16x32_bf16 v[0:3], a[164:167], a[4:7], v[0:3]
ds_read_b64_tr_b16 a[202:203], v254 offset:50944
v_mfma_f32_16x16x32_bf16 v[4:7], a[164:167], a[36:39], v[4:7]
ds_read_b64_tr_b16 a[204:205], v254 offset:34176
v_mfma_f32_16x16x32_bf16 v[8:11], a[164:167], a[68:71], v[8:11]
ds_read_b64_tr_b16 a[206:207], v254 offset:51072
v_mfma_f32_16x16x32_bf16 v[12:15], a[164:167], a[100:103], v[12:15]
v_cvt_pk_bf16_f32 v48, v20, v21
v_cvt_pk_bf16_f32 v49, v22, v23
v_mfma_f32_16x16x32_bf16 v[16:19], a[164:167], a[132:135], v[16:19]
v_cvt_pk_bf16_f32 v50, v24, v25
v_cvt_pk_bf16_f32 v51, v26, v27
v_mfma_f32_16x16x32_bf16 v[0:3], a[168:171], a[8:11], v[0:3]
s_add_u32 s41, s85, 6144
buffer_store_dwordx4 v[48:51], v242, s[24:27], s41 offen sc1
v_mfma_f32_16x16x32_bf16 v[4:7], a[168:171], a[40:43], v[4:7]
v_cvt_pk_bf16_f32 v52, v28, v29
v_cvt_pk_bf16_f32 v53, v30, v31
v_mfma_f32_16x16x32_bf16 v[8:11], a[168:171], a[72:75], v[8:11]
v_cvt_pk_bf16_f32 v54, v32, v33
v_cvt_pk_bf16_f32 v55, v34, v35
v_mfma_f32_16x16x32_bf16 v[12:15], a[168:171], a[104:107], v[12:15]
s_add_u32 s41, s85, 7168
buffer_store_dwordx4 v[52:55], v242, s[24:27], s41 offen sc1
v_mfma_f32_16x16x32_bf16 v[16:19], a[168:171], a[136:139], v[16:19]
v_cvt_pk_bf16_f32 v58, v36, v37
v_cvt_pk_bf16_f32 v59, v38, v39
v_mfma_f32_16x16x32_bf16 v[0:3], a[172:175], a[12:15], v[0:3]
buffer_store_dwordx4 v[56:59], v242, s[24:27], s87 offen offset:1024 sc1
v_mfma_f32_16x16x32_bf16 v[4:7], a[172:175], a[44:47], v[4:7]
ds_read_b64_tr_b16 a[208:209], v254 offset:34304
v_mfma_f32_16x16x32_bf16 v[8:11], a[172:175], a[76:79], v[8:11]
ds_read_b64_tr_b16 a[210:211], v254 offset:51200
v_mfma_f32_16x16x32_bf16 v[12:15], a[172:175], a[108:111], v[12:15]
ds_read_b64_tr_b16 a[212:213], v254 offset:34432
v_mfma_f32_16x16x32_bf16 v[16:19], a[172:175], a[140:143], v[16:19]
ds_read_b64_tr_b16 a[214:215], v254 offset:51328
v_mfma_f32_16x16x32_bf16 v[0:3], a[176:179], a[16:19], v[0:3]
ds_read_b64_tr_b16 a[216:217], v254 offset:34560
v_mfma_f32_16x16x32_bf16 v[4:7], a[176:179], a[48:51], v[4:7]
ds_read_b64_tr_b16 a[218:219], v254 offset:51456
v_mfma_f32_16x16x32_bf16 v[8:11], a[176:179], a[80:83], v[8:11]
ds_read_b64_tr_b16 a[220:221], v254 offset:34688
v_mfma_f32_16x16x32_bf16 v[12:15], a[176:179], a[112:115], v[12:15]
ds_read_b64_tr_b16 a[222:223], v254 offset:51584
v_mfma_f32_16x16x32_bf16 v[16:19], a[176:179], a[144:147], v[16:19]
v_mfma_f32_16x16x32_bf16 v[0:3], a[180:183], a[20:23], v[0:3]
v_mfma_f32_16x16x32_bf16 v[4:7], a[180:183], a[52:55], v[4:7]
v_mfma_f32_16x16x32_bf16 v[8:11], a[180:183], a[84:87], v[8:11]
v_mfma_f32_16x16x32_bf16 v[12:15], a[180:183], a[116:119], v[12:15]
v_mfma_f32_16x16x32_bf16 v[16:19], a[180:183], a[148:151], v[16:19]
v_mfma_f32_16x16x32_bf16 v[0:3], a[184:187], a[24:27], v[0:3]
v_mfma_f32_16x16x32_bf16 v[4:7], a[184:187], a[56:59], v[4:7]
v_mfma_f32_16x16x32_bf16 v[8:11], a[184:187], a[88:91], v[8:11]
v_mfma_f32_16x16x32_bf16 v[12:15], a[184:187], a[120:123], v[12:15]
v_mfma_f32_16x16x32_bf16 v[16:19], a[184:187], a[152:155], v[16:19]
v_mfma_f32_16x16x32_bf16 v[0:3], a[188:191], a[28:31], v[0:3]
v_mfma_f32_16x16x32_bf16 v[4:7], a[188:191], a[60:63], v[4:7]
v_mfma_f32_16x16x32_bf16 v[8:11], a[188:191], a[92:95], v[8:11]
v_mfma_f32_16x16x32_bf16 v[12:15], a[188:191], a[124:127], v[12:15]
v_mfma_f32_16x16x32_bf16 v[16:19], a[188:191], a[156:159], v[16:19]
s_waitcnt lgkmcnt(0)
s_waitcnt vmcnt(8)
s_barrier
v_mfma_f32_16x16x32_bf16 v[20:23], a[192:195], a[0:3], 0
ds_read_b64_tr_b16 a[224:225], v253 offset:0
v_mfma_f32_16x16x32_bf16 v[24:27], a[192:195], a[32:35], 0
ds_read_b64_tr_b16 a[226:227], v253 offset:16896
v_mfma_f32_16x16x32_bf16 v[28:31], a[192:195], a[64:67], 0
ds_read_b64_tr_b16 a[228:229], v253 offset:128
v_mfma_f32_16x16x32_bf16 v[32:35], a[192:195], a[96:99], 0
ds_read_b64_tr_b16 a[230:231], v253 offset:17024
v_mfma_f32_16x16x32_bf16 v[36:39], a[192:195], a[128:131], 0
ds_read_b64_tr_b16 a[232:233], v253 offset:256
v_mfma_f32_16x16x32_bf16 v[20:23], a[196:199], a[4:7], v[20:23]
ds_read_b64_tr_b16 a[234:235], v253 offset:17152
v_mfma_f32_16x16x32_bf16 v[24:27], a[196:199], a[36:39], v[24:27]
ds_read_b64_tr_b16 a[236:237], v253 offset:384
v_mfma_f32_16x16x32_bf16 v[28:31], a[196:199], a[68:71], v[28:31]
ds_read_b64_tr_b16 a[238:239], v253 offset:17280
v_mfma_f32_16x16x32_bf16 v[32:35], a[196:199], a[100:103], v[32:35]
v_cvt_pk_bf16_f32 v40, v0, v1
v_cvt_pk_bf16_f32 v41, v2, v3
v_mfma_f32_16x16x32_bf16 v[36:39], a[196:199], a[132:135], v[36:39]
v_cvt_pk_bf16_f32 v42, v4, v5
v_cvt_pk_bf16_f32 v43, v6, v7
v_mfma_f32_16x16x32_bf16 v[20:23], a[200:203], a[8:11], v[20:23]
s_add_u32 s41, s85, 8192
buffer_store_dwordx4 v[40:43], v242, s[24:27], s41 offen sc1
v_mfma_f32_16x16x32_bf16 v[24:27], a[200:203], a[40:43], v[24:27]
v_cvt_pk_bf16_f32 v44, v8, v9
v_cvt_pk_bf16_f32 v45, v10, v11
v_mfma_f32_16x16x32_bf16 v[28:31], a[200:203], a[72:75], v[28:31]
v_cvt_pk_bf16_f32 v46, v12, v13
v_cvt_pk_bf16_f32 v47, v14, v15
v_mfma_f32_16x16x32_bf16 v[32:35], a[200:203], a[104:107], v[32:35]
s_add_u32 s41, s85, 9216
buffer_store_dwordx4 v[44:47], v242, s[24:27], s41 offen sc1
v_mfma_f32_16x16x32_bf16 v[36:39], a[200:203], a[136:139], v[36:39]
v_cvt_pk_bf16_f32 v56, v16, v17
v_cvt_pk_bf16_f32 v57, v18, v19
v_mfma_f32_16x16x32_bf16 v[20:23], a[204:207], a[12:15], v[20:23]
ds_read_b64_tr_b16 a[240:241], v253 offset:512
v_mfma_f32_16x16x32_bf16 v[24:27], a[204:207], a[44:47], v[24:27]
ds_read_b64_tr_b16 a[242:243], v253 offset:17408
v_mfma_f32_16x16x32_bf16 v[28:31], a[204:207], a[76:79], v[28:31]
ds_read_b64_tr_b16 a[244:245], v253 offset:640
v_mfma_f32_16x16x32_bf16 v[32:35], a[204:207], a[108:111], v[32:35]
ds_read_b64_tr_b16 a[246:247], v253 offset:17536
v_mfma_f32_16x16x32_bf16 v[36:39], a[204:207], a[140:143], v[36:39]
ds_read_b64_tr_b16 a[248:249], v253 offset:768
v_mfma_f32_16x16x32_bf16 v[20:23], a[208:211], a[16:19], v[20:23]
ds_read_b64_tr_b16 a[250:251], v253 offset:17664
v_mfma_f32_16x16x32_bf16 v[24:27], a[208:211], a[48:51], v[24:27]
ds_read_b64_tr_b16 a[252:253], v253 offset:896
v_mfma_f32_16x16x32_bf16 v[28:31], a[208:211], a[80:83], v[28:31]
ds_read_b64_tr_b16 a[254:255], v253 offset:17792
v_mfma_f32_16x16x32_bf16 v[32:35], a[208:211], a[112:115], v[32:35]
v_mfma_f32_16x16x32_bf16 v[36:39], a[208:211], a[144:147], v[36:39]
v_mfma_f32_16x16x32_bf16 v[20:23], a[212:215], a[20:23], v[20:23]
v_mfma_f32_16x16x32_bf16 v[24:27], a[212:215], a[52:55], v[24:27]
v_mfma_f32_16x16x32_bf16 v[28:31], a[212:215], a[84:87], v[28:31]
v_mfma_f32_16x16x32_bf16 v[32:35], a[212:215], a[116:119], v[32:35]
v_mfma_f32_16x16x32_bf16 v[36:39], a[212:215], a[148:151], v[36:39]
v_mfma_f32_16x16x32_bf16 v[20:23], a[216:219], a[24:27], v[20:23]
v_mfma_f32_16x16x32_bf16 v[24:27], a[216:219], a[56:59], v[24:27]
v_mfma_f32_16x16x32_bf16 v[28:31], a[216:219], a[88:91], v[28:31]
v_mfma_f32_16x16x32_bf16 v[32:35], a[216:219], a[120:123], v[32:35]
v_mfma_f32_16x16x32_bf16 v[36:39], a[216:219], a[152:155], v[36:39]
v_mfma_f32_16x16x32_bf16 v[20:23], a[220:223], a[28:31], v[20:23]
v_mfma_f32_16x16x32_bf16 v[24:27], a[220:223], a[60:63], v[24:27]
v_mfma_f32_16x16x32_bf16 v[28:31], a[220:223], a[92:95], v[28:31]
v_mfma_f32_16x16x32_bf16 v[32:35], a[220:223], a[124:127], v[32:35]
v_mfma_f32_16x16x32_bf16 v[36:39], a[220:223], a[156:159], v[36:39]
s_waitcnt lgkmcnt(0)
v_mfma_f32_16x16x32_bf16 v[0:3], a[224:227], a[0:3], 0
v_mfma_f32_16x16x32_bf16 v[4:7], a[224:227], a[32:35], 0
v_mfma_f32_16x16x32_bf16 v[8:11], a[224:227], a[64:67], 0
v_mfma_f32_16x16x32_bf16 v[12:15], a[224:227], a[96:99], 0
v_mfma_f32_16x16x32_bf16 v[16:19], a[224:227], a[128:131], 0
v_mfma_f32_16x16x32_bf16 v[0:3], a[228:231], a[4:7], v[0:3]
v_mfma_f32_16x16x32_bf16 v[4:7], a[228:231], a[36:39], v[4:7]
v_mfma_f32_16x16x32_bf16 v[8:11], a[228:231], a[68:71], v[8:11]
v_mfma_f32_16x16x32_bf16 v[12:15], a[228:231], a[100:103], v[12:15]
v_cvt_pk_bf16_f32 v48, v20, v21
v_cvt_pk_bf16_f32 v49, v22, v23
v_mfma_f32_16x16x32_bf16 v[16:19], a[228:231], a[132:135], v[16:19]
v_cvt_pk_bf16_f32 v50, v24, v25
v_cvt_pk_bf16_f32 v51, v26, v27
v_mfma_f32_16x16x32_bf16 v[0:3], a[232:235], a[8:11], v[0:3]
s_add_u32 s41, s85, 10240
buffer_store_dwordx4 v[48:51], v242, s[24:27], s41 offen sc1
v_mfma_f32_16x16x32_bf16 v[4:7], a[232:235], a[40:43], v[4:7]
v_cvt_pk_bf16_f32 v52, v28, v29
v_cvt_pk_bf16_f32 v53, v30, v31
v_mfma_f32_16x16x32_bf16 v[8:11], a[232:235], a[72:75], v[8:11]
v_cvt_pk_bf16_f32 v54, v32, v33
v_cvt_pk_bf16_f32 v55, v34, v35
v_mfma_f32_16x16x32_bf16 v[12:15], a[232:235], a[104:107], v[12:15]
s_add_u32 s41, s85, 11264
buffer_store_dwordx4 v[52:55], v242, s[24:27], s41 offen sc1
v_mfma_f32_16x16x32_bf16 v[16:19], a[232:235], a[136:139], v[16:19]
v_cvt_pk_bf16_f32 v58, v36, v37
v_cvt_pk_bf16_f32 v59, v38, v39
v_mfma_f32_16x16x32_bf16 v[0:3], a[236:239], a[12:15], v[0:3]
buffer_store_dwordx4 v[56:59], v242, s[24:27], s87 offen offset:2048 sc1
v_mfma_f32_16x16x32_bf16 v[4:7], a[236:239], a[44:47], v[4:7]
v_mfma_f32_16x16x32_bf16 v[8:11], a[236:239], a[76:79], v[8:11]
v_mfma_f32_16x16x32_bf16 v[12:15], a[236:239], a[108:111], v[12:15]
v_mfma_f32_16x16x32_bf16 v[16:19], a[236:239], a[140:143], v[16:19]
v_mfma_f32_16x16x32_bf16 v[0:3], a[240:243], a[16:19], v[0:3]
v_mfma_f32_16x16x32_bf16 v[4:7], a[240:243], a[48:51], v[4:7]
v_mfma_f32_16x16x32_bf16 v[8:11], a[240:243], a[80:83], v[8:11]
v_mfma_f32_16x16x32_bf16 v[12:15], a[240:243], a[112:115], v[12:15]
v_mfma_f32_16x16x32_bf16 v[16:19], a[240:243], a[144:147], v[16:19]
v_mfma_f32_16x16x32_bf16 v[0:3], a[244:247], a[20:23], v[0:3]
v_mfma_f32_16x16x32_bf16 v[4:7], a[244:247], a[52:55], v[4:7]
v_mfma_f32_16x16x32_bf16 v[8:11], a[244:247], a[84:87], v[8:11]
v_mfma_f32_16x16x32_bf16 v[12:15], a[244:247], a[116:119], v[12:15]
v_mfma_f32_16x16x32_bf16 v[16:19], a[244:247], a[148:151], v[16:19]
v_mfma_f32_16x16x32_bf16 v[0:3], a[248:251], a[24:27], v[0:3]
v_mfma_f32_16x16x32_bf16 v[4:7], a[248:251], a[56:59], v[4:7]
v_mfma_f32_16x16x32_bf16 v[8:11], a[248:251], a[88:91], v[8:11]
v_mfma_f32_16x16x32_bf16 v[12:15], a[248:251], a[120:123], v[12:15]
v_mfma_f32_16x16x32_bf16 v[16:19], a[248:251], a[152:155], v[16:19]
v_mfma_f32_16x16x32_bf16 v[0:3], a[252:255], a[28:31], v[0:3]
v_mfma_f32_16x16x32_bf16 v[4:7], a[252:255], a[60:63], v[4:7]
v_mfma_f32_16x16x32_bf16 v[8:11], a[252:255], a[92:95], v[8:11]
v_mfma_f32_16x16x32_bf16 v[12:15], a[252:255], a[124:127], v[12:15]
v_mfma_f32_16x16x32_bf16 v[16:19], a[252:255], a[156:159], v[16:19]
s_nop 7
v_cvt_pk_bf16_f32 v40, v0, v1
v_cvt_pk_bf16_f32 v41, v2, v3
s_nop 7
v_cvt_pk_bf16_f32 v42, v4, v5
v_cvt_pk_bf16_f32 v43, v6, v7
s_nop 7
s_add_u32 s41, s85, 12288
buffer_store_dwordx4 v[40:43], v242, s[24:27], s41 offen sc1
v_cvt_pk_bf16_f32 v44, v8, v9
v_cvt_pk_bf16_f32 v45, v10, v11
v_cvt_pk_bf16_f32 v46, v12, v13
v_cvt_pk_bf16_f32 v47, v14, v15
s_add_u32 s41, s85, 13312
buffer_store_dwordx4 v[44:47], v242, s[24:27], s41 offen sc1
v_cvt_pk_bf16_f32 v56, v16, v17
v_cvt_pk_bf16_f32 v57, v18, v19
buffer_store_dwordx4 v[56:59], v242, s[24:27], s87 offen offset:3072 sc1
s_and_b32 s85, s83, 31
s_lshl_b32 s85, s85, 2
s_add_u32 s85, s85, s3
s_cmp_ge_u32 s85, 112
s_cbranch_scc1 L_t8
s_mul_hi_u32 s87, s85, 306783379
s_mul_i32 s40, s87, 14
s_sub_u32 s40, s85, s40
s_lshr_b32 s86, s87, 2
s_and_b32 s87, s87, 3
s_lshr_b32 s41, s40, 1
s_mul_i32 s88, s86, 3
s_add_u32 s41, s41, s88
s_cmp_ge_u32 s41, 7
s_cselect_b32 s88, 7, 0
s_sub_u32 s41, s41, s88
s_lshl_b32 s41, s41, 2
s_add_u32 s41, s41, s87
s_lshl_b32 s41, s41, 5
s_and_b32 s40, s40, 1
s_lshl_b32 s88, s86, 1
s_add_u32 s40, s40, s88
s_mul_i32 s88, s40, 28672
s_add_u32 s88, s88, s41
s_add_u32 s89, s88, 14336
s_branch L_go
L_t8:
s_sub_u32 s40, s85, 112
s_mov_b32 s86, 0
s_lshr_b32 s87, s40, 2
s_and_b32 s40, s40, 3
s_lshl_b32 s88, s40, 3
s_add_u32 s88, s88, s87
s_lshl_b32 s88, s88, 5
s_add_u32 s88, s88, 114688
s_add_u32 s89, s88, 128
s_cmp_eq_u32 s40, 3
s_cselect_b32 s89, 1073741824, s89
L_go:
s_mul_i32 s40, s81, 129024
s_add_u32 s4, s58, s40
s_addc_u32 s5, s59, 0
s_mov_b32 s6, 129024
s_mov_b32 s7, 0x20000
s_lshl_b32 s40, s81, 21
s_lshl_b32 s41, s85, 10
s_add_u32 s40, s40, s41
s_add_u32 s8, s62, s40
s_addc_u32 s9, s63, 0
s_mov_b32 s10, 1967104
s_mov_b32 s11, 0x20000
s_lshl_b32 s40, s81, 21
s_add_u32 s40, s40, 16777216
s_add_u32 s12, s62, s40
s_addc_u32 s13, s63, 0
s_mov_b32 s14, 2097152
s_mov_b32 s15, 0x20000
s_lshl_b32 s40, s86, 16
s_lshl_b32 s41, s87, 7
s_add_u32 s97, s40, s41
s_add_u32 s97, s97, 61952
v_and_b32 v250, 15, v255
v_mul_u32_u24 v251, 896, v250
v_lshlrev_b32 v250, 17, v250
v_lshrrev_b32 v241, 4, v255
v_lshl_add_u32 v251, v241, 3, v251
buffer_load_dword v245, v250, s[12:15], s97 offen sc1
v_mov_b32 v238, 2
v_mov_b32 v0, 0
v_mov_b32 v1, 0
v_mov_b32 v2, 0
v_mov_b32 v3, 0
v_mov_b32 v4, 0
v_mov_b32 v5, 0
v_mov_b32 v6, 0
v_mov_b32 v7, 0
v_mov_b32 v253, 1073741824
s_mov_b32 s98, 0xffff
s_mov_b32 s35, 0
s_waitcnt vmcnt(1)
buffer_store_dword v238, v239, s[28:31], s96 offen offset:512 sc1
s_waitcnt vmcnt(1)
s_branch L_rchk
L_rpoll:
buffer_load_dword v245, v250, s[12:15], s97 offen sc1
s_waitcnt vmcnt(0)
L_rchk:
v_cmp_eq_u32 vcc, 2, v245
s_add_u32 s35, s35, 1
s_and_b32 s45, vcc_lo, s98
s_cbranch_scc1 L_rsome
s_sleep 2
s_cmp_lt_u32 s35, 0x200000
s_cbranch_scc1 L_rpoll
s_branch L_rdone
L_rsome:
v_cndmask_b32 v250, v250, v253, vcc
s_andn2_b32 s98, s98, s45
s_bcnt1_i32_b32 s40, s45
s_cmp_gt_u32 s40, 4
s_cbranch_scc1 L_rbig
s_ff1_i32_b32 s40, s45
s_bitset0_b32 s45, s40
s_lshl_b32 s40, s40, 17
buffer_load_dwordx4 v[64:67], v242, s[8:11], s40 offen sc1
s_ff1_i32_b32 s40, s45
s_bitset0_b32 s45, s40
s_lshl_b32 s40, s40, 17
buffer_load_dwordx4 v[68:71], v242, s[8:11], s40 offen sc1
s_ff1_i32_b32 s40, s45
s_bitset0_b32 s45, s40
s_lshl_b32 s40, s40, 17
buffer_load_dwordx4 v[72:75], v242, s[8:11], s40 offen sc1
s_ff1_i32_b32 s40, s45
s_bitset0_b32 s45, s40
s_lshl_b32 s40, s40, 17
buffer_load_dwordx4 v[76:79], v242, s[8:11], s40 offen sc1
s_waitcnt vmcnt(3)
v_lshlrev_b32 v12, 16, v64
v_and_b32 v13, 0xffff0000, v64
v_pk_add_f32 v[0:1], v[0:1], v[12:13]
v_lshlrev_b32 v14, 16, v65
v_and_b32 v15, 0xffff0000, v65
v_pk_add_f32 v[2:3], v[2:3], v[14:15]
v_lshlrev_b32 v12, 16, v66
v_and_b32 v13, 0xffff0000, v66
v_pk_add_f32 v[4:5], v[4:5], v[12:13]
v_lshlrev_b32 v14, 16, v67
v_and_b32 v15, 0xffff0000, v67
v_pk_add_f32 v[6:7], v[6:7], v[14:15]
s_waitcnt vmcnt(2)
v_lshlrev_b32 v12, 16, v68
v_and_b32 v13, 0xffff0000, v68
v_pk_add_f32 v[0:1], v[0:1], v[12:13]
v_lshlrev_b32 v14, 16, v69
v_and_b32 v15, 0xffff0000, v69
v_pk_add_f32 v[2:3], v[2:3], v[14:15]
v_lshlrev_b32 v12, 16, v70
v_and_b32 v13, 0xffff0000, v70
v_pk_add_f32 v[4:5], v[4:5], v[12:13]
v_lshlrev_b32 v14, 16, v71
v_and_b32 v15, 0xffff0000, v71
v_pk_add_f32 v[6:7], v[6:7], v[14:15]
s_waitcnt vmcnt(1)
v_lshlrev_b32 v12, 16, v72
v_and_b32 v13, 0xffff0000, v72
v_pk_add_f32 v[0:1], v[0:1], v[12:13]
v_lshlrev_b32 v14, 16, v73
v_and_b32 v15, 0xffff0000, v73
v_pk_add_f32 v[2:3], v[2:3], v[14:15]
v_lshlrev_b32 v12, 16, v74
v_and_b32 v13, 0xffff0000, v74
v_pk_add_f32 v[4:5], v[4:5], v[12:13]
v_lshlrev_b32 v14, 16, v75
v_and_b32 v15, 0xffff0000, v75
v_pk_add_f32 v[6:7], v[6:7], v[14:15]
s_waitcnt vmcnt(0)
v_lshlrev_b32 v12, 16, v76
v_and_b32 v13, 0xffff0000, v76
v_pk_add_f32 v[0:1], v[0:1], v[12:13]
v_lshlrev_b32 v14, 16, v77
v_and_b32 v15, 0xffff0000, v77
v_pk_add_f32 v[2:3], v[2:3], v[14:15]
v_lshlrev_b32 v12, 16, v78
v_and_b32 v13, 0xffff0000, v78
v_pk_add_f32 v[4:5], v[4:5], v[12:13]
v_lshlrev_b32 v14, 16, v79
v_and_b32 v15, 0xffff0000, v79
v_pk_add_f32 v[6:7], v[6:7], v[14:15]
s_cmp_lg_u32 s98, 0
s_cbranch_scc1 L_rpoll
s_branch L_rdone
L_rbig:
s_ff1_i32_b32 s40, s45
s_bitset0_b32 s45, s40
s_lshl_b32 s40, s40, 17
buffer_load_dwordx4 v[64:67], v242, s[8:11], s40 offen sc1
s_ff1_i32_b32 s40, s45
s_bitset0_b32 s45, s40
s_lshl_b32 s40, s40, 17
buffer_load_dwordx4 v[68:71], v242, s[8:11], s40 offen sc1
s_ff1_i32_b32 s40, s45
s_bitset0_b32 s45, s40
s_lshl_b32 s40, s40, 17
buffer_load_dwordx4 v[72:75], v242, s[8:11], s40 offen sc1
s_ff1_i32_b32 s40, s45
s_bitset0_b32 s45, s40
s_lshl_b32 s40, s40, 17
buffer_load_dwordx4 v[76:79], v242, s[8:11], s40 offen sc1
s_ff1_i32_b32 s40, s45
s_bitset0_b32 s45, s40
s_lshl_b32 s40, s40, 17
buffer_load_dwordx4 v[80:83], v242, s[8:11], s40 offen sc1
s_ff1_i32_b32 s40, s45
s_bitset0_b32 s45, s40
s_lshl_b32 s40, s40, 17
buffer_load_dwordx4 v[84:87], v242, s[8:11], s40 offen sc1
s_ff1_i32_b32 s40, s45
s_bitset0_b32 s45, s40
s_lshl_b32 s40, s40, 17
buffer_load_dwordx4 v[88:91], v242, s[8:11], s40 offen sc1
s_ff1_i32_b32 s40, s45
s_bitset0_b32 s45, s40
s_lshl_b32 s40, s40, 17
buffer_load_dwordx4 v[92:95], v242, s[8:11], s40 offen sc1
s_ff1_i32_b32 s40, s45
s_bitset0_b32 s45, s40
s_lshl_b32 s40, s40, 17
buffer_load_dwordx4 v[96:99], v242, s[8:11], s40 offen sc1
s_ff1_i32_b32 s40, s45
s_bitset0_b32 s45, s40
s_lshl_b32 s40, s40, 17
buffer_load_dwordx4 v[100:103], v242, s[8:11], s40 offen sc1
s_ff1_i32_b32 s40, s45
s_bitset0_b32 s45, s40
s_lshl_b32 s40, s40, 17
buffer_load_dwordx4 v[104:107], v242, s[8:11], s40 offen sc1
s_ff1_i32_b32 s40, s45
s_bitset0_b32 s45, s40
s_lshl_b32 s40, s40, 17
buffer_load_dwordx4 v[108:111], v242, s[8:11], s40 offen sc1
s_ff1_i32_b32 s40, s45
s_bitset0_b32 s45, s40
s_lshl_b32 s40, s40, 17
buffer_load_dwordx4 v[112:115], v242, s[8:11], s40 offen sc1
s_ff1_i32_b32 s40, s45
s_bitset0_b32 s45, s40
s_lshl_b32 s40, s40, 17
buffer_load_dwordx4 v[116:119], v242, s[8:11], s40 offen sc1
s_ff1_i32_b32 s40, s45
s_bitset0_b32 s45, s40
s_lshl_b32 s40, s40, 17
buffer_load_dwordx4 v[120:123], v242, s[8:11], s40 offen sc1
s_ff1_i32_b32 s40, s45
s_bitset0_b32 s45, s40
s_lshl_b32 s40, s40, 17
buffer_load_dwordx4 v[124:127], v242, s[8:11], s40 offen sc1
s_waitcnt vmcnt(15)
v_lshlrev_b32 v12, 16, v64
v_and_b32 v13, 0xffff0000, v64
v_pk_add_f32 v[0:1], v[0:1], v[12:13]
v_lshlrev_b32 v14, 16, v65
v_and_b32 v15, 0xffff0000, v65
v_pk_add_f32 v[2:3], v[2:3], v[14:15]
v_lshlrev_b32 v12, 16, v66
v_and_b32 v13, 0xffff0000, v66
v_pk_add_f32 v[4:5], v[4:5], v[12:13]
v_lshlrev_b32 v14, 16, v67
v_and_b32 v15, 0xffff0000, v67
v_pk_add_f32 v[6:7], v[6:7], v[14:15]
s_waitcnt vmcnt(14)
v_lshlrev_b32 v12, 16, v68
v_and_b32 v13, 0xffff0000, v68
v_pk_add_f32 v[0:1], v[0:1], v[12:13]
v_lshlrev_b32 v14, 16, v69
v_and_b32 v15, 0xffff0000, v69
v_pk_add_f32 v[2:3], v[2:3], v[14:15]
v_lshlrev_b32 v12, 16, v70
v_and_b32 v13, 0xffff0000, v70
v_pk_add_f32 v[4:5], v[4:5], v[12:13]
v_lshlrev_b32 v14, 16, v71
v_and_b32 v15, 0xffff0000, v71
v_pk_add_f32 v[6:7], v[6:7], v[14:15]
s_waitcnt vmcnt(13)
v_lshlrev_b32 v12, 16, v72
v_and_b32 v13, 0xffff0000, v72
v_pk_add_f32 v[0:1], v[0:1], v[12:13]
v_lshlrev_b32 v14, 16, v73
v_and_b32 v15, 0xffff0000, v73
v_pk_add_f32 v[2:3], v[2:3], v[14:15]
v_lshlrev_b32 v12, 16, v74
v_and_b32 v13, 0xffff0000, v74
v_pk_add_f32 v[4:5], v[4:5], v[12:13]
v_lshlrev_b32 v14, 16, v75
v_and_b32 v15, 0xffff0000, v75
v_pk_add_f32 v[6:7], v[6:7], v[14:15]
s_waitcnt vmcnt(12)
v_lshlrev_b32 v12, 16, v76
v_and_b32 v13, 0xffff0000, v76
v_pk_add_f32 v[0:1], v[0:1], v[12:13]
v_lshlrev_b32 v14, 16, v77
v_and_b32 v15, 0xffff0000, v77
v_pk_add_f32 v[2:3], v[2:3], v[14:15]
v_lshlrev_b32 v12, 16, v78
v_and_b32 v13, 0xffff0000, v78
v_pk_add_f32 v[4:5], v[4:5], v[12:13]
v_lshlrev_b32 v14, 16, v79
v_and_b32 v15, 0xffff0000, v79
v_pk_add_f32 v[6:7], v[6:7], v[14:15]
s_waitcnt vmcnt(11)
v_lshlrev_b32 v12, 16, v80
v_and_b32 v13, 0xffff0000, v80
v_pk_add_f32 v[0:1], v[0:1], v[12:13]
v_lshlrev_b32 v14, 16, v81
v_and_b32 v15, 0xffff0000, v81
v_pk_add_f32 v[2:3], v[2:3], v[14:15]
v_lshlrev_b32 v12, 16, v82
v_and_b32 v13, 0xffff0000, v82
v_pk_add_f32 v[4:5], v[4:5], v[12:13]
v_lshlrev_b32 v14, 16, v83
v_and_b32 v15, 0xffff0000, v83
v_pk_add_f32 v[6:7], v[6:7], v[14:15]
s_waitcnt vmcnt(10)
v_lshlrev_b32 v12, 16, v84
v_and_b32 v13, 0xffff0000, v84
v_pk_add_f32 v[0:1], v[0:1], v[12:13]
v_lshlrev_b32 v14, 16, v85
v_and_b32 v15, 0xffff0000, v85
v_pk_add_f32 v[2:3], v[2:3], v[14:15]
v_lshlrev_b32 v12, 16, v86
v_and_b32 v13, 0xffff0000, v86
v_pk_add_f32 v[4:5], v[4:5], v[12:13]
v_lshlrev_b32 v14, 16, v87
v_and_b32 v15, 0xffff0000, v87
v_pk_add_f32 v[6:7], v[6:7], v[14:15]
s_waitcnt vmcnt(9)
v_lshlrev_b32 v12, 16, v88
v_and_b32 v13, 0xffff0000, v88
v_pk_add_f32 v[0:1], v[0:1], v[12:13]
v_lshlrev_b32 v14, 16, v89
v_and_b32 v15, 0xffff0000, v89
v_pk_add_f32 v[2:3], v[2:3], v[14:15]
v_lshlrev_b32 v12, 16, v90
v_and_b32 v13, 0xffff0000, v90
v_pk_add_f32 v[4:5], v[4:5], v[12:13]
v_lshlrev_b32 v14, 16, v91
v_and_b32 v15, 0xffff0000, v91
v_pk_add_f32 v[6:7], v[6:7], v[14:15]
s_waitcnt vmcnt(8)
v_lshlrev_b32 v12, 16, v92
v_and_b32 v13, 0xffff0000, v92
v_pk_add_f32 v[0:1], v[0:1], v[12:13]
v_lshlrev_b32 v14, 16, v93
v_and_b32 v15, 0xffff0000, v93
v_pk_add_f32 v[2:3], v[2:3], v[14:15]
v_lshlrev_b32 v12, 16, v94
v_and_b32 v13, 0xffff0000, v94
v_pk_add_f32 v[4:5], v[4:5], v[12:13]
v_lshlrev_b32 v14, 16, v95
v_and_b32 v15, 0xffff0000, v95
v_pk_add_f32 v[6:7], v[6:7], v[14:15]
s_waitcnt vmcnt(7)
v_lshlrev_b32 v12, 16, v96
v_and_b32 v13, 0xffff0000, v96
v_pk_add_f32 v[0:1], v[0:1], v[12:13]
v_lshlrev_b32 v14, 16, v97
v_and_b32 v15, 0xffff0000, v97
v_pk_add_f32 v[2:3], v[2:3], v[14:15]
v_lshlrev_b32 v12, 16, v98
v_and_b32 v13, 0xffff0000, v98
v_pk_add_f32 v[4:5], v[4:5], v[12:13]
v_lshlrev_b32 v14, 16, v99
v_and_b32 v15, 0xffff0000, v99
v_pk_add_f32 v[6:7], v[6:7], v[14:15]
s_waitcnt vmcnt(6)
v_lshlrev_b32 v12, 16, v100
v_and_b32 v13, 0xffff0000, v100
v_pk_add_f32 v[0:1], v[0:1], v[12:13]
v_lshlrev_b32 v14, 16, v101
v_and_b32 v15, 0xffff0000, v101
v_pk_add_f32 v[2:3], v[2:3], v[14:15]
v_lshlrev_b32 v12, 16, v102
v_and_b32 v13, 0xffff0000, v102
v_pk_add_f32 v[4:5], v[4:5], v[12:13]
v_lshlrev_b32 v14, 16, v103
v_and_b32 v15, 0xffff0000, v103
v_pk_add_f32 v[6:7], v[6:7], v[14:15]
s_waitcnt vmcnt(5)
v_lshlrev_b32 v12, 16, v104
v_and_b32 v13, 0xffff0000, v104
v_pk_add_f32 v[0:1], v[0:1], v[12:13]
v_lshlrev_b32 v14, 16, v105
v_and_b32 v15, 0xffff0000, v105
v_pk_add_f32 v[2:3], v[2:3], v[14:15]
v_lshlrev_b32 v12, 16, v106
v_and_b32 v13, 0xffff0000, v106
v_pk_add_f32 v[4:5], v[4:5], v[12:13]
v_lshlrev_b32 v14, 16, v107
v_and_b32 v15, 0xffff0000, v107
v_pk_add_f32 v[6:7], v[6:7], v[14:15]
s_waitcnt vmcnt(4)
v_lshlrev_b32 v12, 16, v108
v_and_b32 v13, 0xffff0000, v108
v_pk_add_f32 v[0:1], v[0:1], v[12:13]
v_lshlrev_b32 v14, 16, v109
v_and_b32 v15, 0xffff0000, v109
v_pk_add_f32 v[2:3], v[2:3], v[14:15]
v_lshlrev_b32 v12, 16, v110
v_and_b32 v13, 0xffff0000, v110
v_pk_add_f32 v[4:5], v[4:5], v[12:13]
v_lshlrev_b32 v14, 16, v111
v_and_b32 v15, 0xffff0000, v111
v_pk_add_f32 v[6:7], v[6:7], v[14:15]
s_waitcnt vmcnt(3)
v_lshlrev_b32 v12, 16, v112
v_and_b32 v13, 0xffff0000, v112
v_pk_add_f32 v[0:1], v[0:1], v[12:13]
v_lshlrev_b32 v14, 16, v113
v_and_b32 v15, 0xffff0000, v113
v_pk_add_f32 v[2:3], v[2:3], v[14:15]
v_lshlrev_b32 v12, 16, v114
v_and_b32 v13, 0xffff0000, v114
v_pk_add_f32 v[4:5], v[4:5], v[12:13]
v_lshlrev_b32 v14, 16, v115
v_and_b32 v15, 0xffff0000, v115
v_pk_add_f32 v[6:7], v[6:7], v[14:15]
s_waitcnt vmcnt(2)
v_lshlrev_b32 v12, 16, v116
v_and_b32 v13, 0xffff0000, v116
v_pk_add_f32 v[0:1], v[0:1], v[12:13]
v_lshlrev_b32 v14, 16, v117
v_and_b32 v15, 0xffff0000, v117
v_pk_add_f32 v[2:3], v[2:3], v[14:15]
v_lshlrev_b32 v12, 16, v118
v_and_b32 v13, 0xffff0000, v118
v_pk_add_f32 v[4:5], v[4:5], v[12:13]
v_lshlrev_b32 v14, 16, v119
v_and_b32 v15, 0xffff0000, v119
v_pk_add_f32 v[6:7], v[6:7], v[14:15]
s_waitcnt vmcnt(1)
v_lshlrev_b32 v12, 16, v120
v_and_b32 v13, 0xffff0000, v120
v_pk_add_f32 v[0:1], v[0:1], v[12:13]
v_lshlrev_b32 v14, 16, v121
v_and_b32 v15, 0xffff0000, v121
v_pk_add_f32 v[2:3], v[2:3], v[14:15]
v_lshlrev_b32 v12, 16, v122
v_and_b32 v13, 0xffff0000, v122
v_pk_add_f32 v[4:5], v[4:5], v[12:13]
v_lshlrev_b32 v14, 16, v123
v_and_b32 v15, 0xffff0000, v123
v_pk_add_f32 v[6:7], v[6:7], v[14:15]
s_waitcnt vmcnt(0)
v_lshlrev_b32 v12, 16, v124
v_and_b32 v13, 0xffff0000, v124
v_pk_add_f32 v[0:1], v[0:1], v[12:13]
v_lshlrev_b32 v14, 16, v125
v_and_b32 v15, 0xffff0000, v125
v_pk_add_f32 v[2:3], v[2:3], v[14:15]
v_lshlrev_b32 v12, 16, v126
v_and_b32 v13, 0xffff0000, v126
v_pk_add_f32 v[4:5], v[4:5], v[12:13]
v_lshlrev_b32 v14, 16, v127
v_and_b32 v15, 0xffff0000, v127
v_pk_add_f32 v[6:7], v[6:7], v[14:15]
s_cmp_lg_u32 s98, 0
s_cbranch_scc1 L_rpoll
L_rdone:
v_cvt_pk_bf16_f32 v16, v0, v1
v_cvt_pk_bf16_f32 v17, v2, v3
v_cvt_pk_bf16_f32 v18, v4, v5
v_cvt_pk_bf16_f32 v19, v6, v7
buffer_store_dwordx2 v[16:17], v251, s[4:7], s88 offen
buffer_store_dwordx2 v[18:19], v251, s[4:7], s89 offen
L_done:
s_endpgm
L_rare0_0:
v_mov_b32 v235, v234
s_nop 1
v_permlane32_swap_b32 v234, v235
s_nop 1
v_max_f32 v234, v234, v235
v_mov_b32 v235, v234
s_nop 1
v_permlane16_swap_b32 v234, v235
s_nop 1
v_max_f32 v234, v234, v235
v_mul_f32 v234, s32, v234
v_max_f32 v234, v234, -v228
v_sub_f32 v235, -v228, v234
v_exp_f32 v235, v235
v_sub_f32 v228, 0, v234
v_mov_b32 v229, s34
v_fma_f32 v229, v234, s33, v229
v_mul_f32 v0, v0, v235
v_mul_f32 v1, v1, v235
v_mul_f32 v2, v2, v235
v_mul_f32 v3, v3, v235
v_mul_f32 v4, v4, v235
v_mul_f32 v5, v5, v235
v_mul_f32 v6, v6, v235
v_mul_f32 v7, v7, v235
v_mul_f32 v8, v8, v235
v_mul_f32 v9, v9, v235
v_mul_f32 v10, v10, v235
v_mul_f32 v11, v11, v235
v_mul_f32 v12, v12, v235
v_mul_f32 v13, v13, v235
v_mul_f32 v14, v14, v235
v_mul_f32 v15, v15, v235
v_mul_f32 v16, v16, v235
v_mul_f32 v17, v17, v235
v_mul_f32 v18, v18, v235
v_mul_f32 v19, v19, v235
v_mul_f32 v20, v20, v235
v_mul_f32 v21, v21, v235
v_mul_f32 v22, v22, v235
v_mul_f32 v23, v23, v235
v_mul_f32 v24, v24, v235
v_mul_f32 v25, v25, v235
v_mul_f32 v26, v26, v235
v_mul_f32 v27, v27, v235
v_mul_f32 v28, v28, v235
v_mul_f32 v29, v29, v235
v_mul_f32 v30, v30, v235
v_mul_f32 v31, v31, v235
v_mul_f32 v32, v32, v235
v_mul_f32 v33, v33, v235
v_mul_f32 v34, v34, v235
v_mul_f32 v35, v35, v235
v_mul_f32 v36, v36, v235
v_mul_f32 v37, v37, v235
v_mul_f32 v38, v38, v235
v_mul_f32 v39, v39, v235
v_mul_f32 v40, v40, v235
v_mul_f32 v41, v41, v235
v_mul_f32 v42, v42, v235
v_mul_f32 v43, v43, v235
v_mul_f32 v44, v44, v235
v_mul_f32 v45, v45, v235
v_mul_f32 v46, v46, v235
v_mul_f32 v47, v47, v235
v_mul_f32 v48, v48, v235
v_mul_f32 v49, v49, v235
v_mul_f32 v50, v50, v235
v_mul_f32 v51, v51, v235
v_mul_f32 v52, v52, v235
v_mul_f32 v53, v53, v235
v_mul_f32 v54, v54, v235
v_mul_f32 v55, v55, v235
v_mul_f32 v56, v56, v235
v_mul_f32 v57, v57, v235
v_mul_f32 v58, v58, v235
v_mul_f32 v59, v59, v235
v_mul_f32 v60, v60, v235
v_mul_f32 v61, v61, v235
v_mul_f32 v62, v62, v235
v_mul_f32 v63, v63, v235
v_accvgpr_read_b32 v234, a224
v_mul_f32 v234, v234, v235
v_accvgpr_write_b32 a224, v234
v_accvgpr_read_b32 v234, a225
v_mul_f32 v234, v234, v235
v_accvgpr_write_b32 a225, v234
v_accvgpr_read_b32 v234, a226
v_mul_f32 v234, v234, v235
v_accvgpr_write_b32 a226, v234
v_accvgpr_read_b32 v234, a227
v_mul_f32 v234, v234, v235
v_accvgpr_write_b32 a227, v234
s_branch L_ret0_0
L_rare0_1:
v_mov_b32 v237, v236
s_nop 1
v_permlane32_swap_b32 v236, v237
s_nop 1
v_max_f32 v236, v236, v237
v_mov_b32 v237, v236
s_nop 1
v_permlane16_swap_b32 v236, v237
s_nop 1
v_max_f32 v236, v236, v237
v_mul_f32 v236, s32, v236
v_max_f32 v236, v236, -v230
v_sub_f32 v237, -v230, v236
v_exp_f32 v237, v237
v_sub_f32 v230, 0, v236
v_mov_b32 v231, s34
v_fma_f32 v231, v236, s33, v231
v_mul_f32 v64, v64, v237
v_mul_f32 v65, v65, v237
v_mul_f32 v66, v66, v237
v_mul_f32 v67, v67, v237
v_mul_f32 v68, v68, v237
v_mul_f32 v69, v69, v237
v_mul_f32 v70, v70, v237
v_mul_f32 v71, v71, v237
v_mul_f32 v72, v72, v237
v_mul_f32 v73, v73, v237
v_mul_f32 v74, v74, v237
v_mul_f32 v75, v75, v237
v_mul_f32 v76, v76, v237
v_mul_f32 v77, v77, v237
v_mul_f32 v78, v78, v237
v_mul_f32 v79, v79, v237
v_mul_f32 v80, v80, v237
v_mul_f32 v81, v81, v237
v_mul_f32 v82, v82, v237
v_mul_f32 v83, v83, v237
v_mul_f32 v84, v84, v237
v_mul_f32 v85, v85, v237
v_mul_f32 v86, v86, v237
v_mul_f32 v87, v87, v237
v_mul_f32 v88, v88, v237
v_mul_f32 v89, v89, v237
v_mul_f32 v90, v90, v237
v_mul_f32 v91, v91, v237
v_mul_f32 v92, v92, v237
v_mul_f32 v93, v93, v237
v_mul_f32 v94, v94, v237
v_mul_f32 v95, v95, v237
v_mul_f32 v96, v96, v237
v_mul_f32 v97, v97, v237
v_mul_f32 v98, v98, v237
v_mul_f32 v99, v99, v237
v_mul_f32 v100, v100, v237
v_mul_f32 v101, v101, v237
v_mul_f32 v102, v102, v237
v_mul_f32 v103, v103, v237
v_mul_f32 v104, v104, v237
v_mul_f32 v105, v105, v237
v_mul_f32 v106, v106, v237
v_mul_f32 v107, v107, v237
v_mul_f32 v108, v108, v237
v_mul_f32 v109, v109, v237
v_mul_f32 v110, v110, v237
v_mul_f32 v111, v111, v237
v_mul_f32 v112, v112, v237
v_mul_f32 v113, v113, v237
v_mul_f32 v114, v114, v237
v_mul_f32 v115, v115, v237
v_mul_f32 v116, v116, v237
v_mul_f32 v117, v117, v237
v_mul_f32 v118, v118, v237
v_mul_f32 v119, v119, v237
v_mul_f32 v120, v120, v237
v_mul_f32 v121, v121, v237
v_mul_f32 v122, v122, v237
v_mul_f32 v123, v123, v237
v_mul_f32 v124, v124, v237
v_mul_f32 v125, v125, v237
v_mul_f32 v126, v126, v237
v_mul_f32 v127, v127, v237
v_accvgpr_read_b32 v236, a228
v_mul_f32 v236, v236, v237
v_accvgpr_write_b32 a228, v236
v_accvgpr_read_b32 v236, a229
v_mul_f32 v236, v236, v237
v_accvgpr_write_b32 a229, v236
v_accvgpr_read_b32 v236, a230
v_mul_f32 v236, v236, v237
v_accvgpr_write_b32 a230, v236
v_accvgpr_read_b32 v236, a231
v_mul_f32 v236, v236, v237
v_accvgpr_write_b32 a231, v236
s_branch L_ret0_1
L_rare0_2:
v_mov_b32 v235, v234
s_nop 1
v_permlane32_swap_b32 v234, v235
s_nop 1
v_max_f32 v234, v234, v235
v_mov_b32 v235, v234
s_nop 1
v_permlane16_swap_b32 v234, v235
s_nop 1
v_max_f32 v234, v234, v235
v_mul_f32 v234, s32, v234
v_max_f32 v234, v234, -v232
v_sub_f32 v235, -v232, v234
v_exp_f32 v235, v235
v_sub_f32 v232, 0, v234
v_mov_b32 v233, s34
v_fma_f32 v233, v234, s33, v233
v_mul_f32 v128, v128, v235
v_mul_f32 v129, v129, v235
v_mul_f32 v130, v130, v235
v_mul_f32 v131, v131, v235
v_mul_f32 v132, v132, v235
v_mul_f32 v133, v133, v235
v_mul_f32 v134, v134, v235
v_mul_f32 v135, v135, v235
v_mul_f32 v136, v136, v235
v_mul_f32 v137, v137, v235
v_mul_f32 v138, v138, v235
v_mul_f32 v139, v139, v235
v_mul_f32 v140, v140, v235
v_mul_f32 v141, v141, v235
v_mul_f32 v142, v142, v235
v_mul_f32 v143, v143, v235
v_mul_f32 v144, v144, v235
v_mul_f32 v145, v145, v235
v_mul_f32 v146, v146, v235
v_mul_f32 v147, v147, v235
v_mul_f32 v148, v148, v235
v_mul_f32 v149, v149, v235
v_mul_f32 v150, v150, v235
v_mul_f32 v151, v151, v235
v_mul_f32 v152, v152, v235
v_mul_f32 v153, v153, v235
v_mul_f32 v154, v154, v235
v_mul_f32 v155, v155, v235
v_mul_f32 v156, v156, v235
v_mul_f32 v157, v157, v235
v_mul_f32 v158, v158, v235
v_mul_f32 v159, v159, v235
v_mul_f32 v160, v160, v235
v_mul_f32 v161, v161, v235
v_mul_f32 v162, v162, v235
v_mul_f32 v163, v163, v235
v_mul_f32 v164, v164, v235
v_mul_f32 v165, v165, v235
v_mul_f32 v166, v166, v235
v_mul_f32 v167, v167, v235
v_mul_f32 v168, v168, v235
v_mul_f32 v169, v169, v235
v_mul_f32 v170, v170, v235
v_mul_f32 v171, v171, v235
v_mul_f32 v172, v172, v235
v_mul_f32 v173, v173, v235
v_mul_f32 v174, v174, v235
v_mul_f32 v175, v175, v235
v_mul_f32 v176, v176, v235
v_mul_f32 v177, v177, v235
v_mul_f32 v178, v178, v235
v_mul_f32 v179, v179, v235
v_mul_f32 v180, v180, v235
v_mul_f32 v181, v181, v235
v_mul_f32 v182, v182, v235
v_mul_f32 v183, v183, v235
v_mul_f32 v184, v184, v235
v_mul_f32 v185, v185, v235
v_mul_f32 v186, v186, v235
v_mul_f32 v187, v187, v235
v_mul_f32 v188, v188, v235
v_mul_f32 v189, v189, v235
v_mul_f32 v190, v190, v235
v_mul_f32 v191, v191, v235
v_accvgpr_read_b32 v234, a232
v_mul_f32 v234, v234, v235
v_accvgpr_write_b32 a232, v234
v_accvgpr_read_b32 v234, a233
v_mul_f32 v234, v234, v235
v_accvgpr_write_b32 a233, v234
v_accvgpr_read_b32 v234, a234
v_mul_f32 v234, v234, v235
v_accvgpr_write_b32 a234, v234
v_accvgpr_read_b32 v234, a235
v_mul_f32 v234, v234, v235
v_accvgpr_write_b32 a235, v234
s_branch L_ret0_2
L_rare1_0:
v_mov_b32 v235, v234
s_nop 1
v_permlane32_swap_b32 v234, v235
s_nop 1
v_max_f32 v234, v234, v235
v_mov_b32 v235, v234
s_nop 1
v_permlane16_swap_b32 v234, v235
s_nop 1
v_max_f32 v234, v234, v235
v_mul_f32 v234, s32, v234
v_max_f32 v234, v234, -v228
v_sub_f32 v235, -v228, v234
v_exp_f32 v235, v235
v_sub_f32 v228, 0, v234
v_mov_b32 v229, s34
v_fma_f32 v229, v234, s33, v229
v_mul_f32 v0, v0, v235
v_mul_f32 v1, v1, v235
v_mul_f32 v2, v2, v235
v_mul_f32 v3, v3, v235
v_mul_f32 v4, v4, v235
v_mul_f32 v5, v5, v235
v_mul_f32 v6, v6, v235
v_mul_f32 v7, v7, v235
v_mul_f32 v8, v8, v235
v_mul_f32 v9, v9, v235
v_mul_f32 v10, v10, v235
v_mul_f32 v11, v11, v235
v_mul_f32 v12, v12, v235
v_mul_f32 v13, v13, v235
v_mul_f32 v14, v14, v235
v_mul_f32 v15, v15, v235
v_mul_f32 v16, v16, v235
v_mul_f32 v17, v17, v235
v_mul_f32 v18, v18, v235
v_mul_f32 v19, v19, v235
v_mul_f32 v20, v20, v235
v_mul_f32 v21, v21, v235
v_mul_f32 v22, v22, v235
v_mul_f32 v23, v23, v235
v_mul_f32 v24, v24, v235
v_mul_f32 v25, v25, v235
v_mul_f32 v26, v26, v235
v_mul_f32 v27, v27, v235
v_mul_f32 v28, v28, v235
v_mul_f32 v29, v29, v235
v_mul_f32 v30, v30, v235
v_mul_f32 v31, v31, v235
v_mul_f32 v32, v32, v235
v_mul_f32 v33, v33, v235
v_mul_f32 v34, v34, v235
v_mul_f32 v35, v35, v235
v_mul_f32 v36, v36, v235
v_mul_f32 v37, v37, v235
v_mul_f32 v38, v38, v235
v_mul_f32 v39, v39, v235
v_mul_f32 v40, v40, v235
v_mul_f32 v41, v41, v235
v_mul_f32 v42, v42, v235
v_mul_f32 v43, v43, v235
v_mul_f32 v44, v44, v235
v_mul_f32 v45, v45, v235
v_mul_f32 v46, v46, v235
v_mul_f32 v47, v47, v235
v_mul_f32 v48, v48, v235
v_mul_f32 v49, v49, v235
v_mul_f32 v50, v50, v235
v_mul_f32 v51, v51, v235
v_mul_f32 v52, v52, v235
v_mul_f32 v53, v53, v235
v_mul_f32 v54, v54, v235
v_mul_f32 v55, v55, v235
v_mul_f32 v56, v56, v235
v_mul_f32 v57, v57, v235
v_mul_f32 v58, v58, v235
v_mul_f32 v59, v59, v235
v_mul_f32 v60, v60, v235
v_mul_f32 v61, v61, v235
v_mul_f32 v62, v62, v235
v_mul_f32 v63, v63, v235
v_accvgpr_read_b32 v234, a224
v_mul_f32 v234, v234, v235
v_accvgpr_write_b32 a224, v234
v_accvgpr_read_b32 v234, a225
v_mul_f32 v234, v234, v235
v_accvgpr_write_b32 a225, v234
v_accvgpr_read_b32 v234, a226
v_mul_f32 v234, v234, v235
v_accvgpr_write_b32 a226, v234
v_accvgpr_read_b32 v234, a227
v_mul_f32 v234, v234, v235
v_accvgpr_write_b32 a227, v234
s_branch L_ret1_0
L_rare1_1:
v_mov_b32 v237, v236
s_nop 1
v_permlane32_swap_b32 v236, v237
s_nop 1
v_max_f32 v236, v236, v237
v_mov_b32 v237, v236
s_nop 1
v_permlane16_swap_b32 v236, v237
s_nop 1
v_max_f32 v236, v236, v237
v_mul_f32 v236, s32, v236
v_max_f32 v236, v236, -v230
v_sub_f32 v237, -v230, v236
v_exp_f32 v237, v237
v_sub_f32 v230, 0, v236
v_mov_b32 v231, s34
v_fma_f32 v231, v236, s33, v231
v_mul_f32 v64, v64, v237
v_mul_f32 v65, v65, v237
v_mul_f32 v66, v66, v237
v_mul_f32 v67, v67, v237
v_mul_f32 v68, v68, v237
v_mul_f32 v69, v69, v237
v_mul_f32 v70, v70, v237
v_mul_f32 v71, v71, v237
v_mul_f32 v72, v72, v237
v_mul_f32 v73, v73, v237
v_mul_f32 v74, v74, v237
v_mul_f32 v75, v75, v237
v_mul_f32 v76, v76, v237
v_mul_f32 v77, v77, v237
v_mul_f32 v78, v78, v237
v_mul_f32 v79, v79, v237
v_mul_f32 v80, v80, v237
v_mul_f32 v81, v81, v237
v_mul_f32 v82, v82, v237
v_mul_f32 v83, v83, v237
v_mul_f32 v84, v84, v237
v_mul_f32 v85, v85, v237
v_mul_f32 v86, v86, v237
v_mul_f32 v87, v87, v237
v_mul_f32 v88, v88, v237
v_mul_f32 v89, v89, v237
v_mul_f32 v90, v90, v237
v_mul_f32 v91, v91, v237
v_mul_f32 v92, v92, v237
v_mul_f32 v93, v93, v237
v_mul_f32 v94, v94, v237
v_mul_f32 v95, v95, v237
v_mul_f32 v96, v96, v237
v_mul_f32 v97, v97, v237
v_mul_f32 v98, v98, v237
v_mul_f32 v99, v99, v237
v_mul_f32 v100, v100, v237
v_mul_f32 v101, v101, v237
v_mul_f32 v102, v102, v237
v_mul_f32 v103, v103, v237
v_mul_f32 v104, v104, v237
v_mul_f32 v105, v105, v237
v_mul_f32 v106, v106, v237
v_mul_f32 v107, v107, v237
v_mul_f32 v108, v108, v237
v_mul_f32 v109, v109, v237
v_mul_f32 v110, v110, v237
v_mul_f32 v111, v111, v237
v_mul_f32 v112, v112, v237
v_mul_f32 v113, v113, v237
v_mul_f32 v114, v114, v237
v_mul_f32 v115, v115, v237
v_mul_f32 v116, v116, v237
v_mul_f32 v117, v117, v237
v_mul_f32 v118, v118, v237
v_mul_f32 v119, v119, v237
v_mul_f32 v120, v120, v237
v_mul_f32 v121, v121, v237
v_mul_f32 v122, v122, v237
v_mul_f32 v123, v123, v237
v_mul_f32 v124, v124, v237
v_mul_f32 v125, v125, v237
v_mul_f32 v126, v126, v237
v_mul_f32 v127, v127, v237
v_accvgpr_read_b32 v236, a228
v_mul_f32 v236, v236, v237
v_accvgpr_write_b32 a228, v236
v_accvgpr_read_b32 v236, a229
v_mul_f32 v236, v236, v237
v_accvgpr_write_b32 a229, v236
v_accvgpr_read_b32 v236, a230
v_mul_f32 v236, v236, v237
v_accvgpr_write_b32 a230, v236
v_accvgpr_read_b32 v236, a231
v_mul_f32 v236, v236, v237
v_accvgpr_write_b32 a231, v236
s_branch L_ret1_1
L_rare2_0:
v_mov_b32 v235, v234
s_nop 1
v_permlane32_swap_b32 v234, v235
s_nop 1
v_max_f32 v234, v234, v235
v_mov_b32 v235, v234
s_nop 1
v_permlane16_swap_b32 v234, v235
s_nop 1
v_max_f32 v234, v234, v235
v_mul_f32 v234, s32, v234
v_max_f32 v234, v234, -v228
v_sub_f32 v235, -v228, v234
v_exp_f32 v235, v235
v_sub_f32 v228, 0, v234
v_mov_b32 v229, s34
v_fma_f32 v229, v234, s33, v229
v_mul_f32 v0, v0, v235
v_mul_f32 v1, v1, v235
v_mul_f32 v2, v2, v235
v_mul_f32 v3, v3, v235
v_mul_f32 v4, v4, v235
v_mul_f32 v5, v5, v235
v_mul_f32 v6, v6, v235
v_mul_f32 v7, v7, v235
v_mul_f32 v8, v8, v235
v_mul_f32 v9, v9, v235
v_mul_f32 v10, v10, v235
v_mul_f32 v11, v11, v235
v_mul_f32 v12, v12, v235
v_mul_f32 v13, v13, v235
v_mul_f32 v14, v14, v235
v_mul_f32 v15, v15, v235
v_mul_f32 v16, v16, v235
v_mul_f32 v17, v17, v235
v_mul_f32 v18, v18, v235
v_mul_f32 v19, v19, v235
v_mul_f32 v20, v20, v235
v_mul_f32 v21, v21, v235
v_mul_f32 v22, v22, v235
v_mul_f32 v23, v23, v235
v_mul_f32 v24, v24, v235
v_mul_f32 v25, v25, v235
v_mul_f32 v26, v26, v235
v_mul_f32 v27, v27, v235
v_mul_f32 v28, v28, v235
v_mul_f32 v29, v29, v235
v_mul_f32 v30, v30, v235
v_mul_f32 v31, v31, v235
v_mul_f32 v32, v32, v235
v_mul_f32 v33, v33, v235
v_mul_f32 v34, v34, v235
v_mul_f32 v35, v35, v235
v_mul_f32 v36, v36, v235
v_mul_f32 v37, v37, v235
v_mul_f32 v38, v38, v235
v_mul_f32 v39, v39, v235
v_mul_f32 v40, v40, v235
v_mul_f32 v41, v41, v235
v_mul_f32 v42, v42, v235
v_mul_f32 v43, v43, v235
v_mul_f32 v44, v44, v235
v_mul_f32 v45, v45, v235
v_mul_f32 v46, v46, v235
v_mul_f32 v47, v47, v235
v_mul_f32 v48, v48, v235
v_mul_f32 v49, v49, v235
v_mul_f32 v50, v50, v235
v_mul_f32 v51, v51, v235
v_mul_f32 v52, v52, v235
v_mul_f32 v53, v53, v235
v_mul_f32 v54, v54, v235
v_mul_f32 v55, v55, v235
v_mul_f32 v56, v56, v235
v_mul_f32 v57, v57, v235
v_mul_f32 v58, v58, v235
v_mul_f32 v59, v59, v235
v_mul_f32 v60, v60, v235
v_mul_f32 v61, v61, v235
v_mul_f32 v62, v62, v235
v_mul_f32 v63, v63, v235
v_accvgpr_read_b32 v234, a224
v_mul_f32 v234, v234, v235
v_accvgpr_write_b32 a224, v234
v_accvgpr_read_b32 v234, a225
v_mul_f32 v234, v234, v235
v_accvgpr_write_b32 a225, v234
v_accvgpr_read_b32 v234, a226
v_mul_f32 v234, v234, v235
v_accvgpr_write_b32 a226, v234
v_accvgpr_read_b32 v234, a227
v_mul_f32 v234, v234, v235
v_accvgpr_write_b32 a227, v234
s_branch L_ret2_0
L_rare2_1:
v_mov_b32 v237, v236
s_nop 1
v_permlane32_swap_b32 v236, v237
s_nop 1
v_max_f32 v236, v236, v237
v_mov_b32 v237, v236
s_nop 1
v_permlane16_swap_b32 v236, v237
s_nop 1
v_max_f32 v236, v236, v237
v_mul_f32 v236, s32, v236
v_max_f32 v236, v236, -v230
v_sub_f32 v237, -v230, v236
v_exp_f32 v237, v237
v_sub_f32 v230, 0, v236
v_mov_b32 v231, s34
v_fma_f32 v231, v236, s33, v231
v_mul_f32 v64, v64, v237
v_mul_f32 v65, v65, v237
v_mul_f32 v66, v66, v237
v_mul_f32 v67, v67, v237
v_mul_f32 v68, v68, v237
v_mul_f32 v69, v69, v237
v_mul_f32 v70, v70, v237
v_mul_f32 v71, v71, v237
v_mul_f32 v72, v72, v237
v_mul_f32 v73, v73, v237
v_mul_f32 v74, v74, v237
v_mul_f32 v75, v75, v237
v_mul_f32 v76, v76, v237
v_mul_f32 v77, v77, v237
v_mul_f32 v78, v78, v237
v_mul_f32 v79, v79, v237
v_mul_f32 v80, v80, v237
v_mul_f32 v81, v81, v237
v_mul_f32 v82, v82, v237
v_mul_f32 v83, v83, v237
v_mul_f32 v84, v84, v237
v_mul_f32 v85, v85, v237
v_mul_f32 v86, v86, v237
v_mul_f32 v87, v87, v237
v_mul_f32 v88, v88, v237
v_mul_f32 v89, v89, v237
v_mul_f32 v90, v90, v237
v_mul_f32 v91, v91, v237
v_mul_f32 v92, v92, v237
v_mul_f32 v93, v93, v237
v_mul_f32 v94, v94, v237
v_mul_f32 v95, v95, v237
v_mul_f32 v96, v96, v237
v_mul_f32 v97, v97, v237
v_mul_f32 v98, v98, v237
v_mul_f32 v99, v99, v237
v_mul_f32 v100, v100, v237
v_mul_f32 v101, v101, v237
v_mul_f32 v102, v102, v237
v_mul_f32 v103, v103, v237
v_mul_f32 v104, v104, v237
v_mul_f32 v105, v105, v237
v_mul_f32 v106, v106, v237
v_mul_f32 v107, v107, v237
v_mul_f32 v108, v108, v237
v_mul_f32 v109, v109, v237
v_mul_f32 v110, v110, v237
v_mul_f32 v111, v111, v237
v_mul_f32 v112, v112, v237
v_mul_f32 v113, v113, v237
v_mul_f32 v114, v114, v237
v_mul_f32 v115, v115, v237
v_mul_f32 v116, v116, v237
v_mul_f32 v117, v117, v237
v_mul_f32 v118, v118, v237
v_mul_f32 v119, v119, v237
v_mul_f32 v120, v120, v237
v_mul_f32 v121, v121, v237
v_mul_f32 v122, v122, v237
v_mul_f32 v123, v123, v237
v_mul_f32 v124, v124, v237
v_mul_f32 v125, v125, v237
v_mul_f32 v126, v126, v237
v_mul_f32 v127, v127, v237
v_accvgpr_read_b32 v236, a228
v_mul_f32 v236, v236, v237
v_accvgpr_write_b32 a228, v236
v_accvgpr_read_b32 v236, a229
v_mul_f32 v236, v236, v237
v_accvgpr_write_b32 a229, v236
v_accvgpr_read_b32 v236, a230
v_mul_f32 v236, v236, v237
v_accvgpr_write_b32 a230, v236
v_accvgpr_read_b32 v236, a231
v_mul_f32 v236, v236, v237
v_accvgpr_write_b32 a231, v236
s_branch L_ret2_1
L_rare3_0:
v_mov_b32 v235, v234
s_nop 1
v_permlane32_swap_b32 v234, v235
s_nop 1
v_max_f32 v234, v234, v235
v_mov_b32 v235, v234
s_nop 1
v_permlane16_swap_b32 v234, v235
s_nop 1
v_max_f32 v234, v234, v235
v_mul_f32 v234, s32, v234
v_max_f32 v234, v234, -v228
v_sub_f32 v235, -v228, v234
v_exp_f32 v235, v235
v_sub_f32 v228, 0, v234
v_mov_b32 v229, s34
v_fma_f32 v229, v234, s33, v229
v_mul_f32 v0, v0, v235
v_mul_f32 v1, v1, v235
v_mul_f32 v2, v2, v235
v_mul_f32 v3, v3, v235
v_mul_f32 v4, v4, v235
v_mul_f32 v5, v5, v235
v_mul_f32 v6, v6, v235
v_mul_f32 v7, v7, v235
v_mul_f32 v8, v8, v235
v_mul_f32 v9, v9, v235
v_mul_f32 v10, v10, v235
v_mul_f32 v11, v11, v235
v_mul_f32 v12, v12, v235
v_mul_f32 v13, v13, v235
v_mul_f32 v14, v14, v235
v_mul_f32 v15, v15, v235
v_mul_f32 v16, v16, v235
v_mul_f32 v17, v17, v235
v_mul_f32 v18, v18, v235
v_mul_f32 v19, v19, v235
v_mul_f32 v20, v20, v235
v_mul_f32 v21, v21, v235
v_mul_f32 v22, v22, v235
v_mul_f32 v23, v23, v235
v_mul_f32 v24, v24, v235
v_mul_f32 v25, v25, v235
v_mul_f32 v26, v26, v235
v_mul_f32 v27, v27, v235
v_mul_f32 v28, v28, v235
v_mul_f32 v29, v29, v235
v_mul_f32 v30, v30, v235
v_mul_f32 v31, v31, v235
v_mul_f32 v32, v32, v235
v_mul_f32 v33, v33, v235
v_mul_f32 v34, v34, v235
v_mul_f32 v35, v35, v235
v_mul_f32 v36, v36, v235
v_mul_f32 v37, v37, v235
v_mul_f32 v38, v38, v235
v_mul_f32 v39, v39, v235
v_mul_f32 v40, v40, v235
v_mul_f32 v41, v41, v235
v_mul_f32 v42, v42, v235
v_mul_f32 v43, v43, v235
v_mul_f32 v44, v44, v235
v_mul_f32 v45, v45, v235
v_mul_f32 v46, v46, v235
v_mul_f32 v47, v47, v235
v_mul_f32 v48, v48, v235
v_mul_f32 v49, v49, v235
v_mul_f32 v50, v50, v235
v_mul_f32 v51, v51, v235
v_mul_f32 v52, v52, v235
v_mul_f32 v53, v53, v235
v_mul_f32 v54, v54, v235
v_mul_f32 v55, v55, v235
v_mul_f32 v56, v56, v235
v_mul_f32 v57, v57, v235
v_mul_f32 v58, v58, v235
v_mul_f32 v59, v59, v235
v_mul_f32 v60, v60, v235
v_mul_f32 v61, v61, v235
v_mul_f32 v62, v62, v235
v_mul_f32 v63, v63, v235
v_accvgpr_read_b32 v234, a224
v_mul_f32 v234, v234, v235
v_accvgpr_write_b32 a224, v234
v_accvgpr_read_b32 v234, a225
v_mul_f32 v234, v234, v235
v_accvgpr_write_b32 a225, v234
v_accvgpr_read_b32 v234, a226
v_mul_f32 v234, v234, v235
v_accvgpr_write_b32 a226, v234
v_accvgpr_read_b32 v234, a227
v_mul_f32 v234, v234, v235
v_accvgpr_write_b32 a227, v234
s_branch L_ret3_0
L_rare3_1:
v_mov_b32 v237, v236
s_nop 1
v_permlane32_swap_b32 v236, v237
s_nop 1
v_max_f32 v236, v236, v237
v_mov_b32 v237, v236
s_nop 1
v_permlane16_swap_b32 v236, v237
s_nop 1
v_max_f32 v236, v236, v237
v_mul_f32 v236, s32, v236
v_max_f32 v236, v236, -v230
v_sub_f32 v237, -v230, v236
v_exp_f32 v237, v237
v_sub_f32 v230, 0, v236
v_mov_b32 v231, s34
v_fma_f32 v231, v236, s33, v231
v_mul_f32 v64, v64, v237
v_mul_f32 v65, v65, v237
v_mul_f32 v66, v66, v237
v_mul_f32 v67, v67, v237
v_mul_f32 v68, v68, v237
v_mul_f32 v69, v69, v237
v_mul_f32 v70, v70, v237
v_mul_f32 v71, v71, v237
v_mul_f32 v72, v72, v237
v_mul_f32 v73, v73, v237
v_mul_f32 v74, v74, v237
v_mul_f32 v75, v75, v237
v_mul_f32 v76, v76, v237
v_mul_f32 v77, v77, v237
v_mul_f32 v78, v78, v237
v_mul_f32 v79, v79, v237
v_mul_f32 v80, v80, v237
v_mul_f32 v81, v81, v237
v_mul_f32 v82, v82, v237
v_mul_f32 v83, v83, v237
v_mul_f32 v84, v84, v237
v_mul_f32 v85, v85, v237
v_mul_f32 v86, v86, v237
v_mul_f32 v87, v87, v237
v_mul_f32 v88, v88, v237
v_mul_f32 v89, v89, v237
v_mul_f32 v90, v90, v237
v_mul_f32 v91, v91, v237
v_mul_f32 v92, v92, v237
v_mul_f32 v93, v93, v237
v_mul_f32 v94, v94, v237
v_mul_f32 v95, v95, v237
v_mul_f32 v96, v96, v237
v_mul_f32 v97, v97, v237
v_mul_f32 v98, v98, v237
v_mul_f32 v99, v99, v237
v_mul_f32 v100, v100, v237
v_mul_f32 v101, v101, v237
v_mul_f32 v102, v102, v237
v_mul_f32 v103, v103, v237
v_mul_f32 v104, v104, v237
v_mul_f32 v105, v105, v237
v_mul_f32 v106, v106, v237
v_mul_f32 v107, v107, v237
v_mul_f32 v108, v108, v237
v_mul_f32 v109, v109, v237
v_mul_f32 v110, v110, v237
v_mul_f32 v111, v111, v237
v_mul_f32 v112, v112, v237
v_mul_f32 v113, v113, v237
v_mul_f32 v114, v114, v237
v_mul_f32 v115, v115, v237
v_mul_f32 v116, v116, v237
v_mul_f32 v117, v117, v237
v_mul_f32 v118, v118, v237
v_mul_f32 v119, v119, v237
v_mul_f32 v120, v120, v237
v_mul_f32 v121, v121, v237
v_mul_f32 v122, v122, v237
v_mul_f32 v123, v123, v237
v_mul_f32 v124, v124, v237
v_mul_f32 v125, v125, v237
v_mul_f32 v126, v126, v237
v_mul_f32 v127, v127, v237
v_accvgpr_read_b32 v236, a228
v_mul_f32 v236, v236, v237
v_accvgpr_write_b32 a228, v236
v_accvgpr_read_b32 v236, a229
v_mul_f32 v236, v236, v237
v_accvgpr_write_b32 a229, v236
v_accvgpr_read_b32 v236, a230
v_mul_f32 v236, v236, v237
v_accvgpr_write_b32 a230, v236
v_accvgpr_read_b32 v236, a231
v_mul_f32 v236, v236, v237
v_accvgpr_write_b32 a231, v236
s_branch L_ret3_1
L_rare4_0:
v_mov_b32 v235, v234
s_nop 1
v_permlane32_swap_b32 v234, v235
s_nop 1
v_max_f32 v234, v234, v235
v_mov_b32 v235, v234
s_nop 1
v_permlane16_swap_b32 v234, v235
s_nop 1
v_max_f32 v234, v234, v235
v_mul_f32 v234, s32, v234
v_max_f32 v234, v234, -v228
v_sub_f32 v235, -v228, v234
v_exp_f32 v235, v235
v_sub_f32 v228, 0, v234
v_mov_b32 v229, s34
v_fma_f32 v229, v234, s33, v229
v_mul_f32 v0, v0, v235
v_mul_f32 v1, v1, v235
v_mul_f32 v2, v2, v235
v_mul_f32 v3, v3, v235
v_mul_f32 v4, v4, v235
v_mul_f32 v5, v5, v235
v_mul_f32 v6, v6, v235
v_mul_f32 v7, v7, v235
v_mul_f32 v8, v8, v235
v_mul_f32 v9, v9, v235
v_mul_f32 v10, v10, v235
v_mul_f32 v11, v11, v235
v_mul_f32 v12, v12, v235
v_mul_f32 v13, v13, v235
v_mul_f32 v14, v14, v235
v_mul_f32 v15, v15, v235
v_mul_f32 v16, v16, v235
v_mul_f32 v17, v17, v235
v_mul_f32 v18, v18, v235
v_mul_f32 v19, v19, v235
v_mul_f32 v20, v20, v235
v_mul_f32 v21, v21, v235
v_mul_f32 v22, v22, v235
v_mul_f32 v23, v23, v235
v_mul_f32 v24, v24, v235
v_mul_f32 v25, v25, v235
v_mul_f32 v26, v26, v235
v_mul_f32 v27, v27, v235
v_mul_f32 v28, v28, v235
v_mul_f32 v29, v29, v235
v_mul_f32 v30, v30, v235
v_mul_f32 v31, v31, v235
v_mul_f32 v32, v32, v235
v_mul_f32 v33, v33, v235
v_mul_f32 v34, v34, v235
v_mul_f32 v35, v35, v235
v_mul_f32 v36, v36, v235
v_mul_f32 v37, v37, v235
v_mul_f32 v38, v38, v235
v_mul_f32 v39, v39, v235
v_mul_f32 v40, v40, v235
v_mul_f32 v41, v41, v235
v_mul_f32 v42, v42, v235
v_mul_f32 v43, v43, v235
v_mul_f32 v44, v44, v235
v_mul_f32 v45, v45, v235
v_mul_f32 v46, v46, v235
v_mul_f32 v47, v47, v235
v_mul_f32 v48, v48, v235
v_mul_f32 v49, v49, v235
v_mul_f32 v50, v50, v235
v_mul_f32 v51, v51, v235
v_mul_f32 v52, v52, v235
v_mul_f32 v53, v53, v235
v_mul_f32 v54, v54, v235
v_mul_f32 v55, v55, v235
v_mul_f32 v56, v56, v235
v_mul_f32 v57, v57, v235
v_mul_f32 v58, v58, v235
v_mul_f32 v59, v59, v235
v_mul_f32 v60, v60, v235
v_mul_f32 v61, v61, v235
v_mul_f32 v62, v62, v235
v_mul_f32 v63, v63, v235
v_accvgpr_read_b32 v234, a224
v_mul_f32 v234, v234, v235
v_accvgpr_write_b32 a224, v234
v_accvgpr_read_b32 v234, a225
v_mul_f32 v234, v234, v235
v_accvgpr_write_b32 a225, v234
v_accvgpr_read_b32 v234, a226
v_mul_f32 v234, v234, v235
v_accvgpr_write_b32 a226, v234
v_accvgpr_read_b32 v234, a227
v_mul_f32 v234, v234, v235
v_accvgpr_write_b32 a227, v234
s_branch L_ret4_0
L_rare4_1:
v_mov_b32 v237, v236
s_nop 1
v_permlane32_swap_b32 v236, v237
s_nop 1
v_max_f32 v236, v236, v237
v_mov_b32 v237, v236
s_nop 1
v_permlane16_swap_b32 v236, v237
s_nop 1
v_max_f32 v236, v236, v237
v_mul_f32 v236, s32, v236
v_max_f32 v236, v236, -v230
v_sub_f32 v237, -v230, v236
v_exp_f32 v237, v237
v_sub_f32 v230, 0, v236
v_mov_b32 v231, s34
v_fma_f32 v231, v236, s33, v231
v_mul_f32 v64, v64, v237
v_mul_f32 v65, v65, v237
v_mul_f32 v66, v66, v237
v_mul_f32 v67, v67, v237
v_mul_f32 v68, v68, v237
v_mul_f32 v69, v69, v237
v_mul_f32 v70, v70, v237
v_mul_f32 v71, v71, v237
v_mul_f32 v72, v72, v237
v_mul_f32 v73, v73, v237
v_mul_f32 v74, v74, v237
v_mul_f32 v75, v75, v237
v_mul_f32 v76, v76, v237
v_mul_f32 v77, v77, v237
v_mul_f32 v78, v78, v237
v_mul_f32 v79, v79, v237
v_mul_f32 v80, v80, v237
v_mul_f32 v81, v81, v237
v_mul_f32 v82, v82, v237
v_mul_f32 v83, v83, v237
v_mul_f32 v84, v84, v237
v_mul_f32 v85, v85, v237
v_mul_f32 v86, v86, v237
v_mul_f32 v87, v87, v237
v_mul_f32 v88, v88, v237
v_mul_f32 v89, v89, v237
v_mul_f32 v90, v90, v237
v_mul_f32 v91, v91, v237
v_mul_f32 v92, v92, v237
v_mul_f32 v93, v93, v237
v_mul_f32 v94, v94, v237
v_mul_f32 v95, v95, v237
v_mul_f32 v96, v96, v237
v_mul_f32 v97, v97, v237
v_mul_f32 v98, v98, v237
v_mul_f32 v99, v99, v237
v_mul_f32 v100, v100, v237
v_mul_f32 v101, v101, v237
v_mul_f32 v102, v102, v237
v_mul_f32 v103, v103, v237
v_mul_f32 v104, v104, v237
v_mul_f32 v105, v105, v237
v_mul_f32 v106, v106, v237
v_mul_f32 v107, v107, v237
v_mul_f32 v108, v108, v237
v_mul_f32 v109, v109, v237
v_mul_f32 v110, v110, v237
v_mul_f32 v111, v111, v237
v_mul_f32 v112, v112, v237
v_mul_f32 v113, v113, v237
v_mul_f32 v114, v114, v237
v_mul_f32 v115, v115, v237
v_mul_f32 v116, v116, v237
v_mul_f32 v117, v117, v237
v_mul_f32 v118, v118, v237
v_mul_f32 v119, v119, v237
v_mul_f32 v120, v120, v237
v_mul_f32 v121, v121, v237
v_mul_f32 v122, v122, v237
v_mul_f32 v123, v123, v237
v_mul_f32 v124, v124, v237
v_mul_f32 v125, v125, v237
v_mul_f32 v126, v126, v237
v_mul_f32 v127, v127, v237
v_accvgpr_read_b32 v236, a228
v_mul_f32 v236, v236, v237
v_accvgpr_write_b32 a228, v236
v_accvgpr_read_b32 v236, a229
v_mul_f32 v236, v236, v237
v_accvgpr_write_b32 a229, v236
v_accvgpr_read_b32 v236, a230
v_mul_f32 v236, v236, v237
v_accvgpr_write_b32 a230, v236
v_accvgpr_read_b32 v236, a231
v_mul_f32 v236, v236, v237
v_accvgpr_write_b32 a231, v236
s_branch L_ret4_1
L_rare5_0:
v_mov_b32 v235, v234
s_nop 1
v_permlane32_swap_b32 v234, v235
s_nop 1
v_max_f32 v234, v234, v235
v_mov_b32 v235, v234
s_nop 1
v_permlane16_swap_b32 v234, v235
s_nop 1
v_max_f32 v234, v234, v235
v_mul_f32 v234, s32, v234
v_max_f32 v234, v234, -v228
v_sub_f32 v235, -v228, v234
v_exp_f32 v235, v235
v_sub_f32 v228, 0, v234
v_mov_b32 v229, s34
v_fma_f32 v229, v234, s33, v229
v_mul_f32 v0, v0, v235
v_mul_f32 v1, v1, v235
v_mul_f32 v2, v2, v235
v_mul_f32 v3, v3, v235
v_mul_f32 v4, v4, v235
v_mul_f32 v5, v5, v235
v_mul_f32 v6, v6, v235
v_mul_f32 v7, v7, v235
v_mul_f32 v8, v8, v235
v_mul_f32 v9, v9, v235
v_mul_f32 v10, v10, v235
v_mul_f32 v11, v11, v235
v_mul_f32 v12, v12, v235
v_mul_f32 v13, v13, v235
v_mul_f32 v14, v14, v235
v_mul_f32 v15, v15, v235
v_mul_f32 v16, v16, v235
v_mul_f32 v17, v17, v235
v_mul_f32 v18, v18, v235
v_mul_f32 v19, v19, v235
v_mul_f32 v20, v20, v235
v_mul_f32 v21, v21, v235
v_mul_f32 v22, v22, v235
v_mul_f32 v23, v23, v235
v_mul_f32 v24, v24, v235
v_mul_f32 v25, v25, v235
v_mul_f32 v26, v26, v235
v_mul_f32 v27, v27, v235
v_mul_f32 v28, v28, v235
v_mul_f32 v29, v29, v235
v_mul_f32 v30, v30, v235
v_mul_f32 v31, v31, v235
v_mul_f32 v32, v32, v235
v_mul_f32 v33, v33, v235
v_mul_f32 v34, v34, v235
v_mul_f32 v35, v35, v235
v_mul_f32 v36, v36, v235
v_mul_f32 v37, v37, v235
v_mul_f32 v38, v38, v235
v_mul_f32 v39, v39, v235
v_mul_f32 v40, v40, v235
v_mul_f32 v41, v41, v235
v_mul_f32 v42, v42, v235
v_mul_f32 v43, v43, v235
v_mul_f32 v44, v44, v235
v_mul_f32 v45, v45, v235
v_mul_f32 v46, v46, v235
v_mul_f32 v47, v47, v235
v_mul_f32 v48, v48, v235
v_mul_f32 v49, v49, v235
v_mul_f32 v50, v50, v235
v_mul_f32 v51, v51, v235
v_mul_f32 v52, v52, v235
v_mul_f32 v53, v53, v235
v_mul_f32 v54, v54, v235
v_mul_f32 v55, v55, v235
v_mul_f32 v56, v56, v235
v_mul_f32 v57, v57, v235
v_mul_f32 v58, v58, v235
v_mul_f32 v59, v59, v235
v_mul_f32 v60, v60, v235
v_mul_f32 v61, v61, v235
v_mul_f32 v62, v62, v235
v_mul_f32 v63, v63, v235
v_accvgpr_read_b32 v234, a224
v_mul_f32 v234, v234, v235
v_accvgpr_write_b32 a224, v234
v_accvgpr_read_b32 v234, a225
v_mul_f32 v234, v234, v235
v_accvgpr_write_b32 a225, v234
v_accvgpr_read_b32 v234, a226
v_mul_f32 v234, v234, v235
v_accvgpr_write_b32 a226, v234
v_accvgpr_read_b32 v234, a227
v_mul_f32 v234, v234, v235
v_accvgpr_write_b32 a227, v234
s_branch L_ret5_0
L_rare5_1:
v_mov_b32 v237, v236
s_nop 1
v_permlane32_swap_b32 v236, v237
s_nop 1
v_max_f32 v236, v236, v237
v_mov_b32 v237, v236
s_nop 1
v_permlane16_swap_b32 v236, v237
s_nop 1
v_max_f32 v236, v236, v237
v_mul_f32 v236, s32, v236
v_max_f32 v236, v236, -v230
v_sub_f32 v237, -v230, v236
v_exp_f32 v237, v237
v_sub_f32 v230, 0, v236
v_mov_b32 v231, s34
v_fma_f32 v231, v236, s33, v231
v_mul_f32 v64, v64, v237
v_mul_f32 v65, v65, v237
v_mul_f32 v66, v66, v237
v_mul_f32 v67, v67, v237
v_mul_f32 v68, v68, v237
v_mul_f32 v69, v69, v237
v_mul_f32 v70, v70, v237
v_mul_f32 v71, v71, v237
v_mul_f32 v72, v72, v237
v_mul_f32 v73, v73, v237
v_mul_f32 v74, v74, v237
v_mul_f32 v75, v75, v237
v_mul_f32 v76, v76, v237
v_mul_f32 v77, v77, v237
v_mul_f32 v78, v78, v237
v_mul_f32 v79, v79, v237
v_mul_f32 v80, v80, v237
v_mul_f32 v81, v81, v237
v_mul_f32 v82, v82, v237
v_mul_f32 v83, v83, v237
v_mul_f32 v84, v84, v237
v_mul_f32 v85, v85, v237
v_mul_f32 v86, v86, v237
v_mul_f32 v87, v87, v237
v_mul_f32 v88, v88, v237
v_mul_f32 v89, v89, v237
v_mul_f32 v90, v90, v237
v_mul_f32 v91, v91, v237
v_mul_f32 v92, v92, v237
v_mul_f32 v93, v93, v237
v_mul_f32 v94, v94, v237
v_mul_f32 v95, v95, v237
v_mul_f32 v96, v96, v237
v_mul_f32 v97, v97, v237
v_mul_f32 v98, v98, v237
v_mul_f32 v99, v99, v237
v_mul_f32 v100, v100, v237
v_mul_f32 v101, v101, v237
v_mul_f32 v102, v102, v237
v_mul_f32 v103, v103, v237
v_mul_f32 v104, v104, v237
v_mul_f32 v105, v105, v237
v_mul_f32 v106, v106, v237
v_mul_f32 v107, v107, v237
v_mul_f32 v108, v108, v237
v_mul_f32 v109, v109, v237
v_mul_f32 v110, v110, v237
v_mul_f32 v111, v111, v237
v_mul_f32 v112, v112, v237
v_mul_f32 v113, v113, v237
v_mul_f32 v114, v114, v237
v_mul_f32 v115, v115, v237
v_mul_f32 v116, v116, v237
v_mul_f32 v117, v117, v237
v_mul_f32 v118, v118, v237
v_mul_f32 v119, v119, v237
v_mul_f32 v120, v120, v237
v_mul_f32 v121, v121, v237
v_mul_f32 v122, v122, v237
v_mul_f32 v123, v123, v237
v_mul_f32 v124, v124, v237
v_mul_f32 v125, v125, v237
v_mul_f32 v126, v126, v237
v_mul_f32 v127, v127, v237
v_accvgpr_read_b32 v236, a228
v_mul_f32 v236, v236, v237
v_accvgpr_write_b32 a228, v236
v_accvgpr_read_b32 v236, a229
v_mul_f32 v236, v236, v237
v_accvgpr_write_b32 a229, v236
v_accvgpr_read_b32 v236, a230
v_mul_f32 v236, v236, v237
v_accvgpr_write_b32 a230, v236
v_accvgpr_read_b32 v236, a231
v_mul_f32 v236, v236, v237
v_accvgpr_write_b32 a231, v236
s_branch L_ret5_1
L_codeend:
.section .rodata,"a"
.p2align 6
.amdhsa_kernel standalone__mha_block_cached__near_ridge_kernel
  .amdhsa_next_free_vgpr 512
  .amdhsa_next_free_sgpr 102
  .amdhsa_accum_offset 256
  .amdhsa_group_segment_fixed_size 0
  .amdhsa_kernarg_size 64
  .amdhsa_user_sgpr_count 2
  .amdhsa_user_sgpr_kernarg_segment_ptr 1
  .amdhsa_system_sgpr_workgroup_id_x 1
.end_amdhsa_kernel
```
